```python
import torch

def _softmax(x, axis=-1):
    return torch.softmax(x, dim=axis)
def _gelu(x):
    return torch.nn.functional.gelu(x, approximate="tanh")
def _silu(x):
    return torch.nn.functional.silu(x)
def _sigmoid(x):
    return torch.sigmoid(x)
def _layernorm(x, axis=-1, eps=1e-5):
    m = x.mean(dim=axis, keepdim=True)
    v = x.var(dim=axis, keepdim=True, unbiased=False)
    return (x - m) / torch.sqrt(v + eps)
def _scatter_add(tgt, idx, src, axis=0):
    return tgt.clone().index_add_(axis, idx, src)
def _segment_sum(src, seg, n):
    out = torch.zeros((n,) + src.shape[1:], dtype=src.dtype)
    return out.index_add_(0, seg, src)
def _pad(x, pw):
    flat = tuple(v for pair in reversed(pw) for v in pair)
    return torch.nn.functional.pad(x, flat)

kernel_name = 'sequential_preLN__linear_kernel_hedgehog__mixer_s_mlp__prompt'

def setup_inputs():

    _w = (lambda a: (lambda t: t.to(torch.bfloat16) if t.is_floating_point() else t)(torch.as_tensor(a)))
    def _A_setup():
        B, S, D, H = 1, 2048, 448, 16
        Dh = D // H
        return {
            "x": _w((lambda *s: torch.randn(*s, dtype=torch.bfloat16) * 0.05)(B, S, D)),
            "wqkv": _w((lambda *s: torch.randn(*s, dtype=torch.bfloat16) * 0.2)(D, 3 * D)),
            "w_phi": _w((lambda *s: torch.randn(*s, dtype=torch.bfloat16) * 0.2)(H, Dh, Dh) * (Dh ** -0.5)),
            "wo": _w((lambda *s: torch.randn(*s, dtype=torch.bfloat16) * 0.05)(D, D)),
        }
    _A_in = _A_setup()

    def _B_setup():
        B, S, D, F = 1, 2048, 448, 1792
        return {
            "x":  _w((lambda *s: torch.randn(*s, dtype=torch.bfloat16) * 0.05)(B, S, D)),
            "w1": _w((lambda *s: torch.randn(*s, dtype=torch.bfloat16) * 3.2)(D, D) * (D ** -0.5)),
            "w2": _w((lambda *s: torch.randn(*s, dtype=torch.bfloat16) * 3.2)(D, D) * (D ** -0.5)),
            "w3": _w((lambda *s: torch.randn(*s, dtype=torch.bfloat16) * 3.2)(D, F) * (D ** -0.5)),
            "w4": _w((lambda *s: torch.randn(*s, dtype=torch.bfloat16) * 3.2)(F, D) * (F ** -0.5)),
        }
    _B_in = _B_setup()

    return {
        "A_x": _A_in["x"],
        "A_wqkv": _A_in["wqkv"],
        "A_w_phi": _A_in["w_phi"],
        "A_wo": _A_in["wo"],
        "B_x": _B_in["x"],
        "B_w1": _B_in["w1"],
        "B_w2": _B_in["w2"],
        "B_w3": _B_in["w3"],
        "B_w4": _B_in["w4"],
    }

def reference(A_x, A_wqkv, A_w_phi, A_wo, B_x, B_w1, B_w2, B_w3, B_w4):
    def _A_ref(x, wqkv, w_phi, wo):
        B, S, D = x.shape
        H = 16; Dh = D // H
        qkv = (lambda x, *d: x.permute(*d))((x @ wqkv).reshape(B, S, 3, H, Dh), 2, 0, 3, 1, 4)
        q, k, v = qkv[0], qkv[1], qkv[2]
        pq = torch.einsum("bhsd,hdf->bhsf", q, w_phi)
        pk = torch.einsum("bhsd,hdf->bhsf", k, w_phi)
        phi_q = torch.concatenate([_softmax(pq, axis=-1), _softmax(-pq, axis=-1)], axis=-1)
        phi_k = torch.concatenate([_softmax(pk, axis=-1), _softmax(-pk, axis=-1)], axis=-1)
        kv = torch.einsum("bhsf,bhsd->bhfd", phi_k, v)
        z  = torch.einsum("bhsf->bhf", phi_k)
        num = torch.einsum("bhqf,bhfd->bhqd", phi_q, kv)
        den = torch.einsum("bhqf,bhf->bhq", phi_q, z)[..., None] + 1e-6
        o = num / den
        return (lambda x, *d: x.permute(*d))(o, 0, 2, 1, 3).reshape(B, S, D) @ wo

    def _B_ref(x, w1, w2, w3, w4):
        B, S, D = x.shape
        h = _gelu(_layernorm(x, axis=-1) @ w1)
        c = D // 4
        g0 = _pad(h[:, :, 0*c:1*c], ((0, 0), (1, 0), (0, 0)))[:, :S, :]
        g1 = _pad(h[:, :, 1*c:2*c], ((0, 0), (0, 1), (0, 0)))[:, 1:, :]
        g2 = _pad(h[:, :, 2*c:3*c], ((0, 0), (2, 0), (0, 0)))[:, :S, :]
        g3 = _pad(h[:, :, 3*c:   ], ((0, 0), (0, 2), (0, 0)))[:, 2:, :]
        hs = torch.concatenate([g0, g1, g2, g3], axis=-1) @ w2
        x1 = x + hs
        h2 = _gelu(_layernorm(x1, axis=-1) @ w3) @ w4
        return x1 + h2

    x = A_x
    h = x + _A_ref(_layernorm(x, axis=-1), A_wqkv, A_w_phi, A_wo)
    h2 = h + _B_ref(_layernorm(h, axis=-1), B_w1, B_w2, B_w3, B_w4)
    return h2
```

```asm
; @launch grid=(256,1,1) block=(256,1,1) lds=163840
.amdgcn_target "amdgcn-amd-amdhsa--gfx950"
.text
.globl sequential_preLN__linear_kernel_hedgehog__mixer_s_mlp__prompt_kernel
.p2align 12
.p2align 8
.type sequential_preLN__linear_kernel_hedgehog__mixer_s_mlp__prompt_kernel,@function
sequential_preLN__linear_kernel_hedgehog__mixer_s_mlp__prompt_kernel:
    s_cmp_ge_u32 s2, 256
    s_cbranch_scc1 L_end
    s_load_dwordx16 s[36:51], s[0:1], 0
    s_load_dwordx8 s[52:59], s[0:1], 64
    s_memrealtime s[96:97]
    s_getpc_b64 s[32:33]
    s_lshr_b32 s61, s2, 3
    s_lshl_b32 s4, s61, 11
    v_lshlrev_b32 v2, 3, v0
    v_add_u32 v2, s4, v2
    v_min_u32 v2, 0x9924, v2
    global_load_dword a251, v2, s[32:33]
    v_lshrrev_b32 v1, 6, v0
    s_and_b32 s60, s2, 7
    v_readfirstlane_b32 s62, v1
    v_and_b32 v0, 63, v0
    s_and_b32 s63, s61, 15
    s_lshr_b32 s64, s61, 4
    s_lshl1_add_u32 s64, s60, s64
    s_lshl2_add_u32 s67, s64, s62
    s_lshl_b32 s67, s67, 5
    s_mul_i32 s69, s62, 24576
    v_lshrrev_b32 v28, 3, v0
    v_mul_u32_u24 v28, 896, v28
    v_lshrrev_b32 v29, 4, v0
    v_and_b32 v30, 7, v0
    v_xor_b32 v29, v29, v30
    v_lshl_add_u32 v2, v29, 4, v28
    v_xor_b32 v29, 4, v29
    v_lshl_add_u32 v3, v29, 4, v28
    v_add_u32 v4, 12288, v2
    v_add_u32 v5, 18432, v3
    v_add_u32 v3, 6144, v3
    v_lshrrev_b32 v28, 2, v0
    v_and_b32 v29, 3, v0
    v_lshlrev_b32 v29, 4, v29
    v_lshl_add_u32 v7, v28, 10, v29
    v_mul_u32_u24 v28, 2688, v28
    v_add_u32 v6, v29, v28
    v_lshrrev_b32 v28, 4, v0
    v_lshlrev_b32 v28, 2, v28
    v_and_b32 v29, 7, v0
    v_lshl_add_u32 v28, v29, 4, v28
    v_bfe_u32 v29, v0, 3, 1
    v_lshl_add_u32 v250, v29, 30, v28
    s_mul_i32 s6, s67, 896
    s_mul_i32 s7, s62, 43008
    s_mul_i32 s4, s63, 56
    s_and_b32 s4, s4, 0xfff0
    s_add_u32 s7, s7, s4
    s_cmp_eq_u32 s60, 7
    s_cselect_b32 s5, 0, s60
    s_lshl_b32 s4, s5, 7
    s_add_u32 s20, s4, s6
    s_mul_i32 s4, s5, 172032
    s_add_u32 s84, s4, s7
    s_add_u32 s5, s5, 1
    s_cmp_eq_u32 s5, 7
    s_cselect_b32 s5, 0, s5
    s_lshl_b32 s4, s5, 7
    s_add_u32 s21, s4, s6
    s_mul_i32 s4, s5, 172032
    s_add_u32 s85, s4, s7
    s_add_u32 s5, s5, 1
    s_cmp_eq_u32 s5, 7
    s_cselect_b32 s5, 0, s5
    s_lshl_b32 s4, s5, 7
    s_add_u32 s22, s4, s6
    s_mul_i32 s4, s5, 172032
    s_add_u32 s86, s4, s7
    s_add_u32 s5, s5, 1
    s_cmp_eq_u32 s5, 7
    s_cselect_b32 s5, 0, s5
    s_lshl_b32 s4, s5, 7
    s_add_u32 s79, s4, s6
    s_mul_i32 s4, s5, 172032
    s_add_u32 s87, s4, s7
    s_add_u32 s5, s5, 1
    s_cmp_eq_u32 s5, 7
    s_cselect_b32 s5, 0, s5
    s_lshl_b32 s4, s5, 7
    s_add_u32 s82, s4, s6
    s_mul_i32 s4, s5, 172032
    s_add_u32 s88, s4, s7
    s_add_u32 s5, s5, 1
    s_cmp_eq_u32 s5, 7
    s_cselect_b32 s5, 0, s5
    s_lshl_b32 s4, s5, 7
    s_add_u32 s35, s4, s6
    s_mul_i32 s4, s5, 172032
    s_add_u32 s89, s4, s7
    s_add_u32 s5, s5, 1
    s_cmp_eq_u32 s5, 7
    s_cselect_b32 s5, 0, s5
    s_lshl_b32 s4, s5, 7
    s_add_u32 s95, s4, s6
    s_mul_i32 s4, s5, 172032
    s_add_u32 s90, s4, s7
    s_lshl_b32 s78, s62, 10
    s_lshl_b32 s33, s62, 11
    s_mov_b32 s10, 1835008
    s_mov_b32 s11, 0x20000
    s_mov_b32 s14, 1204224
    s_mov_b32 s15, 0x20000
    s_mov_b32 s18, 0x10000000
    s_mov_b32 s19, 0x20000
    s_mov_b32 s31, 0x20000
    s_mov_b32 s27, 0x20000
    s_mov_b32 s23, 0x20000
    v_lshlrev_b32_e64 v1, 4, v0
    s_lshl2_add_u32 s4, s63, s62
    s_lshl4_add_u32 s4, s4, s64
    s_lshl_b32 s92, s4, 10
    s_lshl_b32 s100, s4, 7
    s_add_u32 s100, s100, 1048576
    v_accvgpr_write_b32 a252, -1
    v_accvgpr_write_b32 a253, -1
    v_accvgpr_write_b32 a254, -1
    v_accvgpr_write_b32 a255, -1
    s_mul_i32 s101, s63, 1568
    s_add_u32 s30, s101, 1568
    s_add_u32 s101, s101, s78
    v_and_b32 v28, 31, v0
    v_lshlrev_b32 v29, 7, v28
    v_add_u32 v29, s69, v29
    v_bfe_u32 v30, v0, 1, 3
    v_lshrrev_b32 v31, 5, v0
    v_xor_b32 v30, v30, v31
    s_lshl_b32 s4, s62, 1
    v_xor_b32 v30, s4, v30
    v_xor_b32 v31, 0, v30
    v_lshl_add_u32 v8, v31, 4, v29
    v_xor_b32 v31, 2, v30
    v_lshl_add_u32 v9, v31, 4, v29
    v_xor_b32_e64 v31, 4, v30
    v_lshl_add_u32 v10, v31, 4, v29
    v_xor_b32 v31, 6, v30
    v_lshl_add_u32 v11, v31, 4, v29
    v_lshlrev_b32_e64 v252, 7, v0
    s_bfm_b32 s4, s61, 0
    s_and_b32 s4, s4, 3584808363
    s_bcnt1_i32_b32 s4, s4
    s_lshl2_add_u32 s4, s4, s62
    s_bitcmp1_b32 3584808363, s61
    s_cselect_b32 s3, s4, 0x2000
    s_lshl2_add_u32 s91, s61, s62
    s_lshl_b32 s4, s60, 7
    s_add_u32 s4, s4, s91
    s_mul_i32 s4, s4, 1792
    v_min_u32 v28, 13, v0
    v_lshl_add_u32 v201, v28, 7, s4
    s_or_b32 s4, s2, s62
    s_waitcnt lgkmcnt(0)
    s_cbranch_scc1 L_led
    s_lshl_b32 s97, s96, 1
    s_and_b32 s97, s97, 0x3fff8000
    s_and_b32 s96, s96, 0x3fff
    s_or_b32 s96, s96, s97
    s_bitset1_b32 s96, 31
    s_mov_b64 exec, 1
    v_mov_b32_e64 v28, s96
    global_store_dword v0, v28, s[56:57] sc1
    s_mov_b64 exec, -1
L_led:
    s_mov_b32 s1, s3
    s_mov_b64 s[8:9], s[36:37]
    s_mov_b64 s[12:13], s[38:39]
    s_add_u32 m0, s78, 97408
    s_nop 0
    buffer_load_dwordx4 v6, s[12:15], s84 offen offset:896 lds
    s_add_u32 m0, s78, 125184
    s_nop 0
    buffer_load_dwordx4 v6, s[12:15], s84 offen offset:1792 lds
    v_and_b32 v28, 31, v0
    v_add_u32 v28, s67, v28
    s_add_u32 m0, s69, 0
    s_nop 0
    buffer_load_dwordx4 v2, s[8:11], s20 offen offset:0 lds
    v_lshrrev_b32 v29, 4, v28
    v_mul_u32_u24 v29, 14336, v29
    v_and_b32_e64 v28, 15, v28
    v_lshl_add_u32 v29, v28, 4, v29
    buffer_load_dwordx4 v3, s[8:11], s20 offen offset:1024 lds
    buffer_load_dwordx4 v4, s[8:11], s20 offen offset:2048 lds
    buffer_load_dwordx4 v5, s[8:11], s20 offen offset:3072 lds
    buffer_load_dword a251, v201, s[8:11], 0 offen offset:0
    s_lshl3_add_u32 s83, s91, s60
    s_mul_i32 s83, s83, 2688
    s_add_u32 s26, s83, 896
    s_min_u32 s26, s26, 1204224
    s_mov_b32 s24, s12
    s_mov_b32 s25, s13
    v_add_u32 v29, 2097152, v29
    buffer_load_dword a251, v252, s[24:27], s83 offen
    s_mov_b64 s[28:29], s[40:41]
    s_mul_i32 s65, s61, 37
    s_lshr_b32 s65, s65, 8
    s_mul_i32 s66, s65, 7
    s_sub_u32 s66, s61, s66
    s_lshl2_add_u32 s68, s60, s65
    s_lshl2_add_u32 s68, s68, s62
    s_mul_i32 s77, s68, 14336
    s_lshl_b32 s4, s66, 11
    s_add_u32 s93, s77, s4
    s_lshl_b32 s94, s68, 11
    s_lshl2_add_u32 s4, s4, s94
    s_add_u32 s4, s4, 29327360
    s_cmp_ge_u32 s61, 28
    s_cselect_b32 s93, s4, s93
    s_lshl_b32 s4, s63, 2
    s_lshr_b32 s4, 1983194128, s4
    s_and_b32 s4, s4, 7
    s_and_b32 s5, s63, 8
    s_or_b32 s4, s4, s5
    s_lshl_b32 s4, s4, 8
    v_add_u32 v29, s4, v29
    v_lshrrev_b32 v28, 5, v0
    v_lshl_add_u32 v24, v28, 12, v29
    v_lshl_add_u32 v25, v28, 30, v29
    v_add_u32 v25, 8192, v25
    s_lshr_b32 s4, s63, 3
    s_mul_i32 s4, s4, -2040
    s_add_u32 s4, s4, -1073737728
    v_add_u32 v26, s4, v25
    s_mov_b32 s16, s58
    s_mov_b32 s17, s59
    v_lshrrev_b32 v28, 5, v0
    v_lshlrev_b32_e64 v28, 9, v28
    v_bfe_u32 v29, v0, 2, 2
    v_lshl_add_u32 v28, v29, 6, v28
    v_bfe_u32 v29, v0, 4, 1
    s_add_u32 m0, s78, 101504
    s_nop 0
    buffer_load_dwordx4 v6, s[12:15], s85 offen offset:896 lds
    v_and_b32 v30, 3, v0
    v_lshl_add_u32 v29, v29, 2, v30
    v_min_u32 v29, 6, v29
    s_and_b32 s4, s63, 1
    v_add_u32 v29, s4, v29
    v_lshl_add_u32 v244, v29, 3, v28
    s_xor_b32 s4, s78, 0
    s_add_u32 s4, s4, 98304
    v_add_u32 v12, s4, v244
    s_xor_b32 s4, s78, 1024
    s_add_u32 s4, s4, 98304
    v_add_u32 v13, s4, v244
    s_xor_b32 s4, s78, 2048
    s_add_u32 s4, s4, 98304
    v_add_u32 v14, s4, v244
    s_xor_b32 s4, s78, 3072
    s_add_u32 m0, s78, 129280
    s_nop 0
    buffer_load_dwordx4 v6, s[12:15], s85 offen offset:1792 lds
    s_add_u32 s4, s4, 98304
    v_add_u32 v15, s4, v244
    v_add_u32 v245, 159744, v1
    s_lshl_b32 s4, s62, 8
    s_add_u32 s4, s4, 160768
    v_lshrrev_b32 v28, 5, v0
    v_lshlrev_b32 v28, 4, v28
    v_add_u32 v246, s4, v28
    s_mov_b32 s80, 0x3f803f80
    s_mov_b32 s81, 0
    s_getreg_b32 s34, hwreg(HW_REG_XCC_ID, 0, 4)
    s_or_b32 s34, s34, 0x80
    v_and_b32 v28, 31, v0
    v_mul_u32_u24 v28, 208, v28
    v_lshrrev_b32_e64 v29, 5, v0
    v_lshl_add_u32 v28, v29, 4, v28
    s_add_u32 m0, s69, 4096
    s_nop 0
    buffer_load_dwordx4 v2, s[8:11], s21 offen offset:0 lds
    v_add_u32 v247, s69, v28
    v_lshrrev_b32 v28, 2, v0
    v_mul_u32_u24 v28, 416, v28
    v_and_b32 v29, 3, v0
    s_lshr_b32 s4, s62, 1
    s_lshl_b32 s4, s4, 6
    s_add_u32 s4, s4, 12288
    v_lshl_add_u32 v30, v29, 3, v28
    v_add_u32_e64 v248, s4, v30
    s_and_b32 s4, s62, 1
    s_lshl_b32 s4, s4, 5
    s_add_u32 s4, s4, 12416
    v_bfe_u32 v30, v0, 1, 1
    v_lshl_add_u32 v28, v30, 3, v28
    v_and_b32 v30, 1, v0
    v_lshl_add_u32 v28, v30, 4, v28
    s_mov_b64 exec, 0
    s_cmp_eq_u32 s62, 0
    s_cbranch_scc1 L_pg1
    s_cmp_eq_u32 s62, 1
    s_cbranch_scc1 L_pg2
    s_cmp_eq_u32 s62, 2
    s_cbranch_scc1 L_pg3
    s_branch L_pg4
L_pgt:
    s_mov_b64 exec, -1
    v_add_u32 v249, s4, v28
    buffer_load_dwordx4 v3, s[8:11], s21 offen offset:1024 lds
    v_and_b32 v28, 3, v0
    v_bfe_u32 v29, v0, 3, 2
    v_lshl_add_u32 v28, v29, 2, v28
    v_bfe_u32 v29, v0, 2, 1
    v_mad_u32_u24 v29, v29, 14, v28
    v_lshrrev_b32_e64 v30, 5, v0
    v_mul_u32_u24 v31, 224, v30
    v_lshl_add_u32 v29, v29, 1, v31
    v_mov_b32 v31, 2048
    v_cmp_lt_u32 vcc, 13, v28
    s_nop 1
    v_cndmask_b32_e64 v29, v29, v31, vcc
    v_add_u32 v251, 155648, v29
    s_xor_b32 s3, s62, 0
    s_mul_i32 s3, s3, 24576
    buffer_load_dwordx4 v4, s[8:11], s21 offen offset:2048 lds
    v_add_u32 v28, s3, v244
    v_accvgpr_write_b32 a224, v28
    s_xor_b32 s3, s62, 1
    s_mul_i32 s3, s3, 24576
    v_add_u32 v28, s3, v244
    v_accvgpr_write_b32 a225, v28
    s_xor_b32 s3, s62, 2
    s_mul_i32 s3, s3, 24576
    v_add_u32_e64 v28, s3, v244
    v_accvgpr_write_b32 a226, v28
    s_xor_b32 s3, s62, 3
    s_mul_i32 s3, s3, 24576
    buffer_load_dwordx4 v5, s[8:11], s21 offen offset:3072 lds
    v_add_u32 v28, s3, v244
    v_accvgpr_write_b32 a227, v28
    v_lshrrev_b32 v28, 5, v0
    v_lshlrev_b32 v28, 9, v28
    v_bfe_u32 v29, v0, 2, 2
    v_lshl_add_u32 v28, v29, 7, v28
    v_and_b32 v29, 1, v0
    v_lshl_add_u32 v28, v29, 3, v28
    v_bfe_u32 v29, v0, 1, 1
    v_lshl_add_u32 v28, v29, 4, v28
    v_bfe_u32 v29, v0, 4, 1
    v_lshrrev_b32 v30, 5, v0
    v_xor_b32 v29, v29, v30
    v_lshl_add_u32 v28, v29, 5, v28
    v_bfe_u32 v29, v0, 3, 1
    v_lshl_add_u32 v28, v29, 6, v28
    v_accvgpr_write_b32 a228, v28
    v_bfe_u32 v28, v0, 4, 1
    v_lshlrev_b32 v28, 11, v28
    v_and_b32 v29, 3, v0
    v_lshl_add_u32 v28, v29, 4, v28
    v_bfe_u32 v29, v0, 2, 2
    s_add_u32 m0, s78, 105600
    s_nop 0
    buffer_load_dwordx4 v6, s[12:15], s86 offen offset:896 lds
    v_lshl_add_u32 v28, v29, 7, v28
    v_lshrrev_b32 v29, 5, v0
    v_lshl_add_u32 v28, v29, 10, v28
    v_accvgpr_write_b32 a229, v28
    s_and_b32 s3, s62, 1
    s_mul_i32 s0, s3, 7168
    v_lshrrev_b32 v28, 2, v0
    v_lshlrev_b32 v28, 7, v28
    v_and_b32 v29, 1, v0
    v_lshl_add_u32 v28, v29, 3, v28
    v_bfe_u32 v29, v0, 1, 1
    v_lshl_add_u32 v28, v29, 4, v28
    v_bfe_u32 v29, v0, 3, 1
    v_lshlrev_b32 v29, 1, v29
    v_bfe_u32 v30, v0, 4, 1
    v_or_b32 v29, v29, v30
    s_add_u32 m0, s78, 133376
    s_nop 0
    buffer_load_dwordx4 v6, s[12:15], s86 offen offset:1792 lds
    v_lshl_add_u32 v28, v29, 5, v28
    v_accvgpr_write_b32 a230, v28
    v_and_b32 v28, 15, v0
    v_lshlrev_b32 v30, 6, v28
    v_lshrrev_b32 v29, 4, v0
    v_lshl_add_u32 v30, v29, 4, v30
    v_accvgpr_write_b32 a231, v30
    v_mul_u32_u24 v28, 896, v28
    v_lshl_add_u32 v28, v29, 3, v28
    s_mul_i32 s3, s68, 14336
    s_lshl_b32 s45, s66, 7
    s_add_u32 s3, s3, s45
    v_add_u32_e64 v28, s3, v28
    v_accvgpr_write_b32 a232, v28
    s_lshl_b32 s3, s68, 4
    v_and_b32_e64 v28, 15, v0
    s_add_u32 m0, s69, 8192
    s_nop 0
    buffer_load_dwordx4 v2, s[8:11], s22 offen offset:0 lds
    v_add_u32 v28, s3, v28
    v_lshrrev_b32 v29, 4, v0
    v_lshlrev_b32 v29, 8, v29
    v_cmp_lt_u32 vcc, 31, v0
    s_lshl1_add_u32 s3, s66, 0
    s_cmp_ge_u32 s3, 7
    s_cselect_b32 s45, 2, 1
    s_cselect_b32 s65, 7, 0
    s_sub_u32 s3, s3, s65
    s_sub_u32 s65, 0, s45
    s_cmp_ge_u32 s3, 4
    s_cselect_b32 s45, s65, s45
    v_add_u32 v30, s45, v28
    s_cmp_ge_u32 s3, 3
    s_cselect_b32 s45, s65, s45
    buffer_load_dwordx4 v3, s[8:11], s22 offen offset:1024 lds
    v_add_u32 v31, s45, v28
    v_cndmask_b32 v30, v30, v31, vcc
    v_sub_u32 v31, v30, v28
    v_and_b32 v31, 8, v31
    v_add_u32 v31, v31, v30
    v_and_b32 v31, 255, v31
    v_subrev_u32 v31, 8, v31
    v_and_b32 v254, 0x80000000, v31
    v_and_b32 v30, 2047, v30
    v_lshrrev_b32 v31, 4, v30
    v_mul_u32_u24 v31, 14336, v31
    v_and_b32 v30, 15, v30
    v_lshl_add_u32 v31, v30, 4, v31
    s_lshl_b32 s3, s66, 11
    s_add_u32 s3, s3, 6291456
    buffer_load_dwordx4 v4, s[8:11], s22 offen offset:2048 lds
    v_add3_u32 v31, v31, v29, s3
    v_or_b32 v31, v254, v31
    v_accvgpr_write_b32 a233, v31
    s_lshl1_add_u32 s3, s66, 1
    s_cmp_ge_u32 s3, 7
    s_cselect_b32 s45, 2, 1
    s_cselect_b32 s65, 7, 0
    s_sub_u32 s3, s3, s65
    s_sub_u32 s65, 0, s45
    s_cmp_ge_u32 s3, 4
    s_cselect_b32 s45, s65, s45
    v_add_u32 v30, s45, v28
    s_cmp_ge_u32 s3, 3
    s_cselect_b32 s45, s65, s45
    buffer_load_dwordx4 v5, s[8:11], s22 offen offset:3072 lds
    v_add_u32 v31, s45, v28
    v_cndmask_b32 v30, v30, v31, vcc
    v_sub_u32 v31, v30, v28
    v_and_b32 v31, 8, v31
    v_add_u32 v31, v31, v30
    v_and_b32 v31, 255, v31
    v_subrev_u32 v31, 8, v31
    v_and_b32 v254, 0x80000000, v31
    v_and_b32 v30, 2047, v30
    v_lshrrev_b32 v31, 4, v30
    v_mul_u32_u24 v31, 14336, v31
    v_and_b32_e64 v30, 15, v30
    v_lshl_add_u32 v31, v30, 4, v31
    s_lshl_b32 s3, s66, 11
    s_add_u32 s3, s3, 6292480
    v_add3_u32 v31, v31, v29, s3
    v_or_b32_e64 v31, v254, v31
    v_accvgpr_write_b32 a234, v31
    v_bfe_u32 v29, v0, 4, 1
    v_lshlrev_b32 v29, 2, v29
    s_add_u32 m0, s78, 155648
    s_nop 0
    buffer_load_dwordx4 v1, s[28:31], s101 offen lds
    v_bfe_u32 v30, v0, 5, 1
    v_lshl_or_b32 v29, v30, 1, v29
    v_and_b32_e64 v30, 7, v0
    v_xor_b32 v29, v29, v30
    v_lshlrev_b32 v29, 4, v29
    v_lshrrev_b32 v28, 3, v0
    v_mul_u32_u24 v28, 896, v28
    v_add_u32 v30, v28, v29
    v_accvgpr_write_b32 a235, v30
    v_lshl_add_u32 v30, v28, 2, v29
    v_accvgpr_write_b32 a236, v30
    v_bfe_u32 v28, v0, 1, 3
    v_lshlrev_b32 v28, 5, v28
    v_and_b32 v29, 1, v0
    v_lshl_add_u32 v28, v29, 4, v28
    v_add_u32 v28, s63, v28
    s_lshl_b32 s3, s60, 5
    v_add_u32 v29, s3, v0
    v_cmp_gt_u32 vcc, 32, v0
    s_nop 1
    v_cndmask_b32 v28, v28, v29, vcc
    v_lshlrev_b32_e64 v28, 4, v28
    v_add_u32 v28, 1572864, v28
    v_accvgpr_write_b32 a237, v28
    v_mov_b32 v240, 0
    v_mov_b32 v241, 0
    v_mov_b32 v242, 0
    v_mov_b32 v243, 0
    v_mov_b32 v253, 0
    v_mov_b32 v254, 0
    s_waitcnt vmcnt(15)
    s_barrier
    ds_read_b128 v[32:35], v8 offset:0
    ds_read_b128 v[36:39], v9 offset:0
    ds_read_b128 v[40:43], v10 offset:0
    ds_read_b128 v[44:47], v11 offset:0
    ds_read_b64_tr_b16 v[144:145], v12 offset:0
    ds_read_b64_tr_b16 v[146:147], v12 offset:256
    ds_read_b64_tr_b16 v[148:149], v12 offset:28672
    ds_read_b64_tr_b16 v[150:151], v12 offset:28928
    ds_read_b64_tr_b16 v[152:153], v13 offset:0
    ds_read_b64_tr_b16 v[154:155], v13 offset:256
    ds_read_b64_tr_b16 v[156:157], v13 offset:28672
    ds_read_b64_tr_b16 v[158:159], v13 offset:28928
    ds_read_b64_tr_b16 v[160:161], v14 offset:0
    ds_read_b64_tr_b16 v[162:163], v14 offset:256
    ds_read_b64_tr_b16 v[164:165], v14 offset:28672
    ds_read_b64_tr_b16 v[166:167], v14 offset:28928
    ds_read_b64_tr_b16 v[168:169], v15 offset:0
    ds_read_b64_tr_b16 v[170:171], v15 offset:256
    ds_read_b64_tr_b16 v[172:173], v15 offset:28672
    ds_read_b64_tr_b16 v[174:175], v15 offset:28928
    s_waitcnt lgkmcnt(15)
    v_dot2c_f32_bf16 v240, s80, v32
    s_add_u32 m0, s78, 109696
    s_nop 0
    buffer_load_dwordx4 v6, s[12:15], s87 offen offset:896 lds
    v_dot2c_f32_bf16 v242, v32, v32
    v_dot2c_f32_bf16 v241, s80, v33
    v_dot2c_f32_bf16 v243, v33, v33
    v_dot2c_f32_bf16 v240, s80, v34
    v_dot2c_f32_bf16 v242, v34, v34
    v_dot2c_f32_bf16 v241, s80, v35
    v_dot2c_f32_bf16 v243, v35, v35
    v_dot2c_f32_bf16 v240, s80, v36
    v_dot2c_f32_bf16 v242, v36, v36
    v_dot2c_f32_bf16 v241, s80, v37
    v_dot2c_f32_bf16 v243, v37, v37
    v_dot2c_f32_bf16 v240, s80, v38
    v_dot2c_f32_bf16 v242, v38, v38
    v_dot2c_f32_bf16 v241, s80, v39
    v_dot2c_f32_bf16 v243, v39, v39
    v_dot2c_f32_bf16 v240, s80, v40
    s_add_u32 m0, s78, 137472
    s_nop 0
    buffer_load_dwordx4 v6, s[12:15], s87 offen offset:1792 lds
    v_dot2c_f32_bf16 v242, v40, v40
    v_dot2c_f32_bf16 v241, s80, v41
    v_dot2c_f32_bf16 v243, v41, v41
    v_dot2c_f32_bf16 v240, s80, v42
    v_dot2c_f32_bf16 v242, v42, v42
    v_dot2c_f32_bf16 v241, s80, v43
    v_dot2c_f32_bf16 v243, v43, v43
    v_dot2c_f32_bf16 v240, s80, v44
    v_dot2c_f32_bf16 v242, v44, v44
    v_dot2c_f32_bf16 v241, s80, v45
    v_dot2c_f32_bf16 v243, v45, v45
    v_dot2c_f32_bf16 v240, s80, v46
    v_dot2c_f32_bf16 v242, v46, v46
    v_dot2c_f32_bf16 v241, s80, v47
    v_dot2c_f32_bf16 v243, v47, v47
    s_waitcnt lgkmcnt(4)
    v_dot2c_f32_bf16 v253, s80, v144
    s_add_u32 m0, s69, 12288
    s_nop 0
    buffer_load_dwordx4 v2, s[8:11], s79 offen offset:0 lds
    v_dot2c_f32_bf16 v254, s80, v148
    v_dot2c_f32_bf16 v253, s80, v145
    v_dot2c_f32_bf16 v254, s80, v149
    v_dot2c_f32_bf16 v253, s80, v146
    v_dot2c_f32_bf16 v254, s80, v150
    v_dot2c_f32_bf16 v253, s80, v147
    v_dot2c_f32_bf16 v254, s80, v151
    v_mfma_f32_32x32x16_bf16 v[208:223], v[144:147], v[32:35], 0
    buffer_load_dwordx4 v3, s[8:11], s79 offen offset:1024 lds
    s_mul_i32 s3, s62, 14336
    s_lshl_b32 s45, s66, 7
    s_add_u32 s3, s3, s45
    s_mov_b32 s45, s66
    v_mfma_f32_32x32x16_bf16 v[224:239], v[148:151], v[32:35], 0
    s_mul_i32 s65, s45, 57344
    s_add_u32 s36, s65, s3
    s_lshl_b32 s65, s45, 11
    s_add_u32 s70, s65, s77
    s_add_u32 s45, s45, 1
    s_cmp_eq_u32 s45, 7
    s_cselect_b32 s45, 0, s45
    v_mfma_f32_32x32x16_bf16 v[208:223], v[152:155], v[36:39], v[208:223]
    s_mul_i32 s65, s45, 57344
    s_add_u32 s37, s65, s3
    s_lshl_b32 s65, s45, 11
    s_add_u32 s71, s65, s77
    s_add_u32 s45, s45, 1
    s_cmp_eq_u32 s45, 7
    s_cselect_b32 s45, 0, s45
    v_mfma_f32_32x32x16_bf16 v[224:239], v[156:159], v[36:39], v[224:239]
    s_mul_i32 s65, s45, 57344
    buffer_load_dwordx4 v4, s[8:11], s79 offen offset:2048 lds
    buffer_load_dwordx4 v5, s[8:11], s79 offen offset:3072 lds
    s_waitcnt vmcnt(13)
    v_mfma_f32_32x32x16_bf16 v[208:223], v[160:163], v[40:43], v[208:223]
    s_barrier
    ds_read_b128 v[48:51], v8 offset:4096
    ds_read_b128 v[52:55], v9 offset:4096
    ds_read_b128 v[56:59], v10 offset:4096
    ds_read_b128 v[60:63], v11 offset:4096
    v_mfma_f32_32x32x16_bf16 v[224:239], v[164:167], v[40:43], v[224:239]
    s_waitcnt lgkmcnt(4)
    ds_read_b64_tr_b16 v[176:177], v12 offset:4096
    ds_read_b64_tr_b16 v[178:179], v12 offset:4352
    ds_read_b64_tr_b16 v[180:181], v12 offset:32768
    ds_read_b64_tr_b16 v[182:183], v12 offset:33024
    ds_read_b64_tr_b16 v[184:185], v13 offset:4096
    ds_read_b64_tr_b16 v[186:187], v13 offset:4352
    v_mfma_f32_32x32x16_bf16 v[208:223], v[168:171], v[44:47], v[208:223]
    s_nop 0
    ds_read_b64_tr_b16 v[188:189], v13 offset:32768
    ds_read_b64_tr_b16 v[190:191], v13 offset:33024
    ds_read_b64_tr_b16 v[192:193], v14 offset:4096
    ds_read_b64_tr_b16 v[194:195], v14 offset:4352
    ds_read_b64_tr_b16 v[196:197], v14 offset:32768
    v_mfma_f32_32x32x16_bf16 v[224:239], v[172:175], v[44:47], v[224:239]
    s_waitcnt lgkmcnt(11)
    s_add_u32 m0, s78, 113792
    s_nop 0
    buffer_load_dwordx4 v6, s[12:15], s88 offen offset:896 lds
    ds_read_b64_tr_b16 v[198:199], v14 offset:33024
    ds_read_b64_tr_b16 v[200:201], v15 offset:4096
    ds_read_b64_tr_b16 v[202:203], v15 offset:4352
    v_dot2c_f32_bf16 v240, s80, v48
    v_dot2c_f32_bf16 v242, v48, v48
    v_dot2c_f32_bf16 v241, s80, v49
    v_dot2c_f32_bf16 v243, v49, v49
    v_dot2c_f32_bf16 v240, s80, v50
    v_dot2c_f32_bf16 v242, v50, v50
    v_dot2c_f32_bf16 v241, s80, v51
    v_dot2c_f32_bf16 v243, v51, v51
    s_nop 0
    ds_read_b64_tr_b16 v[204:205], v15 offset:32768
    ds_read_b64_tr_b16 v[206:207], v15 offset:33024
    v_dot2c_f32_bf16 v240, s80, v52
    v_dot2c_f32_bf16 v242, v52, v52
    v_dot2c_f32_bf16 v241, s80, v53
    v_dot2c_f32_bf16 v243, v53, v53
    s_add_u32 m0, s78, 141568
    s_nop 0
    buffer_load_dwordx4 v6, s[12:15], s88 offen offset:1792 lds
    v_dot2c_f32_bf16 v240, s80, v54
    v_dot2c_f32_bf16 v242, v54, v54
    v_dot2c_f32_bf16 v241, s80, v55
    v_dot2c_f32_bf16 v243, v55, v55
    v_dot2c_f32_bf16 v240, s80, v56
    v_dot2c_f32_bf16 v242, v56, v56
    v_dot2c_f32_bf16 v241, s80, v57
    v_dot2c_f32_bf16 v243, v57, v57
    v_dot2c_f32_bf16 v240, s80, v58
    v_dot2c_f32_bf16 v242, v58, v58
    v_dot2c_f32_bf16 v241, s80, v59
    v_dot2c_f32_bf16 v243, v59, v59
    v_dot2c_f32_bf16 v240, s80, v60
    v_dot2c_f32_bf16 v242, v60, v60
    v_dot2c_f32_bf16 v241, s80, v61
    v_dot2c_f32_bf16 v243, v61, v61
    s_add_u32 m0, s69, 16384
    s_nop 0
    buffer_load_dwordx4 v2, s[8:11], s82 offen offset:0 lds
    v_dot2c_f32_bf16 v240, s80, v62
    v_dot2c_f32_bf16 v242, v62, v62
    v_dot2c_f32_bf16 v241, s80, v63
    v_dot2c_f32_bf16 v243, v63, v63
    s_waitcnt lgkmcnt(5)
    v_dot2c_f32_bf16 v253, s80, v176
    v_dot2c_f32_bf16 v254, s80, v180
    v_dot2c_f32_bf16 v253, s80, v177
    v_dot2c_f32_bf16 v254, s80, v181
    v_dot2c_f32_bf16 v253, s80, v178
    v_dot2c_f32_bf16 v254, s80, v182
    v_dot2c_f32_bf16 v253, s80, v179
    v_dot2c_f32_bf16 v254, s80, v183
    v_mfma_f32_32x32x16_bf16 v[208:223], v[176:179], v[48:51], v[208:223]
    s_nop 0
    buffer_load_dwordx4 v3, s[8:11], s82 offen offset:1024 lds
    s_add_u32 s38, s65, s3
    s_lshl_b32 s65, s45, 11
    s_add_u32 s72, s65, s77
    s_add_u32 s45, s45, 1
    s_cmp_eq_u32 s45, 7
    s_cselect_b32 s45, 0, s45
    v_mfma_f32_32x32x16_bf16 v[224:239], v[180:183], v[48:51], v[224:239]
    s_mul_i32 s65, s45, 57344
    s_add_u32 s39, s65, s3
    s_lshl_b32 s65, s45, 11
    s_add_u32 s73, s65, s77
    s_add_u32 s45, s45, 1
    s_cmp_eq_u32 s45, 7
    s_cselect_b32 s45, 0, s45
    v_mfma_f32_32x32x16_bf16 v[208:223], v[184:187], v[52:55], v[208:223]
    s_nop 0
    buffer_load_dwordx4 v4, s[8:11], s82 offen offset:2048 lds
    s_mul_i32 s65, s45, 57344
    s_add_u32 s40, s65, s3
    s_lshl_b32 s65, s45, 11
    s_add_u32 s74, s65, s77
    s_add_u32 s45, s45, 1
    v_mfma_f32_32x32x16_bf16 v[224:239], v[188:191], v[52:55], v[224:239]
    buffer_load_dwordx4 v5, s[8:11], s82 offen offset:3072 lds
    s_waitcnt vmcnt(12)
    s_barrier
    ds_read_b128 v[64:67], v8 offset:8192
    ds_read_b128 v[68:71], v9 offset:8192
    ds_read_b128 v[72:75], v10 offset:8192
    s_waitcnt lgkmcnt(3)
    v_mfma_f32_32x32x16_bf16 v[208:223], v[192:195], v[56:59], v[208:223]
    s_nop 0
    ds_read_b128 v[76:79], v11 offset:8192
    ds_read_b64_tr_b16 v[144:145], v12 offset:8192
    ds_read_b64_tr_b16 v[146:147], v12 offset:8448
    ds_read_b64_tr_b16 v[148:149], v12 offset:36864
    ds_read_b64_tr_b16 v[150:151], v12 offset:37120
    ds_read_b64_tr_b16 v[152:153], v13 offset:8192
    v_mfma_f32_32x32x16_bf16 v[224:239], v[196:199], v[56:59], v[224:239]
    ds_read_b64_tr_b16 v[154:155], v13 offset:8448
    ds_read_b64_tr_b16 v[156:157], v13 offset:36864
    ds_read_b64_tr_b16 v[158:159], v13 offset:37120
    ds_read_b64_tr_b16 v[160:161], v14 offset:8192
    v_mfma_f32_32x32x16_bf16 v[208:223], v[200:203], v[60:63], v[208:223]
L_pg1:
    s_cbranch_execz L_pg5
    ds_read_b64_tr_b16 v[162:163], v14 offset:8448
    ds_read_b64_tr_b16 v[164:165], v14 offset:36864
    ds_read_b64_tr_b16 v[166:167], v14 offset:37120
    s_nop 0
    v_mfma_f32_32x32x16_bf16 v[224:239], v[204:207], v[60:63], v[224:239]
    s_waitcnt lgkmcnt(12)
    s_add_u32 m0, s78, 117888
    s_nop 0
    buffer_load_dwordx4 v6, s[12:15], s89 offen offset:896 lds
    ds_read_b64_tr_b16 v[168:169], v15 offset:8192
    ds_read_b64_tr_b16 v[170:171], v15 offset:8448
    ds_read_b64_tr_b16 v[172:173], v15 offset:36864
    v_dot2c_f32_bf16 v240, s80, v64
    v_dot2c_f32_bf16 v242, v64, v64
    v_dot2c_f32_bf16 v241, s80, v65
    v_dot2c_f32_bf16 v243, v65, v65
    v_dot2c_f32_bf16 v240, s80, v66
    v_dot2c_f32_bf16 v242, v66, v66
    v_dot2c_f32_bf16 v241, s80, v67
    v_dot2c_f32_bf16 v243, v67, v67
    ds_read_b64_tr_b16 v[174:175], v15 offset:37120
    v_dot2c_f32_bf16 v240, s80, v68
    v_dot2c_f32_bf16 v242, v68, v68
    v_dot2c_f32_bf16 v241, s80, v69
    v_dot2c_f32_bf16 v243, v69, v69
    v_dot2c_f32_bf16 v240, s80, v70
    s_add_u32 m0, s78, 145664
    s_nop 0
    buffer_load_dwordx4 v6, s[12:15], s89 offen offset:1792 lds
    v_dot2c_f32_bf16 v242, v70, v70
    v_dot2c_f32_bf16 v241, s80, v71
    v_dot2c_f32_bf16 v243, v71, v71
    v_dot2c_f32_bf16 v240, s80, v72
    v_dot2c_f32_bf16 v242, v72, v72
    v_dot2c_f32_bf16 v241, s80, v73
    v_dot2c_f32_bf16 v243, v73, v73
    v_dot2c_f32_bf16 v240, s80, v74
    v_dot2c_f32_bf16 v242, v74, v74
    v_dot2c_f32_bf16 v241, s80, v75
    v_dot2c_f32_bf16 v243, v75, v75
    v_dot2c_f32_bf16 v240, s80, v76
    v_dot2c_f32_bf16 v242, v76, v76
    v_dot2c_f32_bf16 v241, s80, v77
    v_dot2c_f32_bf16 v243, v77, v77
    v_dot2c_f32_bf16 v240, s80, v78
    s_add_u32 m0, s78, 121984
    s_nop 0
    buffer_load_dwordx4 v6, s[12:15], s90 offen offset:896 lds
    v_dot2c_f32_bf16 v242, v78, v78
    v_dot2c_f32_bf16 v241, s80, v79
    v_dot2c_f32_bf16 v243, v79, v79
    s_waitcnt lgkmcnt(4)
    v_dot2c_f32_bf16 v253, s80, v144
    v_dot2c_f32_bf16 v254, s80, v148
    v_dot2c_f32_bf16 v253, s80, v145
    v_dot2c_f32_bf16 v254, s80, v149
    v_dot2c_f32_bf16 v253, s80, v146
    v_dot2c_f32_bf16 v254, s80, v150
    v_dot2c_f32_bf16 v253, s80, v147
    v_dot2c_f32_bf16 v254, s80, v151
    v_mfma_f32_32x32x16_bf16 v[208:223], v[144:147], v[64:67], v[208:223]
    s_add_u32 m0, s78, 149760
    s_nop 0
    buffer_load_dwordx4 v6, s[12:15], s90 offen offset:1792 lds
    s_cmp_eq_u32 s45, 7
    s_cselect_b32 s45, 0, s45
    s_mul_i32 s65, s45, 57344
    v_mfma_f32_32x32x16_bf16 v[224:239], v[148:151], v[64:67], v[224:239]
    s_add_u32 s41, s65, s3
    s_lshl_b32 s65, s45, 11
    s_add_u32 s75, s65, s77
    s_add_u32 s45, s45, 1
    s_cmp_eq_u32 s45, 7
    s_cselect_b32 s45, 0, s45
    s_mul_i32 s65, s45, 57344
    v_mfma_f32_32x32x16_bf16 v[208:223], v[152:155], v[68:71], v[208:223]
    s_add_u32 s44, s65, s3
    s_add_u32 m0, s69, 20480
    s_nop 0
    buffer_load_dwordx4 v2, s[8:11], s35 offen offset:0 lds
    s_lshl_b32 s65, s45, 11
    s_add_u32 s76, s65, s77
    v_mfma_f32_32x32x16_bf16 v[224:239], v[156:159], v[68:71], v[224:239]
    s_lshl2_add_u32 s32, s66, s62
    s_lshl_b32 s32, s32, 7
    buffer_load_dwordx4 v3, s[8:11], s35 offen offset:1024 lds
    s_waitcnt vmcnt(12)
    v_mfma_f32_32x32x16_bf16 v[208:223], v[160:163], v[72:75], v[208:223]
    s_barrier
    ds_read_b128 v[80:83], v8 offset:12288
    ds_read_b128 v[84:87], v9 offset:12288
    ds_read_b128 v[88:91], v10 offset:12288
    v_mfma_f32_32x32x16_bf16 v[224:239], v[164:167], v[72:75], v[224:239]
    s_nop 0
    ds_read_b128 v[92:95], v11 offset:12288
    s_waitcnt lgkmcnt(4)
    ds_read_b64_tr_b16 v[176:177], v12 offset:12288
    ds_read_b64_tr_b16 v[178:179], v12 offset:12544
    ds_read_b64_tr_b16 v[180:181], v12 offset:40960
    ds_read_b64_tr_b16 v[182:183], v12 offset:41216
    v_mfma_f32_32x32x16_bf16 v[208:223], v[168:171], v[76:79], v[208:223]
    ds_read_b64_tr_b16 v[184:185], v13 offset:12288
    buffer_load_dwordx4 v4, s[8:11], s35 offen offset:2048 lds
    ds_read_b64_tr_b16 v[186:187], v13 offset:12544
    ds_read_b64_tr_b16 v[188:189], v13 offset:40960
    ds_read_b64_tr_b16 v[190:191], v13 offset:41216
    v_mfma_f32_32x32x16_bf16 v[224:239], v[172:175], v[76:79], v[224:239]
    ds_read_b64_tr_b16 v[192:193], v14 offset:12288
    ds_read_b64_tr_b16 v[194:195], v14 offset:12544
    ds_read_b64_tr_b16 v[196:197], v14 offset:40960
    s_waitcnt lgkmcnt(11)
    ds_read_b64_tr_b16 v[198:199], v14 offset:41216
    ds_read_b64_tr_b16 v[200:201], v15 offset:12288
    ds_read_b64_tr_b16 v[202:203], v15 offset:12544
    buffer_load_dwordx4 v5, s[8:11], s35 offen offset:3072 lds
    v_dot2c_f32_bf16 v240, s80, v80
    v_dot2c_f32_bf16 v242, v80, v80
    v_dot2c_f32_bf16 v241, s80, v81
    v_dot2c_f32_bf16 v243, v81, v81
    v_dot2c_f32_bf16 v240, s80, v82
    v_dot2c_f32_bf16 v242, v82, v82
    v_dot2c_f32_bf16 v241, s80, v83
    v_dot2c_f32_bf16 v243, v83, v83
    v_dot2c_f32_bf16 v240, s80, v84
    v_dot2c_f32_bf16 v242, v84, v84
    s_nop 0
    ds_read_b64_tr_b16 v[204:205], v15 offset:40960
    ds_read_b64_tr_b16 v[206:207], v15 offset:41216
    ds_read_u16 v128, v251 offset:0
    ds_read_u16 v129, v251 offset:56
    ds_read_u16 v130, v251 offset:112
    v_dot2c_f32_bf16 v241, s80, v85
    v_dot2c_f32_bf16 v243, v85, v85
    v_dot2c_f32_bf16 v240, s80, v86
    v_dot2c_f32_bf16 v242, v86, v86
    v_dot2c_f32_bf16 v241, s80, v87
    v_dot2c_f32_bf16 v243, v87, v87
    v_dot2c_f32_bf16 v240, s80, v88
    v_dot2c_f32_bf16 v242, v88, v88
    s_add_u32 m0, s69, 0
    s_nop 0
    buffer_load_dwordx4 v2, s[8:11], s95 offen offset:0 lds
    ds_read_u16 v131, v251 offset:168
    ds_read_u16 v132, v251 offset:448
    ds_read_u16 v133, v251 offset:504
    ds_read_u16 v134, v251 offset:560
    v_dot2c_f32_bf16 v241, s80, v89
    v_dot2c_f32_bf16 v243, v89, v89
    v_dot2c_f32_bf16 v240, s80, v90
    v_dot2c_f32_bf16 v242, v90, v90
    v_dot2c_f32_bf16 v241, s80, v91
    v_dot2c_f32_bf16 v243, v91, v91
    v_dot2c_f32_bf16 v240, s80, v92
    v_dot2c_f32_bf16 v242, v92, v92
    v_dot2c_f32_bf16 v241, s80, v93
    v_dot2c_f32_bf16 v243, v93, v93
    ds_read_u16 v135, v251 offset:616
    buffer_load_dwordx4 v3, s[8:11], s95 offen offset:1024 lds
    ds_read_u16 v136, v251 offset:896
    ds_read_u16 v137, v251 offset:952
    ds_read_u16 v138, v251 offset:1008
    v_dot2c_f32_bf16 v240, s80, v94
    v_dot2c_f32_bf16 v242, v94, v94
    v_dot2c_f32_bf16 v241, s80, v95
    v_dot2c_f32_bf16 v243, v95, v95
    s_waitcnt lgkmcnt(14)
    v_dot2c_f32_bf16 v253, s80, v176
    v_dot2c_f32_bf16 v254, s80, v180
    v_dot2c_f32_bf16 v253, s80, v177
    v_dot2c_f32_bf16 v254, s80, v181
    v_dot2c_f32_bf16 v253, s80, v178
    v_dot2c_f32_bf16 v254, s80, v182
    v_dot2c_f32_bf16 v253, s80, v179
    v_dot2c_f32_bf16 v254, s80, v183
    v_mfma_f32_32x32x16_bf16 v[208:223], v[176:179], v[80:83], v[208:223]
    buffer_load_dwordx4 v4, s[8:11], s95 offen offset:2048 lds
    ds_read_u16 v139, v251 offset:1064
    ds_read_u16 v140, v251 offset:1344
    ds_read_u16 v141, v251 offset:1400
    ds_read_u16 v142, v251 offset:1456
    v_mfma_f32_32x32x16_bf16 v[224:239], v[180:183], v[80:83], v[224:239]
    ds_read_u16 v143, v251 offset:1512
    s_lshl_b32 s101, s62, 28
    s_lshl_b32 s3, s60, 9
    v_accvgpr_write_b32 a245, s34
    v_mfma_f32_32x32x16_bf16 v[208:223], v[184:187], v[84:87], v[208:223]
    buffer_load_dwordx4 v5, s[8:11], s95 offen offset:3072 lds
    s_add_u32 s101, s101, s3
    s_lshl_b32 s3, s61, 4
    v_accvgpr_write_b32 a247, s34
    v_mfma_f32_32x32x16_bf16 v[224:239], v[188:191], v[84:87], v[224:239]
    s_add_u32 s101, s101, s3
    s_add_u32 s101, s101, 1572864
    s_mov_b64 s[28:29], s[50:51]
    s_mov_b32 s30, 1605632
    buffer_store_dwordx4 a[252:255], v1, s[16:19], s92 offen sc1
    buffer_store_dword a252, v250, s[16:19], s100 offen sc1
    s_mov_b32 s24, s56
    s_mov_b32 s25, s57
    s_mov_b32 s26, 256
    buffer_load_dword v244, off, s[24:27], 0 sc1
    s_waitcnt vmcnt(15)
    v_mfma_f32_32x32x16_bf16 v[208:223], v[192:195], v[88:91], v[208:223]
    s_barrier
    ds_read_b128 v[96:99], v8 offset:16384
    ds_read_b128 v[100:103], v9 offset:16384
    ds_read_b128 v[104:107], v10 offset:16384
    ds_read_b128 v[108:111], v11 offset:16384
    v_mfma_f32_32x32x16_bf16 v[224:239], v[196:199], v[88:91], v[224:239]
    s_waitcnt lgkmcnt(14)
    ds_read_b64_tr_b16 v[144:145], v12 offset:16384
    ds_read_b64_tr_b16 v[146:147], v12 offset:16640
    ds_read_b64_tr_b16 v[148:149], v12 offset:45056
    ds_read_b64_tr_b16 v[150:151], v12 offset:45312
    ds_read_b64_tr_b16 v[152:153], v13 offset:16384
    ds_read_b64_tr_b16 v[154:155], v13 offset:16640
    v_mfma_f32_32x32x16_bf16 v[208:223], v[200:203], v[92:95], v[208:223]
    ds_read_b64_tr_b16 v[156:157], v13 offset:45056
    ds_read_b64_tr_b16 v[158:159], v13 offset:45312
    ds_read_b64_tr_b16 v[160:161], v14 offset:16384
    v_mfma_f32_32x32x16_bf16 v[224:239], v[204:207], v[92:95], v[224:239]
    s_waitcnt lgkmcnt(9)
    ds_read_b64_tr_b16 v[162:163], v14 offset:16640
    ds_read_b64_tr_b16 v[164:165], v14 offset:45056
    s_add_u32 m0, s69, 4096
    s_nop 0
    buffer_load_dwordx4 v6, s[12:15], s84 offen offset:0 lds
    ds_read_b64_tr_b16 v[166:167], v14 offset:45312
    v_dot2c_f32_bf16 v240, s80, v96
    v_dot2c_f32_bf16 v242, v96, v96
    v_dot2c_f32_bf16 v241, s80, v97
    v_dot2c_f32_bf16 v243, v97, v97
    v_dot2c_f32_bf16 v240, s80, v98
    v_dot2c_f32_bf16 v242, v98, v98
    v_dot2c_f32_bf16 v241, s80, v99
    v_dot2c_f32_bf16 v243, v99, v99
    v_dot2c_f32_bf16 v240, s80, v100
    v_dot2c_f32_bf16 v242, v100, v100
    ds_read_b64_tr_b16 v[168:169], v15 offset:16384
    ds_read_b64_tr_b16 v[170:171], v15 offset:16640
    ds_read_b64_tr_b16 v[172:173], v15 offset:45056
    ds_read_b64_tr_b16 v[174:175], v15 offset:45312
    v_dot2c_f32_bf16 v241, s80, v101
    v_dot2c_f32_bf16 v243, v101, v101
    v_dot2c_f32_bf16 v240, s80, v102
    v_dot2c_f32_bf16 v242, v102, v102
    v_dot2c_f32_bf16 v241, s80, v103
    v_dot2c_f32_bf16 v243, v103, v103
    s_add_u32 m0, s69, 5120
    s_nop 0
    buffer_load_dwordx4 v6, s[12:15], s85 offen offset:0 lds
    v_dot2c_f32_bf16 v240, s80, v104
    v_dot2c_f32_bf16 v242, v104, v104
    v_dot2c_f32_bf16 v241, s80, v105
    v_dot2c_f32_bf16 v243, v105, v105
    v_dot2c_f32_bf16 v240, s80, v106
    v_dot2c_f32_bf16 v242, v106, v106
    v_dot2c_f32_bf16 v241, s80, v107
    v_dot2c_f32_bf16 v243, v107, v107
    v_dot2c_f32_bf16 v240, s80, v108
    v_dot2c_f32_bf16 v242, v108, v108
    v_dot2c_f32_bf16 v241, s80, v109
    v_dot2c_f32_bf16 v243, v109, v109
    v_dot2c_f32_bf16 v240, s80, v110
    v_dot2c_f32_bf16 v242, v110, v110
    v_dot2c_f32_bf16 v241, s80, v111
    v_dot2c_f32_bf16 v243, v111, v111
    s_add_u32 m0, s69, 6144
    s_nop 0
    buffer_load_dwordx4 v6, s[12:15], s86 offen offset:0 lds
    s_waitcnt lgkmcnt(7)
    v_dot2c_f32_bf16 v253, s80, v144
    v_dot2c_f32_bf16 v254, s80, v148
    v_dot2c_f32_bf16 v253, s80, v145
    v_dot2c_f32_bf16 v254, s80, v149
    v_dot2c_f32_bf16 v253, s80, v146
    v_dot2c_f32_bf16 v254, s80, v150
    v_dot2c_f32_bf16 v253, s80, v147
    v_dot2c_f32_bf16 v254, s80, v151
    v_mfma_f32_32x32x16_bf16 v[208:223], v[144:147], v[96:99], v[208:223]
    s_add_u32 m0, s69, 7168
    s_nop 0
    buffer_load_dwordx4 v6, s[12:15], s87 offen offset:0 lds
    v_lshl_or_b32 v16, v129, 16, v128
    v_lshl_or_b32 v17, v131, 16, v130
    v_lshl_or_b32 v18, v133, 16, v132
    v_lshl_or_b32 v19, v135, 16, v134
    v_mfma_f32_32x32x16_bf16 v[224:239], v[148:151], v[96:99], v[224:239]
    v_lshl_or_b32 v20, v137, 16, v136
    v_lshl_or_b32 v21, v139, 16, v138
    v_lshl_or_b32 v22, v141, 16, v140
    v_lshl_or_b32 v23, v143, 16, v142
    s_add_u32 m0, s69, 8192
    v_mfma_f32_32x32x16_bf16 v[208:223], v[152:155], v[100:103], v[208:223]
    buffer_load_dwordx4 v6, s[12:15], s88 offen offset:0 lds
    s_add_u32 m0, s69, 9216
    s_nop 0
    buffer_load_dwordx4 v6, s[12:15], s89 offen offset:0 lds
    v_mfma_f32_32x32x16_bf16 v[224:239], v[156:159], v[100:103], v[224:239]
    s_waitcnt vmcnt(13)
    s_barrier
    ds_read_b128 v[112:115], v8 offset:20480
    ds_read_b128 v[116:119], v9 offset:20480
    s_waitcnt lgkmcnt(2)
    ds_read_b128 v[120:123], v10 offset:20480
    v_mfma_f32_32x32x16_bf16 v[208:223], v[160:163], v[104:107], v[208:223]
    ds_read_b128 v[124:127], v11 offset:20480
    ds_read_b64_tr_b16 v[176:177], v12 offset:20480
    ds_read_b64_tr_b16 v[178:179], v12 offset:20736
    ds_read_b64_tr_b16 v[180:181], v12 offset:49152
    ds_read_b64_tr_b16 v[182:183], v12 offset:49408
    ds_read_b64_tr_b16 v[184:185], v13 offset:20480
    v_mfma_f32_32x32x16_bf16 v[224:239], v[164:167], v[104:107], v[224:239]
    s_nop 0
    ds_read_b64_tr_b16 v[186:187], v13 offset:20736
    ds_read_b64_tr_b16 v[188:189], v13 offset:49152
    ds_read_b64_tr_b16 v[190:191], v13 offset:49408
    v_mfma_f32_32x32x16_bf16 v[208:223], v[168:171], v[108:111], v[208:223]
    s_add_u32 m0, s69, 10240
    s_nop 0
    buffer_load_dwordx4 v6, s[12:15], s90 offen offset:0 lds
    ds_read_b64_tr_b16 v[192:193], v14 offset:20480
    ds_read_b64_tr_b16 v[194:195], v14 offset:20736
    ds_read_b64_tr_b16 v[196:197], v14 offset:49152
    v_mfma_f32_32x32x16_bf16 v[224:239], v[172:175], v[108:111], v[224:239]
    ds_read_b64_tr_b16 v[198:199], v14 offset:49408
    s_waitcnt lgkmcnt(12)
    ds_read_b64_tr_b16 v[200:201], v15 offset:20480
    ds_read_b64_tr_b16 v[202:203], v15 offset:20736
    ds_read_b64_tr_b16 v[204:205], v15 offset:49152
    v_dot2c_f32_bf16 v240, s80, v112
    v_dot2c_f32_bf16 v242, v112, v112
    v_dot2c_f32_bf16 v241, s80, v113
    v_dot2c_f32_bf16 v243, v113, v113
    v_dot2c_f32_bf16 v240, s80, v114
    v_dot2c_f32_bf16 v242, v114, v114
    v_dot2c_f32_bf16 v241, s80, v115
    v_dot2c_f32_bf16 v243, v115, v115
    s_lshl3_add_u32 s83, s91, s60
    s_mul_i32 s83, s83, 512
    s_add_u32 s26, s83, 512
    s_min_u32 s26, s26, 401408
    s_mov_b32 s24, s46
    v_dot2c_f32_bf16 v240, s80, v116
    v_dot2c_f32_bf16 v242, v116, v116
    s_mov_b32 s25, s47
    buffer_load_dword a251, v252, s[24:27], s83 offen
    ds_read_b64_tr_b16 v[206:207], v15 offset:49408
    ds_read_b64_tr_b16 v[128:129], v12 offset:24576
    ds_read_b64_tr_b16 v[130:131], v12 offset:24832
    ds_read_b64_tr_b16 v[132:133], v12 offset:53248
    ds_read_b64_tr_b16 v[134:135], v12 offset:53504
    v_dot2c_f32_bf16 v241, s80, v117
    v_dot2c_f32_bf16 v243, v117, v117
    v_dot2c_f32_bf16 v240, s80, v118
    v_dot2c_f32_bf16 v242, v118, v118
    v_dot2c_f32_bf16 v241, s80, v119
    v_dot2c_f32_bf16 v243, v119, v119
    v_dot2c_f32_bf16 v240, s80, v120
    v_dot2c_f32_bf16 v242, v120, v120
    v_dot2c_f32_bf16 v241, s80, v121
    s_lshl3_add_u32 s83, s91, s60
    s_mul_i32 s83, s83, 512
    s_add_u32 s26, s83, 512
    s_min_u32 s26, s26, 401408
    s_mov_b32 s24, s48
    s_mov_b32 s25, s49
    buffer_load_dword a251, v252, s[24:27], s83 offen
    v_dot2c_f32_bf16 v243, v121, v121
    v_dot2c_f32_bf16 v240, s80, v122
    v_dot2c_f32_bf16 v242, v122, v122
    v_dot2c_f32_bf16 v241, s80, v123
    v_dot2c_f32_bf16 v243, v123, v123
    v_dot2c_f32_bf16 v240, s80, v124
    v_dot2c_f32_bf16 v242, v124, v124
    v_dot2c_f32_bf16 v241, s80, v125
    v_dot2c_f32_bf16 v243, v125, v125
    v_dot2c_f32_bf16 v240, s80, v126
    v_dot2c_f32_bf16 v242, v126, v126
    v_dot2c_f32_bf16 v241, s80, v127
    v_dot2c_f32_bf16 v243, v127, v127
    s_waitcnt lgkmcnt(6)
    v_dot2c_f32_bf16 v253, s80, v176
    v_dot2c_f32_bf16 v254, s80, v180
    s_lshl3_add_u32 s83, s91, s60
    s_mul_i32 s83, s83, 640
    s_add_u32 s83, s83, 344064
    s_nop 0
    s_add_u32 s26, s83, 640
    s_min_u32 s26, s26, 917504
    s_mov_b32 s24, s50
    s_mov_b32 s25, s51
    buffer_load_dword a251, v252, s[24:27], s83 offen
    v_dot2c_f32_bf16 v253, s80, v177
    v_dot2c_f32_bf16 v254, s80, v181
    v_dot2c_f32_bf16 v253, s80, v178
    v_dot2c_f32_bf16 v254, s80, v182
    v_dot2c_f32_bf16 v253, s80, v179
    v_dot2c_f32_bf16 v254, s80, v183
    s_waitcnt lgkmcnt(0)
    v_dot2c_f32_bf16 v253, s80, v128
    v_dot2c_f32_bf16 v254, s80, v132
    v_dot2c_f32_bf16 v253, s80, v129
    v_dot2c_f32_bf16 v254, s80, v133
    v_dot2c_f32_bf16 v253, s80, v130
    v_dot2c_f32_bf16 v254, s80, v134
    v_dot2c_f32_bf16 v253, s80, v131
    v_dot2c_f32_bf16 v254, s80, v135
    s_lshl_b32 s4, s62, 2
    s_mul_i32 s83, s1, 5120
    s_add_u32 s26, s83, 5120
    s_min_u32 s26, s26, 401408
    s_mov_b32 s24, s42
    s_mov_b32 s25, s43
    buffer_load_dword a251, v252, s[24:27], s83 offen
    v_add_u32_e64 v31, s4, v245
    v_permlane32_swap_b32 v253, v254
    v_add_f32_e64 v253, v253, v254
    v_mfma_f32_32x32x16_bf16 v[208:223], v[176:179], v[112:115], v[208:223]
    s_nop 0
    ds_write_b32 v31, v253
    v_accvgpr_read_b32 v2, a235
    v_add_u32 v3, 6144, v2
    v_lshrrev_b32 v5, 5, v0
    s_lshl_b32 s3, s66, 7
    s_mov_b32 s45, 21504
    s_mov_b32 s65, 0
    s_cmp_ge_u32 s62, 2
    s_cselect_b32 s45, 46592, s45
    v_mfma_f32_32x32x16_bf16 v[224:239], v[180:183], v[112:115], v[224:239]
    s_cmp_ge_u32 s62, 2
    s_cselect_b32 s65, 50176, s65
    s_add_u32 s65, s65, s3
    v_mul_u32_u24_e64 v4, s45, v5
    v_add3_u32 v4, v4, v2, s65
    s_mov_b32 s45, 46592
    s_mov_b32 s65, 74240
    v_mfma_f32_32x32x16_bf16 v[208:223], v[184:187], v[116:119], v[208:223]
    s_cmp_ge_u32 s62, 2
    s_cselect_b32 s45, 21504, s45
    s_cmp_ge_u32 s62, 2
    s_cselect_b32 s65, 149504, s65
    s_add_u32 s65, s65, s3
    v_mul_u32_u24 v5, s45, v5
    v_add3_u32 v5, v5, v2, s65
    v_accvgpr_read_b32 v251, a237
    v_mfma_f32_32x32x16_bf16 v[224:239], v[188:191], v[116:119], v[224:239]
    s_waitcnt vmcnt(11) lgkmcnt(0)
    s_barrier
    ds_read_b128 v[128:131], v8 offset:0
    ds_read_b128 v[132:135], v9 offset:0
    ds_read_b128 v[136:139], v10 offset:0
    ds_read_b128 v[140:143], v11 offset:0
    v_mfma_f32_32x32x16_bf16 v[208:223], v[192:195], v[120:123], v[208:223]
L_non_c:
    v_readfirstlane_b32 s67, v244
    s_nop 0
    s_cmp_eq_u32 s67, 0
    s_cbranch_scc1 L_non_s
L_non_k:
    v_accvgpr_write_b32 a244, s67
    v_accvgpr_write_b32 a246, s67
    s_mov_b64 exec, 1
    buffer_store_dwordx4 a[244:247], v1, s[16:19], s101 offen sc1
    s_mov_b64 exec, -1
    v_mfma_f32_32x32x16_bf16 v[224:239], v[196:199], v[120:123], v[224:239]
    ds_read_b64_tr_b16 v[144:145], v12 offset:24576
    ds_read_b64_tr_b16 v[146:147], v12 offset:24832
    ds_read_b64_tr_b16 v[148:149], v12 offset:53248
    ds_read_b64_tr_b16 v[150:151], v12 offset:53504
    ds_read_b64_tr_b16 v[152:153], v13 offset:24576
    ds_read_b64_tr_b16 v[154:155], v13 offset:24832
    v_mfma_f32_32x32x16_bf16 v[208:223], v[200:203], v[124:127], v[208:223]
    ds_read_b64_tr_b16 v[156:157], v13 offset:53248
    ds_read_b64_tr_b16 v[158:159], v13 offset:53504
    ds_read_b64_tr_b16 v[160:161], v14 offset:24576
    ds_read_b64_tr_b16 v[162:163], v14 offset:24832
    v_mfma_f32_32x32x16_bf16 v[224:239], v[204:207], v[124:127], v[224:239]
    s_waitcnt lgkmcnt(8)
    ds_read_b64_tr_b16 v[164:165], v14 offset:53248
    ds_read_b64_tr_b16 v[166:167], v14 offset:53504
    ds_read_b64_tr_b16 v[168:169], v15 offset:24576
    s_nop 0
    ds_read_b64_tr_b16 v[170:171], v15 offset:24832
    ds_read_b64_tr_b16 v[172:173], v15 offset:53248
    ds_read_b64_tr_b16 v[174:175], v15 offset:53504
    ds_read_b128 v[204:207], v245
    s_mul_i32 s83, s91, 2688
    s_add_u32 s26, s83, 2688
    v_dot2c_f32_bf16 v240, s80, v128
    s_min_u32 s26, s26, 344064
    s_mov_b32 s24, s50
    s_mov_b32 s25, s51
    buffer_load_dword a251, v252, s[24:27], s83 offen
    v_dot2c_f32_bf16 v242, v128, v128
    v_dot2c_f32_bf16 v241, s80, v129
    v_dot2c_f32_bf16 v243, v129, v129
    v_dot2c_f32_bf16 v240, s80, v130
    v_dot2c_f32_bf16 v242, v130, v130
    v_dot2c_f32_bf16 v241, s80, v131
    v_dot2c_f32_bf16 v243, v131, v131
    v_dot2c_f32_bf16 v240, s80, v132
    v_dot2c_f32_bf16 v242, v132, v132
    v_dot2c_f32_bf16 v241, s80, v133
    v_dot2c_f32_bf16 v243, v133, v133
    v_dot2c_f32_bf16 v240, s80, v134
    v_dot2c_f32_bf16 v242, v134, v134
    v_dot2c_f32_bf16 v241, s80, v135
    v_dot2c_f32_bf16 v243, v135, v135
    v_dot2c_f32_bf16 v240, s80, v136
    v_dot2c_f32_bf16 v242, v136, v136
    v_dot2c_f32_bf16 v241, s80, v137
    v_dot2c_f32_bf16 v243, v137, v137
    v_dot2c_f32_bf16 v240, s80, v138
    v_dot2c_f32_bf16 v242, v138, v138
    v_dot2c_f32_bf16 v241, s80, v139
    v_dot2c_f32_bf16 v243, v139, v139
    v_dot2c_f32_bf16 v240, s80, v140
    v_dot2c_f32_bf16 v242, v140, v140
    v_dot2c_f32_bf16 v241, s80, v141
    v_dot2c_f32_bf16 v243, v141, v141
    v_dot2c_f32_bf16 v240, s80, v142
    v_dot2c_f32_bf16 v242, v142, v142
    v_dot2c_f32_bf16 v241, s80, v143
    v_dot2c_f32_bf16 v243, v143, v143
    s_waitcnt lgkmcnt(0)
    v_add_f32 v204, v204, v205
    v_add_f32 v206, v206, v207
    s_lshl_b32 s4, s62, 8
    s_add_u32 s4, s4, 160768
    v_lshl_add_u32 v205, v0, 2, s4
    v_add_f32_e64 v204, v204, v206
    v_mfma_f32_32x32x16_bf16 v[208:223], v[144:147], v[128:131], v[208:223]
    ds_write_b32 v205, v204
    ds_read_b128 v[176:179], v246 offset:0
    ds_read_b128 v[180:183], v246 offset:32
    ds_read_b128 v[184:187], v246 offset:64
    v_mfma_f32_32x32x16_bf16 v[208:223], v[152:155], v[132:135], v[208:223]
    ds_read_b128 v[188:191], v246 offset:96
    ds_read_b128 v[192:195], v246 offset:128
    ds_read_b128 v[196:199], v246 offset:160
    ds_read_b128 v[200:203], v246 offset:192
    v_mfma_f32_32x32x16_bf16 v[208:223], v[160:163], v[136:139], v[208:223]
    ds_read_b128 v[204:207], v246 offset:224
    v_mfma_f32_32x32x16_bf16 v[208:223], v[168:171], v[140:143], v[208:223]
    v_add_f32 v240, v240, v241
    v_add_f32 v242, v242, v243
    v_mov_b32 v241, v240
    v_mov_b32 v243, v242
    s_nop 0
    v_permlane32_swap_b32 v240, v241
    v_permlane32_swap_b32 v242, v243
    v_add_f32 v240, v240, v241
    v_add_f32_e64 v242, v242, v243
    v_mul_f32 v241, 0x3b124925, v240
    v_mul_f32 v242, 0x3b124925, v242
    v_fma_f32 v242, -v241, v241, v242
    v_add_f32 v242, 0x3727c5ac, v242
    v_rsq_f32 v240, v242
    s_nop 0
    v_mul_f32 v241, v241, v240
    v_mul_f32 v242, 0x3fb8aa3b, v240
    v_mul_f32 v243, 0x3fb8aa3b, v241
    s_waitcnt lgkmcnt(4)
    v_xor_b32 v253, 0x80000000, v243
    v_xor_b32 v254, 0x80000000, v241
    v_mfma_f32_32x32x16_bf16 v[224:239], v[148:151], v[128:131], v[224:239]
    v_mul_f32 v208, v242, v208
    v_mul_f32 v209, v242, v209
    v_mul_f32 v210, v242, v210
    v_mul_f32 v211, v242, v211
    v_mul_f32 v212, v242, v212
    v_mul_f32 v213, v242, v213
    v_mfma_f32_32x32x16_bf16 v[224:239], v[156:159], v[132:135], v[224:239]
    v_mul_f32 v214, v242, v214
    v_mul_f32 v215, v242, v215
    v_mul_f32 v216, v242, v216
    v_mul_f32 v217, v242, v217
    v_mul_f32 v218, v242, v218
    v_mul_f32 v219, v242, v219
    v_mfma_f32_32x32x16_bf16 v[224:239], v[164:167], v[136:139], v[224:239]
    v_mul_f32 v220, v242, v220
    v_mul_f32 v221, v242, v221
    v_mul_f32 v222, v242, v222
    v_mul_f32 v223, v242, v223
    v_fmac_f32 v208, v253, v176
    v_fmac_f32 v209, v253, v177
    v_mfma_f32_32x32x16_bf16 v[224:239], v[172:175], v[140:143], v[224:239]
    v_fmac_f32 v210, v253, v178
    v_fmac_f32 v211, v253, v179
    v_fmac_f32 v212, v253, v180
    v_fmac_f32 v213, v253, v181
    v_fmac_f32 v214, v253, v182
    v_fmac_f32 v215, v253, v183
    v_fmac_f32 v216, v253, v184
    v_fmac_f32 v217, v253, v185
    v_fmac_f32 v218, v253, v186
    v_fmac_f32 v219, v253, v187
    v_fmac_f32 v220, v253, v188
    v_fmac_f32 v221, v253, v189
    v_fmac_f32 v222, v253, v190
    v_fmac_f32 v223, v253, v191
    v_cvt_pk_bf16_f32 v176, v208, v209
    v_cvt_pk_bf16_f32 v177, v210, v211
    v_cvt_pk_bf16_f32 v178, v212, v213
    v_cvt_pk_bf16_f32 v179, v214, v215
    v_cvt_pk_bf16_f32 v180, v216, v217
    v_cvt_pk_bf16_f32 v181, v218, v219
    v_cvt_pk_bf16_f32 v182, v220, v221
    v_cvt_pk_bf16_f32 v183, v222, v223
    s_waitcnt lgkmcnt(0)
    v_mfma_f32_32x32x16_bf16 v[144:159], v[16:19], v[176:179], 0
    s_nop 0
    v_accvgpr_read_b32 v8, a236
    v_add_u32_e64 v8, s32, v8
    v_add_u32 v9, 27648, v8
    v_add_u32 v10, 55296, v8
    v_add_u32 v11, 82944, v8
    v_mfma_f32_32x32x16_bf16 v[144:159], v[20:23], v[180:183], v[144:159]
    v_mul_f32 v224, v240, v224
    v_mul_f32 v225, v240, v225
    v_mul_f32 v226, v240, v226
    v_mul_f32 v227, v240, v227
    v_mul_f32 v228, v240, v228
    v_mul_f32 v229, v240, v229
    v_mul_f32 v230, v240, v230
    v_mul_f32 v231, v240, v231
    v_mul_f32 v232, v240, v232
    v_mul_f32 v233, v240, v233
    v_mul_f32 v234, v240, v234
    v_mul_f32 v235, v240, v235
    v_mul_f32 v236, v240, v236
    v_mul_f32 v237, v240, v237
    v_mul_f32 v238, v240, v238
    v_mul_f32 v239, v240, v239
    v_fmac_f32 v224, v254, v192
    v_fmac_f32 v225, v254, v193
    v_fmac_f32 v226, v254, v194
    v_fmac_f32 v227, v254, v195
    v_fmac_f32 v228, v254, v196
    v_fmac_f32 v229, v254, v197
    v_fmac_f32 v230, v254, v198
    v_fmac_f32 v231, v254, v199
    v_fmac_f32 v232, v254, v200
    v_fmac_f32 v233, v254, v201
    v_fmac_f32 v234, v254, v202
    v_fmac_f32 v235, v254, v203
    v_fmac_f32 v236, v254, v204
    v_fmac_f32 v237, v254, v205
    v_fmac_f32 v238, v254, v206
    v_fmac_f32 v239, v254, v207
    v_cvt_pk_bf16_f32 v184, v224, v225
    v_cvt_pk_bf16_f32 v185, v226, v227
    v_cvt_pk_bf16_f32 v186, v228, v229
    v_cvt_pk_bf16_f32 v187, v230, v231
    v_cvt_pk_bf16_f32 v188, v232, v233
    v_cvt_pk_bf16_f32 v189, v234, v235
    s_nop 0
    buffer_store_dwordx4 a[252:255], v24, s[16:19], 0 offen
    v_cvt_pk_bf16_f32 v190, v236, v237
    v_cvt_pk_bf16_f32 v191, v238, v239
    s_mov_b32 exec_lo, 0
    v_mov_b32 v190, 0x3f80
    v_mov_b32 v191, 0
    s_mov_b32 exec_lo, -1
    v_max3_f32 v28, v144, v145, v146
    v_min3_f32 v29, v144, v145, v146
    v_max3_f32 v28, v28, v147, v148
    v_min3_f32 v29, v29, v147, v148
    v_max3_f32 v28, v28, v149, v150
    v_min3_f32 v29, v29, v149, v150
    ds_write_b128 v247, v[184:187] offset:12416
    ds_write_b128 v247, v[188:191] offset:12448
    buffer_store_dwordx4 a[252:255], v25, s[16:19], 0 offen
    buffer_store_dwordx2 a[252:253], v26, s[16:19], 0 offen
    v_max3_f32 v28, v28, v151, v152
    v_min3_f32 v29, v29, v151, v152
    v_max3_f32 v28, v28, v153, v154
    v_min3_f32 v29, v29, v153, v154
    v_max3_f32 v28, v28, v155, v156
    v_min3_f32 v29, v29, v155, v156
    v_max_f32_e64 v28, v28, v157
    v_min_f32 v29, v29, v157
    v_mov_b32 v30, v28
    v_mov_b32 v31, v29
    s_nop 0
    v_permlane32_swap_b32 v28, v30
    s_add_u32 s83, s93, 4194304
    buffer_store_dwordx4 a[252:255], v1, s[16:19], s83 offen offset:0
    v_permlane32_swap_b32 v29, v31
    v_max_f32 v28, v28, v30
    v_min_f32 v29, v29, v31
    v_pk_add_f32 v[160:161], v[144:145], v[28:29] op_sel:[0,0] op_sel_hi:[1,0] neg_lo:[0,1] neg_hi:[0,1]
    v_pk_add_f32 v[208:209], v[144:145], v[28:29] op_sel:[0,1] op_sel_hi:[1,1] neg_lo:[1,0] neg_hi:[1,0]
    v_pk_add_f32 v[162:163], v[146:147], v[28:29] op_sel:[0,0] op_sel_hi:[1,0] neg_lo:[0,1] neg_hi:[0,1]
    v_pk_add_f32 v[210:211], v[146:147], v[28:29] op_sel:[0,1] op_sel_hi:[1,1] neg_lo:[1,0] neg_hi:[1,0]
    v_pk_add_f32 v[164:165], v[148:149], v[28:29] op_sel:[0,0] op_sel_hi:[1,0] neg_lo:[0,1] neg_hi:[0,1]
    v_pk_add_f32 v[212:213], v[148:149], v[28:29] op_sel:[0,1] op_sel_hi:[1,1] neg_lo:[1,0] neg_hi:[1,0]
    v_pk_add_f32 v[166:167], v[150:151], v[28:29] op_sel:[0,0] op_sel_hi:[1,0] neg_lo:[0,1] neg_hi:[0,1]
    v_pk_add_f32 v[214:215], v[150:151], v[28:29] op_sel:[0,1] op_sel_hi:[1,1] neg_lo:[1,0] neg_hi:[1,0]
    buffer_store_dwordx4 a[252:255], v1, s[16:19], s83 offen offset:1024
    v_pk_add_f32 v[168:169], v[152:153], v[28:29] op_sel:[0,0] op_sel_hi:[1,0] neg_lo:[0,1] neg_hi:[0,1]
    v_pk_add_f32 v[216:217], v[152:153], v[28:29] op_sel:[0,1] op_sel_hi:[1,1] neg_lo:[1,0] neg_hi:[1,0]
    v_pk_add_f32 v[170:171], v[154:155], v[28:29] op_sel:[0,0] op_sel_hi:[1,0] neg_lo:[0,1] neg_hi:[0,1]
    v_pk_add_f32 v[218:219], v[154:155], v[28:29] op_sel:[0,1] op_sel_hi:[1,1] neg_lo:[1,0] neg_hi:[1,0]
    v_pk_add_f32 v[172:173], v[156:157], v[28:29] op_sel:[0,0] op_sel_hi:[1,0] neg_lo:[0,1] neg_hi:[0,1]
    v_pk_add_f32 v[220:221], v[156:157], v[28:29] op_sel:[0,1] op_sel_hi:[1,1] neg_lo:[1,0] neg_hi:[1,0]
    v_exp_f32 v160, v160
    v_exp_f32 v208, v208
    v_exp_f32_e64 v161, v161
    s_add_u32 s83, s93, 6291456
    s_bitcmp1_b32 2147581953, s68
    s_cbranch_scc1 L_es_r
    buffer_store_dwordx4 a[252:255], v1, s[16:19], s83 offen offset:0
    buffer_store_dwordx4 a[252:255], v1, s[16:19], s83 offen offset:1024
    s_branch L_es_e
L_pg2:
    s_branch L_pg6
L_es_r:
    buffer_store_dwordx4 a[252:255], v1, s[16:19], s83 offen offset:0 sc1
    buffer_store_dwordx4 a[252:255], v1, s[16:19], s83 offen offset:1024 sc1
L_es_e:
    v_exp_f32 v209, v209
    v_exp_f32 v162, v162
    v_exp_f32 v210, v210
    v_exp_f32 v163, v163
    v_exp_f32 v211, v211
    v_exp_f32 v164, v164
    v_exp_f32 v212, v212
    v_exp_f32 v165, v165
    v_exp_f32 v213, v213
    v_exp_f32 v166, v166
    v_exp_f32 v214, v214
    v_exp_f32_e64 v167, v167
    s_add_u32 s83, s93, 8388608
    buffer_store_dwordx4 a[252:255], v1, s[16:19], s83 offen offset:0
    buffer_store_dwordx4 a[252:255], v1, s[16:19], s83 offen offset:1024
    v_exp_f32 v215, v215
    v_exp_f32 v168, v168
    v_exp_f32 v216, v216
    v_exp_f32 v169, v169
    v_exp_f32 v217, v217
    v_exp_f32 v170, v170
    v_exp_f32 v218, v218
    v_exp_f32 v171, v171
    v_exp_f32 v219, v219
    v_exp_f32 v172, v172
    v_exp_f32 v220, v220
    v_exp_f32 v173, v173
    s_add_u32 s83, s93, 2097152
    s_add_u32 s26, s83, 2048
    s_mov_b32 s24, s58
    s_mov_b32 s25, s59
    buffer_load_dword a251, v252, s[24:27], s83 offen
    v_exp_f32_e64 v221, v221
    v_pk_add_f32 v[174:175], v[160:161], v[162:163]
    v_pk_add_f32 v[222:223], v[208:209], v[210:211]
    v_pk_add_f32 v[174:175], v[174:175], v[164:165]
    v_pk_add_f32 v[222:223], v[222:223], v[212:213]
    v_pk_add_f32 v[174:175], v[174:175], v[166:167]
    v_pk_add_f32 v[222:223], v[222:223], v[214:215]
    v_pk_add_f32 v[174:175], v[174:175], v[168:169]
    v_pk_add_f32 v[222:223], v[222:223], v[216:217]
    v_pk_add_f32 v[174:175], v[174:175], v[170:171]
    v_pk_add_f32 v[222:223], v[222:223], v[218:219]
    v_pk_add_f32 v[174:175], v[174:175], v[172:173]
    v_pk_add_f32 v[222:223], v[222:223], v[220:221]
    v_add_f32 v174, v174, v175
    v_add_f32 v222, v222, v223
    s_mov_b32 s20, s42
    s_mov_b32 s21, s43
    s_mov_b32 s22, 401408
    s_add_u32 m0, s33, 98304
    s_add_u32 s87, s0, 0
    buffer_load_dwordx4 v4, s[20:23], s87 offen offset:0 lds
    v_mov_b32 v30, v174
    v_mov_b32 v31, v222
    s_nop 0
    v_permlane32_swap_b32 v174, v30
    v_permlane32_swap_b32 v222, v31
    v_add_f32 v174, v174, v30
    v_add_f32 v222, v222, v31
    v_rcp_f32 v174, v174
    v_rcp_f32 v222, v222
    v_mov_b32 v199, 0
    v_mov_b32 v207, 0
    v_pk_mul_f32 v[160:161], v[160:161], v[174:175] op_sel:[0,0] op_sel_hi:[1,0]
    buffer_load_dwordx4 v5, s[20:23], s87 offen offset:1024 lds
    v_pk_mul_f32 v[208:209], v[208:209], v[222:223] op_sel:[0,0] op_sel_hi:[1,0]
    v_pk_mul_f32 v[162:163], v[162:163], v[174:175] op_sel:[0,0] op_sel_hi:[1,0]
    v_pk_mul_f32 v[210:211], v[210:211], v[222:223] op_sel:[0,0] op_sel_hi:[1,0]
    v_pk_mul_f32 v[164:165], v[164:165], v[174:175] op_sel:[0,0] op_sel_hi:[1,0]
    v_pk_mul_f32 v[212:213], v[212:213], v[222:223] op_sel:[0,0] op_sel_hi:[1,0]
    v_pk_mul_f32 v[166:167], v[166:167], v[174:175] op_sel:[0,0] op_sel_hi:[1,0]
    v_pk_mul_f32 v[214:215], v[214:215], v[222:223] op_sel:[0,0] op_sel_hi:[1,0]
    v_pk_mul_f32 v[168:169], v[168:169], v[174:175] op_sel:[0,0] op_sel_hi:[1,0]
    v_pk_mul_f32 v[216:217], v[216:217], v[222:223] op_sel:[0,0] op_sel_hi:[1,0]
    v_pk_mul_f32 v[170:171], v[170:171], v[174:175] op_sel:[0,0] op_sel_hi:[1,0]
    v_pk_mul_f32 v[218:219], v[218:219], v[222:223] op_sel:[0,0] op_sel_hi:[1,0]
    v_pk_mul_f32 v[172:173], v[172:173], v[174:175] op_sel:[0,0] op_sel_hi:[1,0]
    v_pk_mul_f32 v[220:221], v[220:221], v[222:223] op_sel:[0,0] op_sel_hi:[1,0]
    v_cvt_pk_bf16_f32 v192, v160, v161
    v_cvt_pk_bf16_f32 v193, v162, v163
    v_cvt_pk_bf16_f32 v194, v168, v169
    s_add_u32 m0, s33, 106496
    v_cvt_pk_bf16_f32 v195, v170, v171
    v_cvt_pk_bf16_f32 v196, v164, v165
    v_cvt_pk_bf16_f32 v197, v166, v167
    v_cvt_pk_bf16_f32 v198, v172, v173
    v_cvt_pk_bf16_f32 v200, v208, v209
    s_add_u32 s87, s0, 200704
    buffer_load_dwordx4 v4, s[20:23], s87 offen offset:0 lds
    ds_write_b128 v247, v[192:195] offset:12288
    buffer_load_dwordx4 v5, s[20:23], s87 offen offset:1024 lds
    ds_write_b128 v247, v[196:199] offset:12320
    v_cvt_pk_bf16_f32 v201, v210, v211
    v_cvt_pk_bf16_f32 v202, v216, v217
    v_cvt_pk_bf16_f32 v203, v218, v219
    v_cvt_pk_bf16_f32 v204, v212, v213
    v_cvt_pk_bf16_f32 v205, v214, v215
    v_cvt_pk_bf16_f32 v206, v220, v221
    ds_write_b128 v247, v[200:203] offset:12352
    ds_write_b128 v247, v[204:207] offset:12384
    v_add_u32 v30, 49152, v248
    v_add_u32 v31, 49152, v249
    s_waitcnt lgkmcnt(0) vmcnt(20)
    v_accvgpr_read_b32 v12, a224
    v_accvgpr_read_b32 v13, a225
    v_accvgpr_read_b32 v14, a226
    v_accvgpr_read_b32 v15, a227
    s_barrier
    ds_read_b64_tr_b16 v[208:209], v249 offset:0
    ds_read_b64_tr_b16 v[144:145], v248 offset:0
    ds_read_b64_tr_b16 v[148:149], v248 offset:32
    ds_read_b64_tr_b16 v[210:211], v249 offset:208
    ds_read_b64_tr_b16 v[146:147], v248 offset:208
    ds_read_b64_tr_b16 v[150:151], v248 offset:240
    ds_read_b64_tr_b16 v[212:213], v249 offset:24576
    ds_read_b64_tr_b16 v[152:153], v248 offset:24576
    ds_read_b64_tr_b16 v[156:157], v248 offset:24608
    ds_read_b64_tr_b16 v[214:215], v249 offset:24784
    ds_read_b64_tr_b16 v[154:155], v248 offset:24784
    ds_read_b64_tr_b16 v[158:159], v248 offset:24816
    ds_read_b64_tr_b16 v[216:217], v31 offset:0
    ds_read_b64_tr_b16 v[160:161], v30 offset:0
    ds_read_b64_tr_b16 v[164:165], v30 offset:32
    ds_read_b64_tr_b16 v[218:219], v31 offset:208
    ds_read_b64_tr_b16 v[162:163], v30 offset:208
    ds_read_b64_tr_b16 v[166:167], v30 offset:240
    ds_read_b64_tr_b16 v[220:221], v31 offset:24576
    ds_read_b64_tr_b16 v[168:169], v30 offset:24576
    ds_read_b64_tr_b16 v[172:173], v30 offset:24608
    ds_read_b64_tr_b16 v[222:223], v31 offset:24784
    ds_read_b64_tr_b16 v[170:171], v30 offset:24784
    ds_read_b64_tr_b16 v[174:175], v30 offset:24816
    s_waitcnt lgkmcnt(15)
    v_mfma_f32_16x16x32_bf16 v[224:227], v[144:147], v[208:211], 0
    v_mfma_f32_16x16x32_bf16 v[228:231], v[148:151], v[208:211], 0
    s_waitcnt lgkmcnt(12)
    v_mfma_f32_16x16x32_bf16 v[224:227], v[152:155], v[212:215], v[224:227]
    v_mfma_f32_16x16x32_bf16 v[228:231], v[156:159], v[212:215], v[228:231]
    s_waitcnt lgkmcnt(6)
    v_mfma_f32_16x16x32_bf16 v[224:227], v[160:163], v[216:219], v[224:227]
    v_mfma_f32_16x16x32_bf16 v[228:231], v[164:167], v[216:219], v[228:231]
    s_waitcnt lgkmcnt(0)
    v_mfma_f32_16x16x32_bf16 v[224:227], v[168:171], v[220:223], v[224:227]
    v_mfma_f32_16x16x32_bf16 v[228:231], v[172:175], v[220:223], v[228:231]
    s_barrier
    ds_read_b64_tr_b16 v[176:177], v12 offset:4096
    ds_read_b64_tr_b16 v[178:179], v12 offset:4352
    ds_read_b64_tr_b16 v[180:181], v12 offset:5120
    ds_read_b64_tr_b16 v[182:183], v12 offset:5376
    s_nop 1
    v_cvt_pk_bf16_f32 v232, v224, v225
    v_cvt_pk_bf16_f32 v233, v226, v227
    v_cvt_pk_bf16_f32 v234, v228, v229
    v_cvt_pk_bf16_f32 v235, v230, v231
    buffer_store_dwordx4 v[232:235], v1, s[16:19], s92 offen sc1
    ds_read_b64_tr_b16 v[184:185], v12 offset:6144
    ds_read_b64_tr_b16 v[186:187], v12 offset:6400
    ds_read_b64_tr_b16 v[188:189], v12 offset:7168
    ds_read_b64_tr_b16 v[190:191], v12 offset:7424
    ds_read_b64_tr_b16 v[192:193], v12 offset:8192
    ds_read_b64_tr_b16 v[194:195], v12 offset:8448
    ds_read_b64_tr_b16 v[196:197], v12 offset:9216
    ds_read_b64_tr_b16 v[198:199], v12 offset:9472
    ds_read_b64_tr_b16 v[200:201], v12 offset:10240
    ds_read_b64_tr_b16 v[202:203], v12 offset:10496
    v_mov_b32 v253, 0
    v_mov_b32 v254, 0
    v_mov_b32_e64 v204, v7
    v_accvgpr_read_b32 v6, a228
    s_add_u32 m0, s33, 114688
    s_add_u32 s87, s0, 3584
    buffer_load_dwordx4 v4, s[20:23], s87 offen offset:0 lds
    v_xor_b32 v7, 64, v6
    v_add_u32 v247, s69, v6
    v_add_u32 v248, s69, v7
    v_accvgpr_read_b32 v249, a229
    s_and_b32 s3, s92, 4294950912
    s_lshl_b32 s84, s64, 6
    s_add_u32 s84, s84, s3
    s_and_b32 s85, s100, 4294959104
    s_add_u32 s86, s85, 4096
    s_add_u32 s88, s77, 4096
    s_add_u32 s89, s77, 8192
    s_add_u32 s90, s77, 12288
    s_waitcnt lgkmcnt(0)
    ds_read_b64_tr_b16 a[128:129], v13 offset:4096
    ds_read_b64_tr_b16 a[130:131], v13 offset:4352
    ds_read_b64_tr_b16 a[132:133], v13 offset:5120
    buffer_load_dwordx4 v5, s[20:23], s87 offen offset:1024 lds
    ds_read_b64_tr_b16 a[134:135], v13 offset:5376
    ds_read_b64_tr_b16 a[136:137], v13 offset:6144
    ds_read_b64_tr_b16 a[138:139], v13 offset:6400
    ds_read_b64_tr_b16 a[140:141], v13 offset:7168
    ds_read_b64_tr_b16 a[142:143], v13 offset:7424
    ds_read_b64_tr_b16 a[144:145], v13 offset:8192
    ds_read_b64_tr_b16 a[146:147], v13 offset:8448
    v_dot2c_f32_bf16 v253, s80, v176
    v_dot2c_f32_bf16 v254, s80, v177
    v_dot2c_f32_bf16 v253, s80, v178
    v_dot2c_f32_bf16 v254, s80, v179
    v_dot2c_f32_bf16 v253, s80, v180
    v_dot2c_f32_bf16 v254, s80, v181
    v_dot2c_f32_bf16 v253, s80, v182
    v_dot2c_f32_bf16 v254, s80, v183
    v_dot2c_f32_bf16 v253, s80, v184
    buffer_load_dwordx2 v[236:237], v251, s[16:19], 0 offen
    v_dot2c_f32_bf16 v254, s80, v185
    v_dot2c_f32_bf16 v253, s80, v186
    v_dot2c_f32_bf16 v254, s80, v187
    v_dot2c_f32_bf16 v253, s80, v188
    v_dot2c_f32_bf16 v254, s80, v189
    v_dot2c_f32_bf16 v253, s80, v190
    v_dot2c_f32_bf16 v254, s80, v191
    s_add_u32 m0, s33, 131072
    s_add_u32 s87, s0, 14336
    buffer_load_dwordx4 v4, s[20:23], s87 offen offset:0 lds
    v_dot2c_f32_bf16 v253, s80, v192
    v_dot2c_f32_bf16 v254, s80, v193
    v_dot2c_f32_bf16 v253, s80, v194
    v_dot2c_f32_bf16 v254, s80, v195
    v_dot2c_f32_bf16 v253, s80, v196
    v_dot2c_f32_bf16 v254, s80, v197
    v_dot2c_f32_bf16 v253, s80, v198
    v_dot2c_f32_bf16 v254, s80, v199
    v_dot2c_f32_bf16 v253, s80, v200
    v_dot2c_f32_bf16 v254, s80, v201
    v_dot2c_f32_bf16 v253, s80, v202
    v_dot2c_f32_bf16 v254, s80, v203
    s_lshl_b32 s4, s62, 2
    buffer_load_dwordx4 v5, s[20:23], s87 offen offset:1024 lds
    v_add_u32_e64 v31, s4, v245
    v_permlane32_swap_b32 v253, v254
    v_add_f32_e64 v253, v253, v254
    v_mfma_f32_32x32x16_bf16 v[208:223], v[176:179], v[32:35], 0
    ds_write_b32 v31, v253
    ds_read_b64_tr_b16 a[148:149], v13 offset:9216
    ds_read_b64_tr_b16 a[150:151], v13 offset:9472
    ds_read_b64_tr_b16 a[152:153], v13 offset:10240
    v_mfma_f32_32x32x16_bf16 v[208:223], v[180:183], v[48:51], v[208:223]
    ds_read_b64_tr_b16 a[154:155], v13 offset:10496
    ds_read_b64_tr_b16 a[156:157], v14 offset:4096
    ds_read_b64_tr_b16 a[158:159], v14 offset:4352
    v_mfma_f32_32x32x16_bf16 v[208:223], v[184:187], v[64:67], v[208:223]
    s_add_u32 m0, s33, 139264
    s_add_u32 s87, s0, 215040
    buffer_load_dwordx4 v4, s[20:23], s87 offen offset:0 lds
    ds_read_b64_tr_b16 a[160:161], v14 offset:5120
    ds_read_b64_tr_b16 a[162:163], v14 offset:5376
    v_mfma_f32_32x32x16_bf16 v[208:223], v[188:191], v[80:83], v[208:223]
    ds_read_b64_tr_b16 a[164:165], v14 offset:6144
    ds_read_b64_tr_b16 a[166:167], v14 offset:6400
    ds_read_b64_tr_b16 a[168:169], v14 offset:7168
    ds_read_b64_tr_b16 a[170:171], v14 offset:7424
    ds_read_b64_tr_b16 a[172:173], v14 offset:8192
    ds_read_b64_tr_b16 a[174:175], v14 offset:8448
    v_mfma_f32_32x32x16_bf16 v[208:223], v[192:195], v[96:99], v[208:223]
    buffer_load_dwordx4 v5, s[20:23], s87 offen offset:1024 lds
    ds_read_b64_tr_b16 a[176:177], v14 offset:9216
    ds_read_b64_tr_b16 a[178:179], v14 offset:9472
    ds_read_b64_tr_b16 a[180:181], v14 offset:10240
    ds_read_b64_tr_b16 a[182:183], v14 offset:10496
    v_mfma_f32_32x32x16_bf16 v[208:223], v[196:199], v[112:115], v[208:223]
    ds_read_b64_tr_b16 a[184:185], v15 offset:4096
    ds_read_b64_tr_b16 a[186:187], v15 offset:4352
    s_add_u32 m0, s33, 122880
    s_add_u32 s87, s0, 204288
    v_mfma_f32_32x32x16_bf16 v[208:223], v[200:203], v[128:131], v[208:223]
    buffer_load_dwordx4 v4, s[20:23], s87 offen offset:0 lds
    ds_read_b64_tr_b16 a[188:189], v15 offset:5120
    ds_read_b64_tr_b16 a[190:191], v15 offset:5376
    ds_read_b64_tr_b16 a[192:193], v15 offset:6144
    s_waitcnt lgkmcnt(15)
    v_mfma_f32_32x32x16_bf16 v[208:223], a[128:131], v[36:39], v[208:223]
    s_barrier
    ds_read_b128 v[156:159], v245
    ds_read_b64_tr_b16 a[194:195], v15 offset:6400
    ds_read_b64_tr_b16 a[196:197], v15 offset:7168
    ds_read_b64_tr_b16 a[198:199], v15 offset:7424
    ds_read_b64_tr_b16 a[200:201], v15 offset:8192
    v_mfma_f32_32x32x16_bf16 v[208:223], a[132:135], v[52:55], v[208:223]
    ds_read_b64_tr_b16 a[202:203], v15 offset:8448
    buffer_load_dwordx4 v5, s[20:23], s87 offen offset:1024 lds
    ds_read_b64_tr_b16 a[204:205], v15 offset:9216
    ds_read_b64_tr_b16 a[206:207], v15 offset:9472
    ds_read_b64_tr_b16 a[208:209], v15 offset:10240
    v_mfma_f32_32x32x16_bf16 v[208:223], a[136:139], v[68:71], v[208:223]
    s_nop 0
    ds_read_b64_tr_b16 a[210:211], v15 offset:10496
    s_add_u32 m0, s33, 147456
    s_mul_i32 s87, s0, 28
    s_add_u32 s87, s87, 17920
    v_mfma_f32_32x32x16_bf16 v[208:223], a[140:143], v[84:87], v[208:223]
    buffer_load_dwordx4 v4, s[20:23], s87 offen offset:0 lds
    v_mfma_f32_32x32x16_bf16 v[208:223], a[144:147], v[100:103], v[208:223]
    v_mfma_f32_32x32x16_bf16 v[208:223], a[148:151], v[116:119], v[208:223]
    s_waitcnt lgkmcnt(9)
    buffer_load_dwordx4 v5, s[20:23], s87 offen offset:1024 lds
    v_add_f32 v156, v156, v157
    v_add_f32 v158, v158, v159
    s_lshl_b32 s4, s62, 8
    s_add_u32 s4, s4, 160768
    v_lshl_add_u32 v157, v0, 2, s4
    v_add_f32 v156, v156, v158
    v_mov_b32 v158, v156
    s_nop 1
    v_permlane32_swap_b32 v156, v158
    v_add_f32_e64 v156, v156, v158
    v_mfma_f32_32x32x16_bf16 v[208:223], a[152:155], v[132:135], v[208:223]
    ds_write_b32 v157, v156
    s_add_u32 m0, s69, 16384
    s_add_u32 s12, s28, 0
    s_addc_u32 s13, s29, 0
    v_mfma_f32_32x32x16_bf16 v[208:223], a[156:159], v[40:43], v[208:223]
    global_load_lds_dwordx4 v8, s[12:13] offset:0
    ds_read_b128 v[144:147], v246 offset:0
    ds_read_b128 v[148:151], v246 offset:32
    ds_read_b128 v[152:155], v246 offset:64
    s_waitcnt vmcnt(9)
L_d1_C:
    v_cmp_ne_u32 vcc, s67, v236
    s_cbranch_vccnz L_d1_S
L_d1_K:
    v_cmp_eq_u32 vcc, s34, v237
    s_add_u32 s5, s68, 1
    s_and_b32 s5, s5, 15
    s_cmp_eq_u32 vcc_lo, -1
    s_cselect_b32 s34, 1, 0
    s_cmp_lt_u32 s5, 2
    s_cselect_b32 s35, 0, s34
    s_cmp_eq_u32 s34, 0
    s_cbranch_scc1 L_redo
L_redone:
    v_mfma_f32_32x32x16_bf16 v[208:223], a[160:163], v[56:59], v[208:223]
    buffer_load_dwordx4 v[32:35], v204, s[16:19], s84 offen sc1
    ds_read_b128 v[156:159], v246 offset:96
    v_mfma_f32_32x32x16_bf16 v[208:223], a[164:167], v[72:75], v[208:223]
    global_load_lds_dwordx4 v9, s[12:13] offset:1024
    v_mfma_f32_32x32x16_bf16 v[208:223], a[168:171], v[88:91], v[208:223]
    v_mfma_f32_32x32x16_bf16 v[208:223], a[172:175], v[104:107], v[208:223]
    global_load_lds_dwordx4 v10, s[12:13] offset:2048
    v_mfma_f32_32x32x16_bf16 v[208:223], a[176:179], v[120:123], v[208:223]
    v_mfma_f32_32x32x16_bf16 v[208:223], a[180:183], v[136:139], v[208:223]
    global_load_lds_dwordx4 v11, s[12:13] offset:3072
    v_mfma_f32_32x32x16_bf16 v[208:223], a[184:187], v[44:47], v[208:223]
    v_mfma_f32_32x32x16_bf16 v[208:223], a[188:191], v[60:63], v[208:223]
    s_waitcnt lgkmcnt(5)
    v_mfma_f32_32x32x16_bf16 v[208:223], a[192:195], v[76:79], v[208:223]
    s_add_u32 m0, s69, 20480
    s_add_u32 s12, s28, 114688
    s_addc_u32 s13, s29, 0
    global_load_lds_dwordx4 v8, s[12:13] offset:0
    v_mfma_f32_32x32x16_bf16 v[208:223], a[196:199], v[92:95], v[208:223]
    v_mfma_f32_32x32x16_bf16 v[208:223], a[200:203], v[108:111], v[208:223]
    global_load_lds_dwordx4 v9, s[12:13] offset:1024
    v_mfma_f32_32x32x16_bf16 v[208:223], a[204:207], v[124:127], v[208:223]
    global_load_lds_dwordx4 v10, s[12:13] offset:2048
    v_mfma_f32_32x32x16_bf16 v[208:223], a[208:211], v[140:143], v[208:223]
    global_load_lds_dwordx4 v11, s[12:13] offset:3072
    s_add_u32 m0, s69, 12288
    s_add_u32 s12, s28, 229376
    s_addc_u32 s13, s29, 0
    global_load_lds_dwordx4 v8, s[12:13] offset:0
    s_waitcnt vmcnt(8)
L_kv1_C:
    v_cmp_eq_u32 vcc, -1, v32
    s_cbranch_vccnz L_kv1_S
L_kv1_K:
    v_lshlrev_b32 v40, 16, v32
    v_and_b32 v41, 0xffff0000, v32
    v_lshlrev_b32 v42, 16, v33
    v_and_b32 v43, 0xffff0000, v33
    v_lshlrev_b32 v44, 16, v34
    v_and_b32 v45, 0xffff0000, v34
    v_lshlrev_b32 v46, 16, v35
    v_and_b32 v47, 0xffff0000, v35
    v_permlane32_swap_b32 v40, v44
    v_permlane32_swap_b32 v41, v45
    v_permlane32_swap_b32 v42, v46
    v_permlane32_swap_b32 v43, v47
    v_add_f32 v40, v40, v44
    v_add_f32 v41, v41, v45
    v_add_f32 v42, v42, v46
    v_add_f32 v43, v43, v47
    s_nop 0
    v_permlane16_swap_b32 v40, v42
    v_permlane16_swap_b32 v41, v43
    v_add_f32 v40, v40, v42
    v_add_f32 v41, v41, v43
    s_nop 0
    v_add_f32_dpp v40, v40, v40 row_ror:8 row_mask:0xf bank_mask:0xf
    v_add_f32_dpp v41, v41, v41 row_ror:8 row_mask:0xf bank_mask:0xf
    s_nop 0
    v_add_f32_dpp v40, v40, v40 row_ror:4 row_mask:0xf bank_mask:0xf
    v_add_f32_dpp v41, v41, v41 row_ror:4 row_mask:0xf bank_mask:0xf
    v_cvt_pk_bf16_f32 v40, v40, v41
    buffer_store_dword v40, v250, s[16:19], s100 offen sc1
    s_waitcnt lgkmcnt(0)
    s_barrier
    s_add_u32 s101, s101, 0x8000
    s_mov_b64 exec, 1
    buffer_store_dwordx4 a[244:247], v1, s[16:19], s101 offen sc1
    s_mov_b64 exec, -1
    v_accvgpr_read_b32 v12, a230
    v_xor_b32_e64 v13, 32, v12
    v_xor_b32 v14, 64, v12
    v_xor_b32 v15, 96, v12
    v_pk_mul_f32 v[208:209], v[208:209], v[242:243] op_sel:[0,0] op_sel_hi:[1,0]
    v_pk_mul_f32 v[210:211], v[210:211], v[242:243] op_sel:[0,0] op_sel_hi:[1,0]
    v_pk_mul_f32 v[212:213], v[212:213], v[242:243] op_sel:[0,0] op_sel_hi:[1,0]
    v_pk_mul_f32 v[214:215], v[214:215], v[242:243] op_sel:[0,0] op_sel_hi:[1,0]
    v_pk_mul_f32 v[216:217], v[216:217], v[242:243] op_sel:[0,0] op_sel_hi:[1,0]
    v_pk_mul_f32 v[218:219], v[218:219], v[242:243] op_sel:[0,0] op_sel_hi:[1,0]
    v_pk_mul_f32 v[220:221], v[220:221], v[242:243] op_sel:[0,0] op_sel_hi:[1,0]
    v_pk_mul_f32 v[222:223], v[222:223], v[242:243] op_sel:[0,0] op_sel_hi:[1,0]
    v_pk_fma_f32 v[208:209], v[144:145], v[242:243], v[208:209] op_sel:[0,1,0] op_sel_hi:[1,1,1] neg_lo:[0,1,0] neg_hi:[0,1,0]
    v_pk_fma_f32 v[210:211], v[146:147], v[242:243], v[210:211] op_sel:[0,1,0] op_sel_hi:[1,1,1] neg_lo:[0,1,0] neg_hi:[0,1,0]
    v_pk_fma_f32 v[212:213], v[148:149], v[242:243], v[212:213] op_sel:[0,1,0] op_sel_hi:[1,1,1] neg_lo:[0,1,0] neg_hi:[0,1,0]
    v_pk_fma_f32 v[214:215], v[150:151], v[242:243], v[214:215] op_sel:[0,1,0] op_sel_hi:[1,1,1] neg_lo:[0,1,0] neg_hi:[0,1,0]
    v_pk_fma_f32 v[216:217], v[152:153], v[242:243], v[216:217] op_sel:[0,1,0] op_sel_hi:[1,1,1] neg_lo:[0,1,0] neg_hi:[0,1,0]
    v_pk_fma_f32 v[218:219], v[154:155], v[242:243], v[218:219] op_sel:[0,1,0] op_sel_hi:[1,1,1] neg_lo:[0,1,0] neg_hi:[0,1,0]
    v_pk_fma_f32 v[220:221], v[156:157], v[242:243], v[220:221] op_sel:[0,1,0] op_sel_hi:[1,1,1] neg_lo:[0,1,0] neg_hi:[0,1,0]
    v_pk_fma_f32 v[222:223], v[158:159], v[242:243], v[222:223] op_sel:[0,1,0] op_sel_hi:[1,1,1] neg_lo:[0,1,0] neg_hi:[0,1,0]
    v_cvt_pk_bf16_f32 v176, v208, v209
    v_cvt_pk_bf16_f32 v177, v210, v211
    v_cvt_pk_bf16_f32 v178, v212, v213
    v_cvt_pk_bf16_f32 v179, v214, v215
    v_cvt_pk_bf16_f32 v180, v216, v217
    v_cvt_pk_bf16_f32 v181, v218, v219
    v_cvt_pk_bf16_f32 v182, v220, v221
    v_cvt_pk_bf16_f32 v183, v222, v223
    v_mfma_f32_32x32x16_bf16 v[144:159], v[16:19], v[176:179], 0
    global_load_lds_dwordx4 v9, s[12:13] offset:1024
    global_load_lds_dwordx4 v10, s[12:13] offset:2048
    v_mfma_f32_32x32x16_bf16 v[144:159], v[20:23], v[180:183], v[144:159]
    v_add_u32 v16, 98304, v12
    v_add_u32 v17, 98304, v13
    v_add_u32 v18, 98304, v14
    v_add_u32 v19, 98304, v15
    v_accvgpr_read_b32 v20, a231
    v_accvgpr_read_b32 v21, a232
    v_mov_b32 v22, v247
    v_mov_b32_e64 v23, v248
    s_lshl_b32 s4, s60, 5
    s_add_u32 s4, s4, 240
    v_add_u32 v72, s4, v0
    v_and_b32 v72, 255, v72
    v_lshlrev_b32 v72, 4, v72
    v_add_u32 v72, 1605632, v72
    v_max3_f32 v28, v144, v145, v146
    v_min3_f32 v29, v144, v145, v146
    v_max3_f32 v28, v28, v147, v148
    v_min3_f32 v29, v29, v147, v148
    v_max3_f32 v28, v28, v149, v150
    v_min3_f32 v29, v29, v149, v150
    v_max3_f32 v28, v28, v151, v152
    v_min3_f32 v29, v29, v151, v152
    ds_read_b64_tr_b16 a[112:113], v16 offset:0
    buffer_load_dwordx2 v[64:65], v21, s[8:11], 0 offen offset:0
    ds_read_b64_tr_b16 a[114:115], v16 offset:2048
    ds_read_b64_tr_b16 a[116:117], v17 offset:0
    buffer_load_dwordx2 v[66:67], v21, s[8:11], 0 offen offset:32
    ds_read_b64_tr_b16 a[118:119], v17 offset:2048
    buffer_load_dwordx2 v[68:69], v21, s[8:11], 0 offen offset:64
    v_max3_f32 v28, v28, v153, v154
    v_min3_f32 v29, v29, v153, v154
    v_max3_f32 v28, v28, v155, v156
    v_min3_f32 v29, v29, v155, v156
    v_max_f32 v28, v28, v157
    v_min_f32 v29, v29, v157
    v_mov_b32 v30, v28
    v_mov_b32 v31, v29
    s_nop 0
    v_permlane32_swap_b32 v28, v30
    v_permlane32_swap_b32 v29, v31
    v_max_f32 v28, v28, v30
    v_min_f32_e64 v29, v29, v31
    v_pk_add_f32 v[160:161], v[144:145], v[28:29] op_sel:[0,0] op_sel_hi:[1,0] neg_lo:[0,1] neg_hi:[0,1]
    v_pk_add_f32 v[224:225], v[144:145], v[28:29] op_sel:[0,1] op_sel_hi:[1,1] neg_lo:[1,0] neg_hi:[1,0]
    v_pk_add_f32 v[162:163], v[146:147], v[28:29] op_sel:[0,0] op_sel_hi:[1,0] neg_lo:[0,1] neg_hi:[0,1]
    v_pk_add_f32 v[226:227], v[146:147], v[28:29] op_sel:[0,1] op_sel_hi:[1,1] neg_lo:[1,0] neg_hi:[1,0]
    v_pk_add_f32 v[164:165], v[148:149], v[28:29] op_sel:[0,0] op_sel_hi:[1,0] neg_lo:[0,1] neg_hi:[0,1]
    v_pk_add_f32 v[228:229], v[148:149], v[28:29] op_sel:[0,1] op_sel_hi:[1,1] neg_lo:[1,0] neg_hi:[1,0]
    buffer_load_dwordx2 v[70:71], v21, s[8:11], 0 offen offset:96
    ds_read_b64_tr_b16 a[120:121], v18 offset:0
    global_load_lds_dwordx4 v11, s[12:13] offset:3072
    ds_read_b64_tr_b16 a[122:123], v18 offset:2048
    ds_read_b64_tr_b16 a[124:125], v19 offset:0
    ds_read_b64_tr_b16 a[126:127], v19 offset:2048
    ds_read_b64_tr_b16 a[128:129], v16 offset:16384
    v_pk_add_f32 v[166:167], v[150:151], v[28:29] op_sel:[0,0] op_sel_hi:[1,0] neg_lo:[0,1] neg_hi:[0,1]
    v_pk_add_f32 v[230:231], v[150:151], v[28:29] op_sel:[0,1] op_sel_hi:[1,1] neg_lo:[1,0] neg_hi:[1,0]
    v_pk_add_f32 v[168:169], v[152:153], v[28:29] op_sel:[0,0] op_sel_hi:[1,0] neg_lo:[0,1] neg_hi:[0,1]
    v_pk_add_f32 v[232:233], v[152:153], v[28:29] op_sel:[0,1] op_sel_hi:[1,1] neg_lo:[1,0] neg_hi:[1,0]
    v_pk_add_f32 v[170:171], v[154:155], v[28:29] op_sel:[0,0] op_sel_hi:[1,0] neg_lo:[0,1] neg_hi:[0,1]
    v_pk_add_f32 v[234:235], v[154:155], v[28:29] op_sel:[0,1] op_sel_hi:[1,1] neg_lo:[1,0] neg_hi:[1,0]
    v_pk_add_f32 v[172:173], v[156:157], v[28:29] op_sel:[0,0] op_sel_hi:[1,0] neg_lo:[0,1] neg_hi:[0,1]
    v_pk_add_f32 v[236:237], v[156:157], v[28:29] op_sel:[0,1] op_sel_hi:[1,1] neg_lo:[1,0] neg_hi:[1,0]
    s_mov_b32 s20, s46
    s_mov_b32 s21, s47
    s_mov_b32 s22, 401408
    v_exp_f32 v160, v160
    v_exp_f32 v224, v224
    v_exp_f32 v161, v161
    v_exp_f32 v225, v225
    s_add_u32 m0, s69, 0
    s_nop 0
    buffer_load_dwordx4 v2, s[20:23], s36 offen offset:0 lds
    ds_read_b64_tr_b16 a[130:131], v16 offset:18432
    ds_read_b64_tr_b16 a[132:133], v17 offset:16384
    buffer_load_dwordx4 v3, s[20:23], s36 offen offset:1024 lds
    ds_read_b64_tr_b16 a[134:135], v17 offset:18432
    ds_read_b64_tr_b16 a[136:137], v18 offset:16384
    v_exp_f32 v162, v162
    v_exp_f32 v226, v226
    v_exp_f32 v163, v163
    v_exp_f32 v227, v227
    v_exp_f32 v164, v164
    v_exp_f32 v228, v228
    v_exp_f32 v165, v165
    v_exp_f32 v229, v229
    v_exp_f32 v166, v166
    v_exp_f32 v230, v230
    v_exp_f32 v167, v167
    v_exp_f32_e64 v231, v231
    s_add_u32 m0, s69, 2048
    s_nop 0
    buffer_load_dwordx4 v2, s[20:23], s37 offen offset:0 lds
    ds_read_b64_tr_b16 a[138:139], v18 offset:18432
    ds_read_b64_tr_b16 a[140:141], v19 offset:16384
    buffer_load_dwordx4 v3, s[20:23], s37 offen offset:1024 lds
    ds_read_b64_tr_b16 a[142:143], v19 offset:18432
    ds_read_b64_tr_b16 a[144:145], v16 offset:32768
    v_exp_f32 v168, v168
    v_exp_f32 v232, v232
    v_exp_f32 v169, v169
    v_exp_f32 v233, v233
    v_exp_f32 v170, v170
    v_exp_f32 v234, v234
    v_exp_f32 v171, v171
    v_exp_f32 v235, v235
    v_exp_f32 v172, v172
    v_exp_f32 v236, v236
    v_exp_f32_e64 v173, v173
    v_exp_f32 v237, v237
    v_pk_add_f32 v[174:175], v[160:161], v[162:163]
    v_pk_add_f32 v[238:239], v[224:225], v[226:227]
    v_pk_add_f32 v[174:175], v[174:175], v[164:165]
    v_pk_add_f32 v[238:239], v[238:239], v[228:229]
    v_pk_add_f32 v[174:175], v[174:175], v[166:167]
    v_pk_add_f32 v[238:239], v[238:239], v[230:231]
    s_add_u32 m0, s69, 4096
    s_nop 0
    buffer_load_dwordx4 v2, s[20:23], s38 offen offset:0 lds
    ds_read_b64_tr_b16 a[146:147], v16 offset:34816
    ds_read_b64_tr_b16 a[148:149], v17 offset:32768
    ds_read_b64_tr_b16 a[150:151], v17 offset:34816
    buffer_load_dwordx4 v3, s[20:23], s38 offen offset:1024 lds
    ds_read_b64_tr_b16 a[152:153], v18 offset:32768
    ds_read_b64_tr_b16 a[154:155], v18 offset:34816
    ds_read_b64_tr_b16 a[156:157], v19 offset:32768
    v_pk_add_f32 v[174:175], v[174:175], v[168:169]
    v_pk_add_f32 v[238:239], v[238:239], v[232:233]
    v_pk_add_f32 v[174:175], v[174:175], v[170:171]
    v_pk_add_f32 v[238:239], v[238:239], v[234:235]
    v_pk_add_f32 v[174:175], v[174:175], v[172:173]
    v_pk_add_f32 v[238:239], v[238:239], v[236:237]
    v_add_f32 v174, v174, v175
    v_add_f32 v238, v238, v239
    v_mov_b32 v30, v174
    v_mov_b32 v31, v238
    s_add_u32 m0, s69, 6144
    s_nop 0
    buffer_load_dwordx4 v2, s[20:23], s39 offen offset:0 lds
    s_nop 0
    ds_read_b64_tr_b16 a[158:159], v19 offset:34816
    buffer_load_dwordx4 v3, s[20:23], s39 offen offset:1024 lds
    v_permlane32_swap_b32 v174, v30
    v_permlane32_swap_b32 v238, v31
    v_add_f32 v174, v174, v30
    v_add_f32 v238, v238, v31
    v_rcp_f32 v174, v174
    v_rcp_f32 v238, v238
    v_mov_b32 v199, 0
    buffer_load_dwordx4 v[108:111], v249, s[16:19], s85 offen offset:0
    v_mov_b32 v207, 0
    v_pk_mul_f32 v[160:161], v[160:161], v[174:175] op_sel:[0,0] op_sel_hi:[1,0]
    v_pk_mul_f32 v[224:225], v[224:225], v[238:239] op_sel:[0,0] op_sel_hi:[1,0]
    v_pk_mul_f32 v[162:163], v[162:163], v[174:175] op_sel:[0,0] op_sel_hi:[1,0]
    v_pk_mul_f32 v[226:227], v[226:227], v[238:239] op_sel:[0,0] op_sel_hi:[1,0]
    v_pk_mul_f32 v[164:165], v[164:165], v[174:175] op_sel:[0,0] op_sel_hi:[1,0]
    v_pk_mul_f32 v[228:229], v[228:229], v[238:239] op_sel:[0,0] op_sel_hi:[1,0]
    v_pk_mul_f32 v[166:167], v[166:167], v[174:175] op_sel:[0,0] op_sel_hi:[1,0]
    v_pk_mul_f32 v[230:231], v[230:231], v[238:239] op_sel:[0,0] op_sel_hi:[1,0]
    v_pk_mul_f32 v[168:169], v[168:169], v[174:175] op_sel:[0,0] op_sel_hi:[1,0]
    buffer_load_dwordx4 v[112:115], v249, s[16:19], s85 offen offset:512
    buffer_load_dwordx4 v[116:119], v249, s[16:19], s86 offen offset:0
    buffer_load_dwordx4 v[120:123], v249, s[16:19], s86 offen offset:512
    ds_read_b64_tr_b16 a[160:161], v16 offset:12288
    ds_read_b64_tr_b16 a[162:163], v16 offset:14336
    ds_read_b64_tr_b16 a[164:165], v17 offset:12288
    ds_read_b64_tr_b16 a[166:167], v17 offset:14336
    ds_read_b64_tr_b16 a[168:169], v18 offset:12288
    v_pk_mul_f32 v[232:233], v[232:233], v[238:239] op_sel:[0,0] op_sel_hi:[1,0]
    v_pk_mul_f32 v[170:171], v[170:171], v[174:175] op_sel:[0,0] op_sel_hi:[1,0]
    v_pk_mul_f32 v[234:235], v[234:235], v[238:239] op_sel:[0,0] op_sel_hi:[1,0]
    v_pk_mul_f32 v[172:173], v[172:173], v[174:175] op_sel:[0,0] op_sel_hi:[1,0]
    v_pk_mul_f32 v[236:237], v[236:237], v[238:239] op_sel:[0,0] op_sel_hi:[1,0]
    v_cvt_pk_bf16_f32 v192, v160, v161
    v_cvt_pk_bf16_f32 v193, v162, v163
    v_cvt_pk_bf16_f32 v194, v164, v165
    v_cvt_pk_bf16_f32 v195, v166, v167
    v_cvt_pk_bf16_f32 v196, v168, v169
    v_cvt_pk_bf16_f32 v197, v170, v171
L_pg3:
    s_cbranch_execz L_pg7
    ds_read_b64_tr_b16 a[170:171], v18 offset:14336
    ds_read_b64_tr_b16 a[172:173], v19 offset:12288
    ds_read_b64_tr_b16 a[174:175], v19 offset:14336
    ds_read_b64_tr_b16 a[176:177], v16 offset:28672
    v_cvt_pk_bf16_f32 v198, v172, v173
    v_cvt_pk_bf16_f32 v200, v224, v225
    ds_read_b64_tr_b16 a[178:179], v16 offset:30720
    ds_read_b64_tr_b16 a[180:181], v17 offset:28672
    s_add_u32 m0, s69, 8192
    s_nop 0
    buffer_load_dwordx4 v2, s[20:23], s40 offen offset:0 lds
    ds_read_b64_tr_b16 a[182:183], v17 offset:30720
    ds_read_b64_tr_b16 a[184:185], v18 offset:28672
    ds_read_b64_tr_b16 a[186:187], v18 offset:30720
    ds_read_b64_tr_b16 a[188:189], v19 offset:28672
    ds_read_b64_tr_b16 a[190:191], v19 offset:30720
    ds_read_b64_tr_b16 a[192:193], v16 offset:45056
    ds_read_b64_tr_b16 a[194:195], v16 offset:47104
    ds_read_b64_tr_b16 a[196:197], v17 offset:45056
    ds_read_b64_tr_b16 a[198:199], v17 offset:47104
    ds_read_b64_tr_b16 a[200:201], v18 offset:45056
    ds_read_b64_tr_b16 a[202:203], v18 offset:47104
    ds_read_b64_tr_b16 a[204:205], v19 offset:45056
    ds_read_b64_tr_b16 a[206:207], v19 offset:47104
    ds_read_b64_tr_b16 a[208:209], v16 offset:8192
    buffer_load_dwordx4 v3, s[20:23], s40 offen offset:1024 lds
    ds_read_b64_tr_b16 a[210:211], v16 offset:10240
    ds_read_b64_tr_b16 a[212:213], v17 offset:8192
    ds_read_b64_tr_b16 a[214:215], v17 offset:10240
    ds_read_b64_tr_b16 a[216:217], v18 offset:8192
    ds_read_b64_tr_b16 a[218:219], v18 offset:10240
    v_cvt_pk_bf16_f32 v201, v226, v227
    v_cvt_pk_bf16_f32 v202, v228, v229
    v_cvt_pk_bf16_f32 v203, v230, v231
    v_cvt_pk_bf16_f32 v204, v232, v233
    v_cvt_pk_bf16_f32 v205, v234, v235
    v_cvt_pk_bf16_f32 v206, v236, v237
    ds_read_b64_tr_b16 a[220:221], v19 offset:8192
    ds_read_b64_tr_b16 a[222:223], v19 offset:10240
    s_waitcnt vmcnt(28)
    ds_read_b64_tr_b16 a[0:1], v22 offset:16384
    ds_read_b64_tr_b16 a[2:3], v22 offset:18432
    s_add_u32 m0, s69, 10240
    s_nop 0
    buffer_load_dwordx4 v2, s[20:23], s41 offen offset:0 lds
    ds_read_b64_tr_b16 a[4:5], v23 offset:16384
    ds_read_b64_tr_b16 a[6:7], v23 offset:18432
    ds_read_b64_tr_b16 a[8:9], v22 offset:17408
    ds_read_b64_tr_b16 a[10:11], v22 offset:19456
    ds_read_b64_tr_b16 a[12:13], v23 offset:17408
    ds_read_b64_tr_b16 a[14:15], v23 offset:19456
    s_waitcnt vmcnt(25)
    ds_read_b64_tr_b16 a[16:17], v22 offset:20480
    ds_read_b64_tr_b16 a[18:19], v22 offset:22528
    buffer_load_dwordx4 v3, s[20:23], s41 offen offset:1024 lds
    ds_read_b64_tr_b16 a[20:21], v23 offset:20480
    ds_read_b64_tr_b16 a[22:23], v23 offset:22528
    ds_read_b64_tr_b16 a[24:25], v22 offset:21504
    ds_read_b64_tr_b16 a[26:27], v22 offset:23552
    ds_read_b64_tr_b16 a[28:29], v23 offset:21504
    ds_read_b64_tr_b16 a[30:31], v23 offset:23552
    s_waitcnt vmcnt(16)
    ds_read_b64_tr_b16 a[32:33], v22 offset:12288
    ds_read_b64_tr_b16 a[34:35], v22 offset:14336
    ds_read_b64_tr_b16 a[36:37], v23 offset:12288
    ds_read_b64_tr_b16 a[38:39], v23 offset:14336
    ds_read_b64_tr_b16 a[40:41], v22 offset:13312
    ds_read_b64_tr_b16 a[42:43], v22 offset:15360
    ds_read_b64_tr_b16 a[44:45], v23 offset:13312
    ds_read_b64_tr_b16 a[46:47], v23 offset:15360
    s_waitcnt lgkmcnt(0)
    s_add_u32 m0, s69, 12288
    s_nop 0
    buffer_load_dwordx4 v2, s[20:23], s44 offen offset:0 lds
    ds_read_b64_tr_b16 v[136:137], v16 offset:24576
    ds_read_b64_tr_b16 v[138:139], v16 offset:26624
    ds_read_b64_tr_b16 v[140:141], v17 offset:24576
    ds_read_b64_tr_b16 v[142:143], v17 offset:26624
    ds_read_b64_tr_b16 v[144:145], v18 offset:24576
    ds_read_b64_tr_b16 v[146:147], v18 offset:26624
    ds_read_b64_tr_b16 v[148:149], v19 offset:24576
    ds_read_b64_tr_b16 v[150:151], v19 offset:26624
    buffer_load_dwordx4 v3, s[20:23], s44 offen offset:1024 lds
    ds_read_b64_tr_b16 v[152:153], v16 offset:40960
    ds_read_b64_tr_b16 v[154:155], v16 offset:43008
    ds_read_b64_tr_b16 v[156:157], v17 offset:40960
    ds_read_b64_tr_b16 v[158:159], v17 offset:43008
    ds_read_b64_tr_b16 v[160:161], v18 offset:40960
    ds_read_b64_tr_b16 v[162:163], v18 offset:43008
    ds_read_b64_tr_b16 v[164:165], v19 offset:40960
    ds_read_b64_tr_b16 v[166:167], v19 offset:43008
    s_add_u32 m0, s69, 20480
    s_add_u32 s12, s28, 344064
    s_addc_u32 s13, s29, 0
    global_load_lds_dwordx4 v8, s[12:13] offset:0
    ds_read_b64_tr_b16 v[168:169], v16 offset:49152
    ds_read_b64_tr_b16 v[170:171], v16 offset:51200
    s_nop 0
    ds_read_b64_tr_b16 v[172:173], v17 offset:49152
    ds_read_b64_tr_b16 v[174:175], v17 offset:51200
    ds_read_b64_tr_b16 v[176:177], v18 offset:49152
    ds_read_b64_tr_b16 v[178:179], v18 offset:51200
    ds_read_b64_tr_b16 v[180:181], v19 offset:49152
    ds_read_b64_tr_b16 v[182:183], v19 offset:51200
    ds_read_b64_tr_b16 v[216:217], v16 offset:4096
    global_load_lds_dwordx4 v9, s[12:13] offset:1024
    ds_read_b64_tr_b16 v[218:219], v16 offset:6144
    ds_read_b64_tr_b16 v[220:221], v17 offset:4096
    ds_read_b64_tr_b16 v[222:223], v17 offset:6144
    ds_read_b64_tr_b16 v[224:225], v18 offset:4096
    ds_read_b64_tr_b16 v[226:227], v18 offset:6144
    ds_read_b64_tr_b16 v[228:229], v19 offset:4096
    ds_read_b64_tr_b16 v[230:231], v19 offset:6144
    s_nop 0
    s_waitcnt vmcnt(8)
L_kv2_C:
    v_max3_u32 v28, v108, v109, v110
    v_max3_u32 v29, v111, v112, v113
    v_max3_u32 v28, v28, v114, v115
    v_max3_u32 v29, v29, v116, v117
    v_max3_u32 v28, v28, v118, v119
    v_max3_u32 v29, v29, v120, v121
    v_max3_u32 v28, v28, v122, v123
    v_max_u32_e64 v28, v28, v29
    v_cmp_eq_u32 vcc, -1, v28
    s_cbranch_vccnz L_kv2_S
L_kv2_K:
    v_mfma_f32_32x32x16_bf16 v[32:47], v[108:111], v[192:195], 0
    buffer_load_dword v73, v72, s[16:19], 0 offen
    v_mfma_f32_32x32x16_bf16 v[32:47], v[112:115], v[196:199], v[32:47]
    v_mfma_f32_32x32x16_bf16 v[32:47], v[116:119], v[200:203], v[32:47]
    v_mfma_f32_32x32x16_bf16 v[32:47], v[120:123], v[204:207], v[32:47]
    s_nop 11
    v_mov_b32 v28, v44
    v_mov_b32 v29, v44
    s_nop 1
    v_permlane32_swap_b32 v28, v29
    v_add_f32 v29, 0x358637bd, v29
    v_rcp_f32_e64 v29, v29
    s_nop 0
    v_pk_mul_f32 v[32:33], v[32:33], v[28:29] op_sel:[0,1] op_sel_hi:[1,1]
    v_pk_mul_f32 v[34:35], v[34:35], v[28:29] op_sel:[0,1] op_sel_hi:[1,1]
    v_pk_mul_f32 v[36:37], v[36:37], v[28:29] op_sel:[0,1] op_sel_hi:[1,1]
    v_pk_mul_f32 v[38:39], v[38:39], v[28:29] op_sel:[0,1] op_sel_hi:[1,1]
    v_pk_mul_f32 v[40:41], v[40:41], v[28:29] op_sel:[0,1] op_sel_hi:[1,1]
    v_pk_mul_f32 v[42:43], v[42:43], v[28:29] op_sel:[0,1] op_sel_hi:[1,1]
    v_pk_mul_f32 v[44:45], v[44:45], v[28:29] op_sel:[0,1] op_sel_hi:[1,1]
    v_pk_mul_f32 v[46:47], v[46:47], v[28:29] op_sel:[0,1] op_sel_hi:[1,1]
    v_cvt_pk_bf16_f32 v48, v32, v33
    v_cvt_pk_bf16_f32 v49, v34, v35
    v_cvt_pk_bf16_f32 v50, v36, v37
    v_cvt_pk_bf16_f32 v51, v38, v39
    v_cvt_pk_bf16_f32 v52, v40, v41
    v_cvt_pk_bf16_f32 v53, v42, v43
    v_cvt_pk_bf16_f32 v54, v44, v45
    v_cvt_pk_bf16_f32 v55, v46, v47
    v_or_b32_sdwa v48, v32, 1 dst_sel:WORD_0 dst_unused:UNUSED_PRESERVE src0_sel:WORD_1 src1_sel:DWORD
    v_or_b32_sdwa v52, v40, 1 dst_sel:WORD_0 dst_unused:UNUSED_PRESERVE src0_sel:WORD_1 src1_sel:DWORD
    s_cmp_eq_u32 s34, 0
    s_cbranch_scc1 L_rem_1
    buffer_store_dwordx4 v[48:51], v24, s[16:19], 0 offen
    buffer_store_dwordx4 v[52:55], v25, s[16:19], 0 offen
    buffer_store_dwordx2 v[52:53], v26, s[16:19], 0 offen
L_std_2:
    s_cmp_ge_u32 s61, 28
    s_cbranch_scc1 L_spare
    s_lshl3_add_u32 s94, s66, s94
    ds_read_b64_tr_b16 v[232:233], v16 offset:20480
    s_nop 0
    ds_read_b64_tr_b16 v[234:235], v16 offset:22528
    ds_read_b64_tr_b16 v[236:237], v17 offset:20480
    ds_read_b64_tr_b16 v[238:239], v17 offset:22528
    ds_read_b64_tr_b16 v[240:241], v18 offset:20480
    ds_read_b64_tr_b16 v[242:243], v18 offset:22528
    ds_read_b64_tr_b16 v[244:245], v19 offset:20480
    ds_read_b64_tr_b16 v[246:247], v19 offset:22528
    ds_read_b64_tr_b16 v[184:185], v16 offset:36864
    ds_read_b64_tr_b16 v[186:187], v16 offset:38912
    ds_read_b64_tr_b16 v[188:189], v17 offset:36864
    ds_read_b64_tr_b16 v[190:191], v17 offset:38912
    ds_read_b64_tr_b16 v[192:193], v18 offset:36864
    ds_read_b64_tr_b16 v[194:195], v18 offset:38912
    ds_read_b64_tr_b16 v[196:197], v19 offset:36864
    ds_read_b64_tr_b16 v[198:199], v19 offset:38912
    global_load_lds_dwordx4 v10, s[12:13] offset:2048
    ds_read_b64_tr_b16 v[200:201], v16 offset:53248
    v_accvgpr_read_b32 v24, a233
    v_accvgpr_read_b32 v25, a234
    v_mov_b32 v248, s80
    v_mov_b32 v249, s80
    v_mov_b32 v250, s80
    v_mov_b32 v251, s80
    ds_read_b64_tr_b16 v[202:203], v16 offset:55296
    ds_read_b64_tr_b16 v[204:205], v17 offset:53248
    ds_read_b64_tr_b16 v[206:207], v17 offset:55296
    ds_read_b64_tr_b16 v[208:209], v18 offset:53248
    ds_read_b64_tr_b16 v[210:211], v18 offset:55296
    ds_read_b64_tr_b16 v[212:213], v19 offset:53248
    global_load_lds_dwordx4 v11, s[12:13] offset:3072
    ds_read_b64_tr_b16 v[214:215], v19 offset:55296
    v_lshlrev_b32 v32, 16, v64
    v_and_b32 v33, 0xffff0000, v64
    v_lshlrev_b32 v34, 16, v65
    v_and_b32 v35, 0xffff0000, v65
    v_lshlrev_b32 v36, 16, v66
    v_and_b32 v37, 0xffff0000, v66
    v_lshlrev_b32 v38, 16, v67
    v_and_b32 v39, 0xffff0000, v67
    v_lshlrev_b32_e64 v40, 16, v68
    v_and_b32 v41, 0xffff0000, v68
    v_lshlrev_b32_e64 v42, 16, v69
    v_and_b32 v43, 0xffff0000, v69
    s_add_u32 m0, s69, 16384
    s_add_u32 s12, s28, 458752
    s_addc_u32 s13, s29, 0
    global_load_lds_dwordx4 v8, s[12:13] offset:0
    v_lshlrev_b32 v44, 16, v70
    v_and_b32 v45, 0xffff0000, v70
    v_lshlrev_b32_e64 v46, 16, v71
    v_and_b32 v47, 0xffff0000, v71
    s_waitcnt vmcnt(6)
L_d2_C:
    v_cmp_ne_u32_e64 vcc, s67, v73
    s_cbranch_vccnz L_d2_S
L_d2_K:
    v_add_u32 v16, 49152, v12
    v_add_u32 v17, 49152, v13
    v_add_u32 v18, 49152, v14
    v_add_u32 v19, 49152, v15
    s_lshl_b32 s3, s62, 5
    global_load_lds_dwordx4 v9, s[12:13] offset:1024
    v_xor_b32 v68, s3, v12
    v_add_u32 v69, 49152, v68
    s_add_u32 s3, s78, 155648
    v_add_u32 v70, s3, v1
    s_mov_b32 s84, 0x06543210
    s_mov_b32 s85, 0x654321
    s_lshl_b32 s87, s66, 2
    s_lshr_b64 s[84:85], s[84:85], s87
    s_and_b32 s87, s68, 12
    s_cmp_eq_u32 s87, 0
    s_cselect_b32 s84, 17060706, s84
    s_cmp_eq_u32 s87, 12
    s_cselect_b32 s84, 106049856, s84
    s_mul_i32 s85, s62, 14336
    s_lshl_b32 s87, s66, 7
    s_add_u32 s85, s85, s87
    global_load_lds_dwordx4 v10, s[12:13] offset:2048
    global_load_lds_dwordx4 v11, s[12:13] offset:3072
    v_add_u32 v21, 2097152, v1
    buffer_load_dwordx4 v[80:83], v21, s[16:19], s77 offen offset:0 sc1
    s_waitcnt lgkmcnt(0)
    s_barrier
    buffer_load_dwordx4 v[84:87], v21, s[16:19], s88 offen offset:0 sc1
    buffer_load_dwordx4 v[88:91], v21, s[16:19], s89 offen offset:0 sc1
    buffer_load_dwordx4 v[92:95], v21, s[16:19], s77 offen offset:3072 sc1
    buffer_load_dwordx4 v[96:99], v21, s[16:19], s88 offen offset:3072 sc1
    buffer_load_dwordx4 v[100:103], v21, s[16:19], s89 offen offset:3072 sc1
    s_waitcnt vmcnt(5)
    v_max_u32 v254, v80, v82
    v_cmp_eq_u32 vcc, -1, v254
    s_cbranch_vccnz L_p3_S0
L_p3_K0:
    v_mfma_f32_16x16x32_bf16 v[32:35], a[112:115], v[80:83], v[32:35]
    v_mfma_f32_16x16x32_bf16 v[36:39], a[116:119], v[80:83], v[36:39]
    v_mfma_f32_16x16x32_bf16 v[40:43], a[120:123], v[80:83], v[40:43]
    buffer_load_dwordx4 v[104:107], v21, s[16:19], s77 offen offset:2048 sc1
    ds_read_b64_tr_b16 a[48:49], v22 offset:20480
    ds_read_b64_tr_b16 a[50:51], v22 offset:22528
    ds_read_b64_tr_b16 a[52:53], v23 offset:20480
    s_waitcnt vmcnt(5)
    v_max_u32_e64 v254, v84, v86
    v_cmp_eq_u32_e64 vcc, -1, v254
    v_mfma_f32_16x16x32_bf16 v[44:47], a[124:127], v[80:83], v[44:47]
    s_cbranch_vccnz L_p3_S1
L_p3_K1:
    v_mfma_f32_16x16x32_bf16 v[32:35], a[128:131], v[84:87], v[32:35]
    v_mfma_f32_16x16x32_bf16 v[36:39], a[132:135], v[84:87], v[36:39]
    buffer_load_dwordx4 v[108:111], v21, s[16:19], s88 offen offset:2048 sc1
    ds_read_b64_tr_b16 v[48:49], v68 offset:0
    ds_read_b64_tr_b16 v[50:51], v68 offset:24576
    ds_read_b64_tr_b16 v[52:53], v69 offset:0
    ds_read_b64_tr_b16 v[54:55], v69 offset:24576
    v_mfma_f32_16x16x32_bf16 v[40:43], a[136:139], v[84:87], v[40:43]
    s_waitcnt vmcnt(5)
    v_max_u32 v254, v88, v90
    v_cmp_eq_u32 vcc, -1, v254
    v_mfma_f32_16x16x32_bf16 v[44:47], a[140:143], v[84:87], v[44:47]
    s_cbranch_vccnz L_p3_S2
L_p3_K2:
    buffer_load_dwordx4 v[112:115], v21, s[16:19], s89 offen offset:2048 sc1
    s_waitcnt lgkmcnt(2)
    v_mfma_f32_16x16x32_bf16 v[64:67], v[48:51], v[248:251], 0
    ds_read_b64_tr_b16 v[48:49], v68 offset:4096
    ds_read_b64_tr_b16 v[50:51], v68 offset:28672
    s_waitcnt lgkmcnt(2)
    v_mfma_f32_16x16x32_bf16 v[64:67], v[52:55], v[248:251], v[64:67]
    ds_read_b64_tr_b16 v[56:57], v68 offset:2048
    ds_read_b64_tr_b16 v[58:59], v68 offset:26624
    v_mfma_f32_16x16x32_bf16 v[32:35], a[144:147], v[88:91], v[32:35]
    ds_read_b64_tr_b16 v[60:61], v69 offset:2048
    ds_read_b64_tr_b16 v[62:63], v69 offset:26624
    v_mfma_f32_16x16x32_bf16 v[36:39], a[148:151], v[88:91], v[36:39]
    v_mfma_f32_16x16x32_bf16 v[40:43], a[152:155], v[88:91], v[40:43]
    s_waitcnt vmcnt(5)
    v_max_u32_e64 v254, v92, v94
    v_cmp_eq_u32_e64 vcc, -1, v254
    v_mfma_f32_16x16x32_bf16 v[44:47], a[156:159], v[88:91], v[44:47]
    s_cbranch_vccnz L_p3_S3
L_p3_K3:
    buffer_load_dwordx4 v[116:119], v21, s[16:19], s90 offen offset:0 sc1
    s_waitcnt lgkmcnt(2)
    v_mfma_f32_16x16x32_bf16 v[64:67], v[56:59], v[248:251], v[64:67]
    s_nop 0
    ds_read_b64_tr_b16 v[52:53], v69 offset:4096
    ds_read_b64_tr_b16 v[54:55], v69 offset:28672
    v_mfma_f32_16x16x32_bf16 v[32:35], a[160:163], v[92:95], v[32:35]
    ds_read_b64_tr_b16 v[56:57], v68 offset:6144
    ds_read_b64_tr_b16 v[58:59], v68 offset:30720
    v_mfma_f32_16x16x32_bf16 v[36:39], a[164:167], v[92:95], v[36:39]
    v_mfma_f32_16x16x32_bf16 v[40:43], a[168:171], v[92:95], v[40:43]
    s_waitcnt vmcnt(5)
    v_max_u32 v254, v96, v98
    v_cmp_eq_u32_e64 vcc, -1, v254
    v_mfma_f32_16x16x32_bf16 v[44:47], a[172:175], v[92:95], v[44:47]
    s_cbranch_vccnz L_p3_S4
L_p3_K4:
    buffer_load_dwordx4 v[120:123], v21, s[16:19], s77 offen offset:1024 sc1
    s_waitcnt lgkmcnt(4)
    v_mfma_f32_16x16x32_bf16 v[64:67], v[60:63], v[248:251], v[64:67]
    ds_read_b64_tr_b16 v[60:61], v69 offset:6144
    ds_read_b64_tr_b16 v[62:63], v69 offset:30720
    v_mfma_f32_16x16x32_bf16 v[32:35], a[176:179], v[96:99], v[32:35]
    ds_read_b64_tr_b16 a[54:55], v23 offset:22528
    ds_read_b64_tr_b16 a[56:57], v22 offset:21504
    v_mfma_f32_16x16x32_bf16 v[36:39], a[180:183], v[96:99], v[36:39]
    v_mfma_f32_16x16x32_bf16 v[40:43], a[184:187], v[96:99], v[40:43]
    s_waitcnt vmcnt(5)
    v_max_u32 v254, v100, v102
    v_cmp_eq_u32 vcc, -1, v254
    v_mfma_f32_16x16x32_bf16 v[44:47], a[188:191], v[96:99], v[44:47]
    s_cbranch_vccnz L_p3_S5
L_p3_K5:
    v_mfma_f32_16x16x32_bf16 v[64:67], v[48:51], v[248:251], v[64:67]
    buffer_load_dwordx4 v[124:127], v21, s[16:19], s88 offen offset:1024 sc1
    v_mfma_f32_16x16x32_bf16 v[32:35], a[192:195], v[100:103], v[32:35]
    ds_read_b64_tr_b16 v[48:49], v68 offset:8192
    ds_read_b64_tr_b16 v[50:51], v68 offset:32768
    v_mfma_f32_16x16x32_bf16 v[36:39], a[196:199], v[100:103], v[36:39]
    ds_read_b64_tr_b16 a[58:59], v22 offset:23552
    ds_read_b64_tr_b16 a[60:61], v23 offset:21504
    v_mfma_f32_16x16x32_bf16 v[40:43], a[200:203], v[100:103], v[40:43]
    s_waitcnt vmcnt(5)
    v_max_u32 v254, v104, v106
    v_cmp_eq_u32_e64 vcc, -1, v254
    v_mfma_f32_16x16x32_bf16 v[44:47], a[204:207], v[100:103], v[44:47]
    s_cbranch_vccnz L_p3_S6
L_p3_K6:
    buffer_load_dwordx4 v[128:131], v21, s[16:19], s89 offen offset:1024 sc1
    s_waitcnt lgkmcnt(8)
    v_mfma_f32_16x16x32_bf16 v[64:67], v[52:55], v[248:251], v[64:67]
    ds_read_b64_tr_b16 v[52:53], v69 offset:8192
    ds_read_b64_tr_b16 v[54:55], v69 offset:32768
    v_mfma_f32_16x16x32_bf16 v[32:35], a[208:211], v[104:107], v[32:35]
    ds_read_b64_tr_b16 a[62:63], v23 offset:23552
    v_mfma_f32_16x16x32_bf16 v[36:39], a[212:215], v[104:107], v[36:39]
    v_mfma_f32_16x16x32_bf16 v[40:43], a[216:219], v[104:107], v[40:43]
    s_waitcnt vmcnt(5)
    v_max_u32 v254, v108, v110
    v_cmp_eq_u32 vcc, -1, v254
    v_mfma_f32_16x16x32_bf16 v[44:47], a[220:223], v[104:107], v[44:47]
    s_cbranch_vccnz L_p3_S7
L_p3_K7:
    buffer_load_dwordx4 v[132:135], v21, s[16:19], s90 offen offset:1024 sc1
    v_mfma_f32_16x16x32_bf16 v[64:67], v[56:59], v[248:251], v[64:67]
    ds_read_b64_tr_b16 v[56:57], v68 offset:10240
    ds_read_b64_tr_b16 v[58:59], v68 offset:34816
    ds_read_b64_tr_b16 a[64:65], v22 offset:16384
    v_mfma_f32_16x16x32_bf16 v[32:35], v[136:139], v[108:111], v[32:35]
    s_mov_b32 s20, s48
    s_mov_b32 s21, s49
    s_mov_b32 s22, 401408
    v_mfma_f32_16x16x32_bf16 v[36:39], v[140:143], v[108:111], v[36:39]
    s_add_u32 m0, s33, 98304
    s_bfe_u32 s87, s84, 262144
    s_lshl_b32 s36, s87, 11
    v_mfma_f32_16x16x32_bf16 v[40:43], v[144:147], v[108:111], v[40:43]
    s_mul_i32 s87, s87, 57344
    s_add_u32 s36, s36, s77
    s_add_u32 s87, s87, s85
    buffer_load_dwordx4 v2, s[20:23], s87 offen offset:0 lds
    ds_read_b64_tr_b16 a[66:67], v22 offset:18432
    s_waitcnt vmcnt(6)
    v_max_u32 v254, v112, v114
    v_cmp_eq_u32 vcc, -1, v254
    v_mfma_f32_16x16x32_bf16 v[44:47], v[148:151], v[108:111], v[44:47]
    s_cbranch_vccnz L_p3_S8
L_p3_K8:
    s_waitcnt lgkmcnt(13)
    v_mfma_f32_16x16x32_bf16 v[64:67], v[60:63], v[248:251], v[64:67]
    buffer_load_dwordx4 v3, s[20:23], s87 offen offset:1024 lds
    v_mfma_f32_16x16x32_bf16 v[32:35], v[152:155], v[112:115], v[32:35]
    ds_read_b64_tr_b16 v[60:61], v69 offset:10240
    ds_read_b64_tr_b16 v[62:63], v69 offset:34816
    v_mfma_f32_16x16x32_bf16 v[36:39], v[156:159], v[112:115], v[36:39]
    ds_read_b64_tr_b16 a[68:69], v23 offset:16384
    ds_read_b64_tr_b16 a[70:71], v23 offset:18432
    v_mfma_f32_16x16x32_bf16 v[40:43], v[160:163], v[112:115], v[40:43]
    s_waitcnt vmcnt(6)
    v_max_u32 v254, v116, v118
    v_cmp_eq_u32 vcc, -1, v254
    v_mfma_f32_16x16x32_bf16 v[44:47], v[164:167], v[112:115], v[44:47]
    s_add_u32 m0, s33, 106496
    s_bfe_u32 s87, s84, 262148
    s_lshl_b32 s37, s87, 11
    s_mul_i32 s87, s87, 57344
    s_add_u32 s37, s37, s77
    s_add_u32 s87, s87, s85
    buffer_load_dwordx4 v2, s[20:23], s87 offen offset:0 lds
    s_cbranch_vccnz L_p3_S9
L_p3_K9:
    s_waitcnt lgkmcnt(13)
    v_mfma_f32_16x16x32_bf16 v[64:67], v[48:51], v[248:251], v[64:67]
    ds_read_b64_tr_b16 v[48:49], v68 offset:12288
    ds_read_b64_tr_b16 v[50:51], v68 offset:36864
    v_mfma_f32_16x16x32_bf16 v[32:35], v[168:171], v[116:119], v[32:35]
    buffer_load_dwordx4 v3, s[20:23], s87 offen offset:1024 lds
    v_mfma_f32_16x16x32_bf16 v[36:39], v[172:175], v[116:119], v[36:39]
    ds_read_b64_tr_b16 a[72:73], v22 offset:17408
    ds_read_b64_tr_b16 a[74:75], v22 offset:19456
    v_mfma_f32_16x16x32_bf16 v[40:43], v[176:179], v[116:119], v[40:43]
    s_waitcnt vmcnt(7)
    v_max_u32 v254, v120, v122
    v_cmp_eq_u32 vcc, -1, v254
    v_mfma_f32_16x16x32_bf16 v[44:47], v[180:183], v[116:119], v[44:47]
    s_cbranch_vccnz L_p3_S10
L_p3_K10:
    s_waitcnt lgkmcnt(13)
    s_add_u32 m0, s33, 114688
    v_mfma_f32_16x16x32_bf16 v[64:67], v[52:55], v[248:251], v[64:67]
    s_bfe_u32 s87, s84, 262152
    s_lshl_b32 s38, s87, 11
    s_mul_i32 s87, s87, 57344
    s_add_u32 s38, s38, s77
    s_add_u32 s87, s87, s85
    v_mfma_f32_16x16x32_bf16 v[32:35], v[216:219], v[120:123], v[32:35]
    buffer_load_dwordx4 v2, s[20:23], s87 offen offset:0 lds
    ds_read_b64_tr_b16 v[52:53], v69 offset:12288
    ds_read_b64_tr_b16 v[54:55], v69 offset:36864
    v_mfma_f32_16x16x32_bf16 v[36:39], v[220:223], v[120:123], v[36:39]
    ds_read_b64_tr_b16 a[76:77], v23 offset:17408
    ds_read_b64_tr_b16 a[78:79], v23 offset:19456
    v_mfma_f32_16x16x32_bf16 v[40:43], v[224:227], v[120:123], v[40:43]
    s_waitcnt vmcnt(7)
    buffer_load_dwordx4 v3, s[20:23], s87 offen offset:1024 lds
    v_max_u32 v254, v124, v126
    v_cmp_eq_u32 vcc, -1, v254
    v_mfma_f32_16x16x32_bf16 v[44:47], v[228:231], v[120:123], v[44:47]
    s_cbranch_vccnz L_p3_S11
L_p3_K11:
    s_waitcnt lgkmcnt(14)
    ds_read_b64_tr_b16 a[112:113], v12 offset:0
    v_mfma_f32_16x16x32_bf16 v[64:67], v[56:59], v[248:251], v[64:67]
    s_add_u32 m0, s33, 122880
    s_bfe_u32 s87, s84, 262156
    s_lshl_b32 s39, s87, 11
    v_mfma_f32_16x16x32_bf16 v[32:35], v[232:235], v[124:127], v[32:35]
    s_mul_i32 s87, s87, 57344
    s_add_u32 s39, s39, s77
    s_add_u32 s87, s87, s85
    v_mfma_f32_16x16x32_bf16 v[36:39], v[236:239], v[124:127], v[36:39]
    buffer_load_dwordx4 v2, s[20:23], s87 offen offset:0 lds
    ds_read_b64_tr_b16 a[114:115], v12 offset:24576
    ds_read_b64_tr_b16 a[116:117], v13 offset:0
    ds_read_b64_tr_b16 a[118:119], v13 offset:24576
    v_mfma_f32_16x16x32_bf16 v[40:43], v[240:243], v[124:127], v[40:43]
    s_waitcnt vmcnt(8)
    buffer_load_dwordx4 v3, s[20:23], s87 offen offset:1024 lds
    v_max_u32 v254, v128, v130
    v_cmp_eq_u32 vcc, -1, v254
    v_mfma_f32_16x16x32_bf16 v[44:47], v[244:247], v[124:127], v[44:47]
    s_cbranch_vccnz L_p3_S12
L_p3_K12:
    s_waitcnt lgkmcnt(14)
    ds_read_b64_tr_b16 a[120:121], v14 offset:0
    ds_read_b64_tr_b16 a[122:123], v14 offset:24576
    v_mfma_f32_16x16x32_bf16 v[64:67], v[60:63], v[248:251], v[64:67]
    s_add_u32 m0, s33, 131072
    s_bfe_u32 s87, s84, 262160
    s_lshl_b32 s86, s87, 11
    v_mfma_f32_16x16x32_bf16 v[32:35], v[184:187], v[128:131], v[32:35]
    s_mul_i32 s87, s87, 57344
    s_add_u32 s86, s86, s77
    s_add_u32 s87, s87, s85
    v_mfma_f32_16x16x32_bf16 v[36:39], v[188:191], v[128:131], v[36:39]
    buffer_load_dwordx4 v2, s[20:23], s87 offen offset:0 lds
    ds_read_b64_tr_b16 a[124:125], v15 offset:0
    ds_read_b64_tr_b16 a[126:127], v15 offset:24576
    v_mfma_f32_16x16x32_bf16 v[40:43], v[192:195], v[128:131], v[40:43]
    s_waitcnt vmcnt(9)
    v_max_u32 v254, v132, v134
    v_cmp_eq_u32_e64 vcc, -1, v254
    v_mfma_f32_16x16x32_bf16 v[44:47], v[196:199], v[128:131], v[44:47]
    s_cbranch_vccnz L_p3_S13
L_p3_K13:
    s_waitcnt lgkmcnt(14)
    v_mfma_f32_16x16x32_bf16 v[64:67], v[48:51], v[248:251], v[64:67]
    v_mfma_f32_16x16x32_bf16 v[32:35], v[200:203], v[132:135], v[32:35]
    buffer_load_dwordx4 v3, s[20:23], s87 offen offset:1024 lds
    ds_read_b64_tr_b16 a[128:129], v16 offset:0
    ds_read_b64_tr_b16 a[130:131], v16 offset:24576
    v_mfma_f32_16x16x32_bf16 v[36:39], v[204:207], v[132:135], v[36:39]
    ds_read_b64_tr_b16 a[132:133], v17 offset:0
    ds_read_b64_tr_b16 a[134:135], v17 offset:24576
    v_mfma_f32_16x16x32_bf16 v[40:43], v[208:211], v[132:135], v[40:43]
    s_add_u32 m0, s33, 139264
    s_bfe_u32 s87, s84, 262164
    s_lshl_b32 s41, s87, 11
    v_mfma_f32_16x16x32_bf16 v[44:47], v[212:215], v[132:135], v[44:47]
    s_mul_i32 s87, s87, 57344
    s_add_u32 s41, s41, s77
    s_add_u32 s87, s87, s85
    buffer_load_dwordx4 v2, s[20:23], s87 offen offset:0 lds
    s_waitcnt lgkmcnt(14)
    v_mfma_f32_16x16x32_bf16 v[64:67], v[52:55], v[248:251], v[64:67]
    v_cvt_pk_bf16_f32 v80, v32, v33
    v_cvt_pk_bf16_f32 v81, v34, v35
    v_cvt_pk_bf16_f32 v82, v36, v37
    v_cvt_pk_bf16_f32 v83, v38, v39
    v_cvt_pk_bf16_f32 v84, v40, v41
    v_cvt_pk_bf16_f32 v85, v42, v43
    v_cvt_pk_bf16_f32 v86, v44, v45
    v_cvt_pk_bf16_f32 v87, v46, v47
    v_or_b32_sdwa v80, v32, 1 dst_sel:WORD_0 dst_unused:UNUSED_PRESERVE src0_sel:WORD_1 src1_sel:DWORD
    v_or_b32_sdwa v84, v40, 1 dst_sel:WORD_0 dst_unused:UNUSED_PRESERVE src0_sel:WORD_1 src1_sel:DWORD
    s_add_u32 s4, s93, 4194304
    s_cmp_eq_u32 s34, 0
    s_cbranch_scc1 L_rem_3
    buffer_store_dwordx4 v[80:83], v1, s[16:19], s4 offen offset:0
    buffer_store_dwordx4 v[84:87], v1, s[16:19], s4 offen offset:1024
L_std_4:
    v_add_f32 v48, v32, v34
    v_mul_f32 v50, v32, v32
    v_add_f32 v49, v33, v35
    v_mul_f32 v51, v33, v33
    v_fmac_f32 v50, v34, v34
    v_fmac_f32 v51, v35, v35
    v_add_f32 v48, v48, v36
    v_fmac_f32 v50, v36, v36
    v_add_f32 v49, v49, v37
    v_fmac_f32 v51, v37, v37
    v_add_f32 v48, v48, v38
    v_fmac_f32 v50, v38, v38
    v_add_f32 v49, v49, v39
    v_fmac_f32 v51, v39, v39
    v_add_f32 v48, v48, v40
    v_fmac_f32 v50, v40, v40
    buffer_load_dwordx4 v3, s[20:23], s87 offen offset:1024 lds
    v_add_f32 v49, v49, v41
    v_fmac_f32 v51, v41, v41
    v_add_f32 v48, v48, v42
    v_fmac_f32 v50, v42, v42
    v_add_f32 v49, v49, v43
    v_fmac_f32 v51, v43, v43
    v_add_f32 v48, v48, v44
    v_fmac_f32 v50, v44, v44
    v_add_f32 v49, v49, v45
    v_fmac_f32 v51, v45, v45
    v_add_f32 v48, v48, v46
    v_fmac_f32 v50, v46, v46
    v_add_f32 v49, v49, v47
    v_fmac_f32 v51, v47, v47
    s_add_u32 m0, s33, 147456
    s_bfe_u32 s87, s84, 262168
    s_lshl_b32 s44, s87, 11
    s_mul_i32 s87, s87, 57344
    s_add_u32 s44, s44, s77
    s_add_u32 s87, s87, s85
    buffer_load_dwordx4 v2, s[20:23], s87 offen offset:0 lds
    v_add_f32 v48, v48, v49
    v_add_f32 v49, v50, v51
    v_mov_b32 v50, v48
    v_mov_b32 v51, v49
    s_nop 0
    v_permlane16_swap_b32 v48, v50
    v_permlane16_swap_b32 v49, v51
    v_add_f32 v48, v48, v50
    v_add_f32 v49, v49, v51
    v_mov_b32 v50, v48
    v_mov_b32 v51, v49
    s_nop 0
    buffer_load_dwordx4 v3, s[20:23], s87 offen offset:1024 lds
    v_permlane32_swap_b32 v48, v50
    v_permlane32_swap_b32 v49, v51
    v_add_f32 v48, v48, v50
    v_add_f32 v49, v49, v51
    s_cmp_eq_u32 s34, 0
    s_cbranch_scc1 L_rem_5
    s_add_u32 s4, s94, 33554432
    s_mov_b64 exec, 0xffff
    buffer_store_dwordx2 v[48:49], v20, s[16:19], s4 offen
    s_mov_b64 exec, -1
L_std_6:
    ds_read_b64_tr_b16 a[136:137], v18 offset:0
    ds_read_b64_tr_b16 a[138:139], v18 offset:24576
    ds_read_b64_tr_b16 a[140:141], v19 offset:0
    ds_read_b64_tr_b16 a[142:143], v19 offset:24576
    ds_read_b64_tr_b16 a[144:145], v12 offset:2048
    ds_read_b64_tr_b16 a[146:147], v12 offset:26624
    ds_read_b64_tr_b16 a[148:149], v13 offset:2048
    ds_read_b64_tr_b16 a[150:151], v13 offset:26624
    ds_read_b64_tr_b16 a[152:153], v14 offset:2048
    ds_read_b64_tr_b16 a[154:155], v14 offset:26624
    ds_read_b64_tr_b16 a[156:157], v15 offset:2048
    ds_read_b64_tr_b16 a[158:159], v15 offset:26624
    ds_read_b64_tr_b16 a[160:161], v16 offset:2048
    ds_read_b64_tr_b16 a[162:163], v16 offset:26624
    ds_read_b64_tr_b16 a[164:165], v17 offset:2048
    ds_read_b64_tr_b16 a[166:167], v17 offset:26624
    ds_read_b64_tr_b16 a[168:169], v18 offset:2048
L_pg4:
    s_cbranch_execz L_pg8
    s_barrier
    v_add_u32 v21, 4194304, v1
    s_lshl_b32 s82, s68, 11
    s_nop 0
    v_add_u32 v248, 155648, v1
    s_add_u32 s82, s82, 33554432
    buffer_load_dwordx4 v[88:91], v21, s[16:19], s71 offen offset:0 sc1
    ds_read_b64_tr_b16 a[170:171], v18 offset:26624
    ds_read_b64_tr_b16 a[172:173], v19 offset:2048
    ds_read_b64_tr_b16 a[174:175], v19 offset:26624
    ds_read_b64_tr_b16 a[176:177], v12 offset:4096
    ds_read_b64_tr_b16 a[178:179], v12 offset:28672
    ds_read_b64_tr_b16 a[180:181], v13 offset:4096
    ds_read_b64_tr_b16 a[182:183], v13 offset:28672
    ds_read_b64_tr_b16 a[184:185], v14 offset:4096
    ds_read_b64_tr_b16 a[186:187], v14 offset:28672
    buffer_load_dwordx4 v[92:95], v21, s[16:19], s71 offen offset:1024 sc1
    ds_read_b64_tr_b16 a[188:189], v15 offset:4096
    ds_read_b64_tr_b16 a[190:191], v15 offset:28672
    ds_read_b64_tr_b16 a[192:193], v16 offset:4096
    ds_read_b64_tr_b16 a[194:195], v16 offset:28672
    ds_read_b64_tr_b16 a[196:197], v17 offset:4096
    ds_read_b64_tr_b16 a[198:199], v17 offset:28672
    ds_read_b64_tr_b16 a[200:201], v18 offset:4096
    ds_read_b64_tr_b16 a[202:203], v18 offset:28672
    buffer_load_dwordx4 v[96:99], v21, s[16:19], s72 offen offset:0 sc1
    ds_read_b64_tr_b16 a[204:205], v19 offset:4096
    ds_read_b64_tr_b16 a[206:207], v19 offset:28672
    ds_read_b64_tr_b16 a[208:209], v12 offset:6144
    ds_read_b64_tr_b16 a[210:211], v12 offset:30720
    ds_read_b64_tr_b16 a[212:213], v13 offset:6144
    ds_read_b64_tr_b16 a[214:215], v13 offset:30720
    ds_read_b64_tr_b16 a[216:217], v14 offset:6144
    ds_read_b64_tr_b16 a[218:219], v14 offset:30720
    buffer_load_dwordx4 v[100:103], v21, s[16:19], s72 offen offset:1024 sc1
    ds_read_b64_tr_b16 a[220:221], v15 offset:6144
    ds_read_b64_tr_b16 a[222:223], v15 offset:30720
    ds_read_b64_tr_b16 v[136:137], v16 offset:6144
    ds_read_b64_tr_b16 v[138:139], v16 offset:30720
    ds_read_b64_tr_b16 v[140:141], v17 offset:6144
    ds_read_b64_tr_b16 v[142:143], v17 offset:30720
    ds_read_b64_tr_b16 v[144:145], v18 offset:6144
    ds_read_b64_tr_b16 v[146:147], v18 offset:30720
    buffer_load_dwordx4 v[104:107], v21, s[16:19], s73 offen offset:0 sc1
    ds_read_b64_tr_b16 v[148:149], v19 offset:6144
    ds_read_b64_tr_b16 v[150:151], v19 offset:30720
    ds_read_b64_tr_b16 v[152:153], v12 offset:8192
    ds_read_b64_tr_b16 v[154:155], v12 offset:32768
    ds_read_b64_tr_b16 v[156:157], v13 offset:8192
    ds_read_b64_tr_b16 v[158:159], v13 offset:32768
    ds_read_b64_tr_b16 v[160:161], v14 offset:8192
    ds_read_b64_tr_b16 v[162:163], v14 offset:32768
    buffer_load_dwordx4 v[108:111], v21, s[16:19], s73 offen offset:1024 sc1
    ds_read_b64_tr_b16 v[164:165], v15 offset:8192
    ds_read_b64_tr_b16 v[166:167], v15 offset:32768
    ds_read_b64_tr_b16 v[168:169], v16 offset:8192
    ds_read_b64_tr_b16 v[170:171], v16 offset:32768
    ds_read_b64_tr_b16 v[172:173], v17 offset:8192
    ds_read_b64_tr_b16 v[174:175], v17 offset:32768
    ds_read_b64_tr_b16 v[176:177], v18 offset:8192
    ds_read_b64_tr_b16 v[178:179], v18 offset:32768
    buffer_load_dwordx4 v[112:115], v21, s[16:19], s74 offen offset:0 sc1
    ds_read_b64_tr_b16 v[180:181], v19 offset:8192
    ds_read_b64_tr_b16 v[182:183], v19 offset:32768
    ds_read_b64_tr_b16 v[216:217], v12 offset:10240
    ds_read_b64_tr_b16 v[218:219], v12 offset:34816
    ds_read_b64_tr_b16 v[220:221], v13 offset:10240
    ds_read_b64_tr_b16 v[222:223], v13 offset:34816
    ds_read_b64_tr_b16 v[224:225], v14 offset:10240
    ds_read_b64_tr_b16 v[226:227], v14 offset:34816
    buffer_load_dwordx4 v[116:119], v21, s[16:19], s74 offen offset:1024 sc1
    ds_read_b64_tr_b16 v[228:229], v15 offset:10240
    ds_read_b64_tr_b16 v[230:231], v15 offset:34816
    ds_read_b64_tr_b16 v[232:233], v16 offset:10240
    ds_read_b64_tr_b16 v[234:235], v16 offset:34816
    ds_read_b64_tr_b16 v[236:237], v17 offset:10240
    ds_read_b64_tr_b16 v[238:239], v17 offset:34816
    ds_read_b64_tr_b16 v[240:241], v18 offset:10240
    ds_read_b64_tr_b16 v[242:243], v18 offset:34816
    ds_read_b64_tr_b16 v[244:245], v19 offset:10240
    ds_read_b64_tr_b16 v[246:247], v19 offset:34816
    ds_read_b64_tr_b16 v[184:185], v12 offset:12288
    ds_read_b64_tr_b16 v[186:187], v12 offset:36864
    ds_read_b64_tr_b16 v[188:189], v13 offset:12288
    ds_read_b64_tr_b16 v[190:191], v13 offset:36864
    ds_read_b64_tr_b16 v[192:193], v14 offset:12288
    ds_read_b64_tr_b16 v[194:195], v14 offset:36864
    ds_read_b64_tr_b16 v[196:197], v15 offset:12288
    ds_read_b64_tr_b16 v[198:199], v15 offset:36864
    ds_read_b64_tr_b16 v[200:201], v16 offset:12288
    ds_read_b64_tr_b16 v[202:203], v16 offset:36864
    ds_read_b64_tr_b16 v[204:205], v17 offset:12288
    ds_read_b64_tr_b16 v[206:207], v17 offset:36864
    ds_read_b64_tr_b16 v[208:209], v18 offset:12288
    ds_read_b64_tr_b16 v[210:211], v18 offset:36864
    ds_read_b64_tr_b16 v[212:213], v19 offset:12288
    ds_read_b64_tr_b16 v[214:215], v19 offset:36864
    ds_write_b128 v70, v[64:67]
    v_and_b32 v19, 32, v0
    v_lshlrev_b32 v19, 5, v19
    v_add_u32 v19, 98304, v19
    v_add_u32 v16, v19, v12
    v_add_u32 v17, v19, v13
    v_add_u32 v18, v19, v14
    v_add_u32_e64 v19, v19, v15
    s_waitcnt vmcnt(9) lgkmcnt(0)
    v_mfma_f32_16x16x32_bf16 v[48:51], a[112:115], v[80:83], 0
    s_barrier
    v_mfma_f32_16x16x32_bf16 v[52:55], a[116:119], v[80:83], 0
    v_mfma_f32_16x16x32_bf16 v[56:59], a[120:123], v[80:83], 0
    s_nop 0
    ds_read_b128 v[64:67], v248 offset:0
    ds_read_b128 v[68:71], v248 offset:1024
    v_mfma_f32_16x16x32_bf16 v[60:63], a[124:127], v[80:83], 0
    ds_read_b128 v[72:75], v248 offset:2048
    v_mfma_f32_16x16x32_bf16 v[48:51], a[128:131], v[84:87], v[48:51]
    ds_read_b128 v[76:79], v248 offset:3072
    v_mfma_f32_16x16x32_bf16 v[52:55], a[132:135], v[84:87], v[52:55]
    v_mfma_f32_16x16x32_bf16 v[56:59], a[136:139], v[84:87], v[56:59]
    s_waitcnt vmcnt(7)
    v_cmp_eq_u32 vcc, -1, v88
    v_mfma_f32_16x16x32_bf16 v[60:63], a[140:143], v[84:87], v[60:63]
    s_cbranch_vccnz L_p4_S0
L_p4_K0:
    buffer_load_dwordx4 v[28:31], v20, s[16:19], s82 offen sc1
    v_mfma_f32_16x16x32_bf16 v[48:51], a[144:147], v[88:91], v[48:51]
    s_nop 0
    ds_read_b64_tr_b16 a[112:113], v16 offset:0
    ds_read_b64_tr_b16 a[114:115], v16 offset:1024
    v_mfma_f32_16x16x32_bf16 v[52:55], a[148:151], v[88:91], v[52:55]
    ds_read_b64_tr_b16 a[116:117], v17 offset:0
    ds_read_b64_tr_b16 a[118:119], v17 offset:1024
    v_mfma_f32_16x16x32_bf16 v[56:59], a[152:155], v[88:91], v[56:59]
    s_waitcnt vmcnt(7)
    v_cmp_eq_u32 vcc, -1, v92
    v_mfma_f32_16x16x32_bf16 v[60:63], a[156:159], v[88:91], v[60:63]
    s_cbranch_vccnz L_p4_S1
L_p4_K1:
    buffer_load_dwordx4 v[120:123], v21, s[16:19], s75 offen offset:0 sc1
    v_mfma_f32_16x16x32_bf16 v[48:51], a[160:163], v[92:95], v[48:51]
    s_nop 0
    ds_read_b64_tr_b16 a[120:121], v18 offset:0
    ds_read_b64_tr_b16 a[122:123], v18 offset:1024
    v_mfma_f32_16x16x32_bf16 v[52:55], a[164:167], v[92:95], v[52:55]
    ds_read_b64_tr_b16 a[124:125], v19 offset:0
    ds_read_b64_tr_b16 a[126:127], v19 offset:1024
    v_mfma_f32_16x16x32_bf16 v[56:59], a[168:171], v[92:95], v[56:59]
    s_waitcnt vmcnt(7)
    v_cmp_eq_u32_e64 vcc, -1, v96
    v_mfma_f32_16x16x32_bf16 v[60:63], a[172:175], v[92:95], v[60:63]
    s_cbranch_vccnz L_p4_S2
L_p4_K2:
    buffer_load_dwordx4 v[124:127], v21, s[16:19], s75 offen offset:1024 sc1
    v_mfma_f32_16x16x32_bf16 v[48:51], a[176:179], v[96:99], v[48:51]
    ds_read_b64_tr_b16 a[128:129], v16 offset:4096
    ds_read_b64_tr_b16 a[130:131], v16 offset:5120
    v_mfma_f32_16x16x32_bf16 v[52:55], a[180:183], v[96:99], v[52:55]
    ds_read_b64_tr_b16 a[132:133], v17 offset:4096
    ds_read_b64_tr_b16 a[134:135], v17 offset:5120
    v_mfma_f32_16x16x32_bf16 v[56:59], a[184:187], v[96:99], v[56:59]
    s_waitcnt vmcnt(7)
    v_cmp_eq_u32_e64 vcc, -1, v100
    v_mfma_f32_16x16x32_bf16 v[60:63], a[188:191], v[96:99], v[60:63]
    s_cbranch_vccnz L_p4_S3
L_p4_K3:
    buffer_load_dwordx4 v[128:131], v21, s[16:19], s76 offen offset:0 sc1
    v_mfma_f32_16x16x32_bf16 v[48:51], a[192:195], v[100:103], v[48:51]
    ds_read_b64_tr_b16 a[136:137], v18 offset:4096
    ds_read_b64_tr_b16 a[138:139], v18 offset:5120
    v_mfma_f32_16x16x32_bf16 v[52:55], a[196:199], v[100:103], v[52:55]
    s_nop 0
    ds_read_b64_tr_b16 a[140:141], v19 offset:4096
    ds_read_b64_tr_b16 a[142:143], v19 offset:5120
    v_mfma_f32_16x16x32_bf16 v[56:59], a[200:203], v[100:103], v[56:59]
    s_waitcnt vmcnt(7)
    v_cmp_eq_u32 vcc, -1, v104
    v_mfma_f32_16x16x32_bf16 v[60:63], a[204:207], v[100:103], v[60:63]
    s_cbranch_vccnz L_p4_S4
L_p4_K4:
    buffer_load_dwordx4 v[132:135], v21, s[16:19], s76 offen offset:1024 sc1
    v_mfma_f32_16x16x32_bf16 v[48:51], a[208:211], v[104:107], v[48:51]
    ds_read_b64_tr_b16 a[144:145], v16 offset:8192
    ds_read_b64_tr_b16 a[146:147], v16 offset:9216
    v_mfma_f32_16x16x32_bf16 v[52:55], a[212:215], v[104:107], v[52:55]
    ds_read_b64_tr_b16 a[148:149], v17 offset:8192
    ds_read_b64_tr_b16 a[150:151], v17 offset:9216
    v_mfma_f32_16x16x32_bf16 v[56:59], a[216:219], v[104:107], v[56:59]
    s_waitcnt vmcnt(7)
    v_cmp_eq_u32 vcc, -1, v108
    s_add_u32 m0, s69, 20480
    v_mfma_f32_16x16x32_bf16 v[60:63], a[220:223], v[104:107], v[60:63]
    s_add_u32 s12, s28, 573440
    s_addc_u32 s13, s29, 0
    global_load_lds_dwordx4 v8, s[12:13] offset:0
    s_cbranch_vccnz L_p4_S5
L_p4_K5:
    v_mfma_f32_16x16x32_bf16 v[48:51], v[136:139], v[108:111], v[48:51]
    ds_read_b64_tr_b16 a[152:153], v18 offset:8192
    ds_read_b64_tr_b16 a[154:155], v18 offset:9216
    v_mfma_f32_16x16x32_bf16 v[52:55], v[140:143], v[108:111], v[52:55]
    s_nop 0
    ds_read_b64_tr_b16 a[156:157], v19 offset:8192
    ds_read_b64_tr_b16 a[158:159], v19 offset:9216
    v_mfma_f32_16x16x32_bf16 v[56:59], v[144:147], v[108:111], v[56:59]
    s_waitcnt vmcnt(7)
    global_load_lds_dwordx4 v9, s[12:13] offset:1024
    v_cmp_eq_u32 vcc, -1, v112
    v_mfma_f32_16x16x32_bf16 v[60:63], v[148:151], v[108:111], v[60:63]
    s_cbranch_vccnz L_p4_S6
L_p4_K6:
    v_mfma_f32_16x16x32_bf16 v[48:51], v[152:155], v[112:115], v[48:51]
    s_nop 0
    v_cmp_gt_i32 s[6:7], 0, v24
    v_and_b32 v24, 0x7fffffff, v24
    v_mfma_f32_16x16x32_bf16 v[52:55], v[156:159], v[112:115], v[52:55]
    s_cmp_eq_u32 s34, 0
    v_cmp_gt_i32 s[88:89], 0, v25
    v_and_b32 v25, 0x7fffffff, v25
    v_mfma_f32_16x16x32_bf16 v[56:59], v[160:163], v[112:115], v[56:59]
    s_cselect_b64 s[6:7], -1, s[6:7]
    s_cselect_b64 s[88:89], -1, s[88:89]
    s_waitcnt vmcnt(7)
    global_load_lds_dwordx4 v10, s[12:13] offset:2048
    v_cmp_eq_u32_e64 vcc, -1, v116
    v_mfma_f32_16x16x32_bf16 v[60:63], v[164:167], v[112:115], v[60:63]
    s_cbranch_vccnz L_p4_S7
L_p4_K7:
    ds_read_b64_tr_b16 a[160:161], v16 offset:12288
    ds_read_b64_tr_b16 a[162:163], v16 offset:13312
    v_mfma_f32_16x16x32_bf16 v[48:51], v[168:171], v[116:119], v[48:51]
    ds_read_b64_tr_b16 a[164:165], v17 offset:12288
    v_mfma_f32_16x16x32_bf16 v[52:55], v[172:175], v[116:119], v[52:55]
    v_mfma_f32_16x16x32_bf16 v[56:59], v[176:179], v[116:119], v[56:59]
    s_waitcnt vmcnt(7)
    s_mov_b32 exec_hi, 0xffff
    v_add_f32 v28, v28, v30
    v_add_f32 v29, v29, v31
    s_mov_b32 exec_hi, -1
    global_load_lds_dwordx4 v11, s[12:13] offset:3072
    v_cmp_u_f32_e64 vcc, v28, v29
    s_cbranch_vccnz L_p4_S8
L_p4_K8:
    s_waitcnt vmcnt(7)
    v_cmp_eq_u32 vcc, -1, v120
    v_mfma_f32_16x16x32_bf16 v[60:63], v[180:183], v[116:119], v[60:63]
    s_cbranch_vccnz L_p4_S9
L_p4_K9:
    v_mfma_f32_16x16x32_bf16 v[48:51], v[216:219], v[120:123], v[48:51]
    v_mov_b32_e64 v30, v28
    v_mov_b32 v31, v29
    v_mfma_f32_16x16x32_bf16 v[52:55], v[220:223], v[120:123], v[52:55]
    s_nop 0
    s_add_u32 m0, s69, 16384
    s_add_u32 s12, s28, 688128
    v_mfma_f32_16x16x32_bf16 v[56:59], v[224:227], v[120:123], v[56:59]
    s_addc_u32 s13, s29, 0
    global_load_lds_dwordx4 v8, s[12:13] offset:0
    v_permlane16_swap_b32 v28, v30
    s_waitcnt vmcnt(7)
    v_cmp_eq_u32 vcc, -1, v124
    v_mfma_f32_16x16x32_bf16 v[60:63], v[228:231], v[120:123], v[60:63]
    s_cbranch_vccnz L_p4_S10
L_p4_K10:
    v_mfma_f32_16x16x32_bf16 v[48:51], v[232:235], v[124:127], v[48:51]
    v_permlane16_swap_b32 v29, v31
    v_add_f32_e64 v28, v28, v30
    v_mfma_f32_16x16x32_bf16 v[52:55], v[236:239], v[124:127], v[52:55]
    global_load_lds_dwordx4 v9, s[12:13] offset:1024
    v_add_f32 v29, v29, v31
    v_mfma_f32_16x16x32_bf16 v[56:59], v[240:243], v[124:127], v[56:59]
    v_mov_b32 v30, v28
    s_waitcnt vmcnt(7)
    v_cmp_eq_u32 vcc, -1, v128
    v_mfma_f32_16x16x32_bf16 v[60:63], v[244:247], v[124:127], v[60:63]
    s_cbranch_vccnz L_p4_S11
L_p4_K11:
    v_mfma_f32_16x16x32_bf16 v[48:51], v[184:187], v[128:131], v[48:51]
    v_mov_b32 v31, v29
    s_nop 0
    v_mfma_f32_16x16x32_bf16 v[52:55], v[188:191], v[128:131], v[52:55]
    global_load_lds_dwordx4 v10, s[12:13] offset:2048
    v_permlane32_swap_b32 v28, v30
    v_mfma_f32_16x16x32_bf16 v[56:59], v[192:195], v[128:131], v[56:59]
    v_permlane32_swap_b32 v29, v31
    s_waitcnt vmcnt(7)
    v_cmp_eq_u32 vcc, -1, v132
    v_mfma_f32_16x16x32_bf16 v[60:63], v[196:199], v[128:131], v[60:63]
    s_cbranch_vccnz L_p4_S12
L_p4_K12:
    global_load_lds_dwordx4 v11, s[12:13] offset:3072
    v_mfma_f32_16x16x32_bf16 v[48:51], v[200:203], v[132:135], v[48:51]
    v_add_f32 v28, v28, v30
    v_add_f32 v29, v29, v31
    v_mfma_f32_16x16x32_bf16 v[52:55], v[204:207], v[132:135], v[52:55]
    v_mul_f32 v28, 0x3b124925, v28
    v_mfma_f32_16x16x32_bf16 v[56:59], v[208:211], v[132:135], v[56:59]
    s_nop 0
    v_mov_b32 v30, 0x3727c5ac
    s_add_u32 m0, s69, 0
    v_mfma_f32_16x16x32_bf16 v[60:63], v[212:215], v[132:135], v[60:63]
    s_add_u32 s12, s28, 802816
    v_fmac_f32 v30, 0x3b124925, v29
    v_fma_f32 v29, -v28, v28, v30
    v_rsq_f32 v85, v29
    v_mov_b32 v84, v28
    v_add_f32 v30, 0xb727c5ac, v29
    v_mul_f32 v31, v85, v85
    v_mov_b32 v28, 0x3727c5ac
    v_fmac_f32 v28, v31, v30
    v_rsq_f32 v30, v28
    v_mul_f32 v28, v28, v29
    v_mul_f32 v30, v85, v30
    s_addc_u32 s13, s29, 0
    global_load_lds_dwordx4 v8, s[12:13] offset:0
    s_waitcnt lgkmcnt(15)
    global_load_lds_dwordx4 v9, s[12:13] offset:1024
    v_mul_f32 v82, v28, v30
    v_mul_f32 v80, 0xc0135761, v30
    v_mul_f32 v31, v30, v30
    v_mul_f32 v31, v31, v30
    v_mul_f32 v81, 0xbdd2d3e8, v31
    v_pk_fma_f32 v[48:49], v[64:65], v[84:85], v[48:49] op_sel:[0,0,0] op_sel_hi:[1,0,1] neg_lo:[0,1,0] neg_hi:[0,1,0]
    v_pk_fma_f32 v[50:51], v[66:67], v[84:85], v[50:51] op_sel:[0,0,0] op_sel_hi:[1,0,1] neg_lo:[0,1,0] neg_hi:[0,1,0]
    v_pk_fma_f32 v[52:53], v[68:69], v[84:85], v[52:53] op_sel:[0,0,0] op_sel_hi:[1,0,1] neg_lo:[0,1,0] neg_hi:[0,1,0]
    v_pk_fma_f32 v[54:55], v[70:71], v[84:85], v[54:55] op_sel:[0,0,0] op_sel_hi:[1,0,1] neg_lo:[0,1,0] neg_hi:[0,1,0]
    v_pk_fma_f32 v[56:57], v[72:73], v[84:85], v[56:57] op_sel:[0,0,0] op_sel_hi:[1,0,1] neg_lo:[0,1,0] neg_hi:[0,1,0]
    v_pk_fma_f32 v[58:59], v[74:75], v[84:85], v[58:59] op_sel:[0,0,0] op_sel_hi:[1,0,1] neg_lo:[0,1,0] neg_hi:[0,1,0]
    v_pk_fma_f32 v[60:61], v[76:77], v[84:85], v[60:61] op_sel:[0,0,0] op_sel_hi:[1,0,1] neg_lo:[0,1,0] neg_hi:[0,1,0]
    v_pk_fma_f32 v[62:63], v[78:79], v[84:85], v[62:63] op_sel:[0,0,0] op_sel_hi:[1,0,1] neg_lo:[0,1,0] neg_hi:[0,1,0]
    v_pk_mul_f32 v[100:101], v[48:49], v[48:49]
    v_pk_mul_f32 v[102:103], v[50:51], v[50:51]
    v_pk_mul_f32 v[104:105], v[52:53], v[52:53]
    v_pk_mul_f32 v[106:107], v[54:55], v[54:55]
    v_pk_mul_f32 v[108:109], v[56:57], v[56:57]
    v_pk_mul_f32 v[110:111], v[58:59], v[58:59]
    v_pk_mul_f32 v[112:113], v[60:61], v[60:61]
    v_pk_mul_f32 v[114:115], v[62:63], v[62:63]
    v_pk_fma_f32 v[100:101], v[100:101], v[80:81], v[80:81] op_sel:[0,1,0] op_sel_hi:[1,1,0]
    v_pk_fma_f32 v[102:103], v[102:103], v[80:81], v[80:81] op_sel:[0,1,0] op_sel_hi:[1,1,0]
    v_pk_fma_f32 v[104:105], v[104:105], v[80:81], v[80:81] op_sel:[0,1,0] op_sel_hi:[1,1,0]
    v_pk_fma_f32 v[106:107], v[106:107], v[80:81], v[80:81] op_sel:[0,1,0] op_sel_hi:[1,1,0]
    v_pk_fma_f32 v[108:109], v[108:109], v[80:81], v[80:81] op_sel:[0,1,0] op_sel_hi:[1,1,0]
    v_pk_fma_f32 v[110:111], v[110:111], v[80:81], v[80:81] op_sel:[0,1,0] op_sel_hi:[1,1,0]
    v_pk_fma_f32 v[112:113], v[112:113], v[80:81], v[80:81] op_sel:[0,1,0] op_sel_hi:[1,1,0]
    v_pk_fma_f32 v[114:115], v[114:115], v[80:81], v[80:81] op_sel:[0,1,0] op_sel_hi:[1,1,0]
    v_pk_mul_f32 v[100:101], v[100:101], v[48:49]
    global_load_lds_dwordx4 v10, s[12:13] offset:2048
    global_load_lds_dwordx4 v11, s[12:13] offset:3072
    v_pk_mul_f32 v[102:103], v[102:103], v[50:51]
    v_pk_mul_f32 v[104:105], v[104:105], v[52:53]
    v_pk_mul_f32 v[106:107], v[106:107], v[54:55]
    v_pk_mul_f32 v[108:109], v[108:109], v[56:57]
    v_pk_mul_f32 v[110:111], v[110:111], v[58:59]
    v_pk_mul_f32 v[112:113], v[112:113], v[60:61]
    v_pk_mul_f32 v[114:115], v[114:115], v[62:63]
    v_exp_f32_e64 v100, v100
    v_exp_f32 v101, v101
    v_exp_f32 v102, v102
    v_exp_f32 v103, v103
    v_exp_f32 v104, v104
    v_exp_f32 v105, v105
    v_exp_f32 v106, v106
    s_add_u32 m0, s69, 4096
    s_add_u32 s12, s28, 917504
    v_exp_f32 v107, v107
    v_exp_f32 v108, v108
    s_addc_u32 s13, s29, 0
    global_load_lds_dwordx4 v8, s[12:13] offset:0
    global_load_lds_dwordx4 v9, s[12:13] offset:1024
    v_exp_f32 v109, v109
    v_exp_f32 v110, v110
    v_exp_f32 v111, v111
    v_exp_f32 v112, v112
    v_exp_f32 v113, v113
    v_exp_f32 v114, v114
    v_exp_f32 v115, v115
    v_pk_fma_f32 v[100:101], v[100:101], v[82:83], v[82:83] op_sel:[0,0,0] op_sel_hi:[1,0,0]
    v_pk_fma_f32 v[102:103], v[102:103], v[82:83], v[82:83] op_sel:[0,0,0] op_sel_hi:[1,0,0]
    v_pk_fma_f32 v[104:105], v[104:105], v[82:83], v[82:83] op_sel:[0,0,0] op_sel_hi:[1,0,0]
    v_pk_fma_f32 v[106:107], v[106:107], v[82:83], v[82:83] op_sel:[0,0,0] op_sel_hi:[1,0,0]
    v_pk_fma_f32 v[108:109], v[108:109], v[82:83], v[82:83] op_sel:[0,0,0] op_sel_hi:[1,0,0]
    v_pk_fma_f32 v[110:111], v[110:111], v[82:83], v[82:83] op_sel:[0,0,0] op_sel_hi:[1,0,0]
    v_pk_fma_f32 v[112:113], v[112:113], v[82:83], v[82:83] op_sel:[0,0,0] op_sel_hi:[1,0,0]
    v_pk_fma_f32 v[114:115], v[114:115], v[82:83], v[82:83] op_sel:[0,0,0] op_sel_hi:[1,0,0]
    v_rcp_f32 v100, v100
    v_rcp_f32 v101, v101
    v_rcp_f32 v102, v102
    v_rcp_f32 v103, v103
    v_rcp_f32 v104, v104
    global_load_lds_dwordx4 v10, s[12:13] offset:2048
    global_load_lds_dwordx4 v11, s[12:13] offset:3072
    v_rcp_f32 v105, v105
    v_rcp_f32 v106, v106
    v_rcp_f32 v107, v107
    v_rcp_f32 v108, v108
    v_rcp_f32 v109, v109
    v_rcp_f32 v110, v110
    v_rcp_f32 v111, v111
    v_rcp_f32 v112, v112
    v_rcp_f32 v113, v113
    v_rcp_f32_e64 v114, v114
    v_rcp_f32 v115, v115
    v_pk_mul_f32 v[100:101], v[100:101], v[48:49]
    v_pk_mul_f32 v[102:103], v[102:103], v[50:51]
    v_pk_mul_f32 v[104:105], v[104:105], v[52:53]
    v_pk_mul_f32 v[106:107], v[106:107], v[54:55]
    v_pk_mul_f32 v[108:109], v[108:109], v[56:57]
    s_add_u32 m0, s69, 8192
    s_add_u32 s12, s28, 1032192
    s_addc_u32 s13, s29, 0
    global_load_lds_dwordx4 v8, s[12:13] offset:0
    v_pk_mul_f32 v[110:111], v[110:111], v[58:59]
    v_pk_mul_f32 v[112:113], v[112:113], v[60:61]
    v_pk_mul_f32 v[114:115], v[114:115], v[62:63]
    v_cvt_pk_bf16_f32 v88, v100, v101
    v_cvt_pk_bf16_f32 v89, v102, v103
    v_cvt_pk_bf16_f32 v90, v104, v105
    v_cvt_pk_bf16_f32 v91, v106, v107
    v_cvt_pk_bf16_f32 v92, v108, v109
    v_cvt_pk_bf16_f32 v93, v110, v111
    v_cvt_pk_bf16_f32 v94, v112, v113
    v_cvt_pk_bf16_f32 v95, v114, v115
    s_mov_b32 exec_hi, 0
    v_or_b32_sdwa v88, v100, 1 dst_sel:WORD_0 dst_unused:UNUSED_PRESERVE src0_sel:WORD_1 src1_sel:DWORD
    v_or_b32_sdwa v90, v104, 1 dst_sel:WORD_0 dst_unused:UNUSED_PRESERVE src0_sel:WORD_1 src1_sel:DWORD
    v_or_b32_sdwa v92, v108, 1 dst_sel:WORD_0 dst_unused:UNUSED_PRESERVE src0_sel:WORD_1 src1_sel:DWORD
    v_or_b32_sdwa v94, v112, 1 dst_sel:WORD_0 dst_unused:UNUSED_PRESERVE src0_sel:WORD_1 src1_sel:DWORD
    s_mov_b32 exec_hi, -1
    v_permlane32_swap_b32 v89, v91
    v_permlane32_swap_b32 v93, v95
    v_permlane32_swap_b32 v88, v90
    v_permlane32_swap_b32 v92, v94
    s_cmp_lg_u32 s35, 0
    s_cbranch_scc1 L_s_l
    s_add_u32 s4, s68, 1
    s_and_b32 s4, s4, 126
    s_cbranch_scc1 L_s_b
    s_add_u32 s4, s77, 6277120
    s_mov_b32 s5, 43008
    v_subrev_u32 v28, s4, v24
    v_cmp_lt_u32_e64 vcc, s5, v28
    s_nop 1
    v_cndmask_b32 v88, v88, 1, vcc
    v_cndmask_b32 v89, v89, 0, vcc
    v_cndmask_b32 v90, v90, 0, vcc
    v_cndmask_b32 v91, v91, 0, vcc
    v_subrev_u32 v28, s4, v25
    v_cmp_lt_u32 vcc, s5, v28
    s_nop 1
    v_cndmask_b32 v92, v92, 1, vcc
    v_cndmask_b32 v93, v93, 0, vcc
    v_cndmask_b32 v94, v94, 0, vcc
    v_cndmask_b32 v95, v95, 0, vcc
L_s_b:
    s_mov_b64 exec, s[6:7]
    buffer_store_dwordx4 v[88:91], v24, s[16:19], 0 offen sc1
    s_mov_b64 exec, s[88:89]
    buffer_store_dwordx4 v[92:95], v25, s[16:19], 0 offen sc1
    s_cmp_eq_u32 s34, 0
    s_cbranch_scc1 L_s_e
L_s_l:
    s_not_b64 exec, s[6:7]
    buffer_store_dwordx4 v[88:91], v24, s[16:19], 0 offen
    s_not_b64 exec, s[88:89]
    buffer_store_dwordx4 v[92:95], v25, s[16:19], 0 offen
L_s_e:
    s_mov_b64 exec, -1
    v_pk_add_f32 v[48:49], v[32:33], v[84:85] op_sel:[0,0] op_sel_hi:[1,0] neg_lo:[0,1] neg_hi:[0,1]
    v_pk_add_f32 v[50:51], v[34:35], v[84:85] op_sel:[0,0] op_sel_hi:[1,0] neg_lo:[0,1] neg_hi:[0,1]
    v_pk_add_f32 v[52:53], v[36:37], v[84:85] op_sel:[0,0] op_sel_hi:[1,0] neg_lo:[0,1] neg_hi:[0,1]
    v_pk_add_f32 v[54:55], v[38:39], v[84:85] op_sel:[0,0] op_sel_hi:[1,0] neg_lo:[0,1] neg_hi:[0,1]
    v_pk_add_f32 v[56:57], v[40:41], v[84:85] op_sel:[0,0] op_sel_hi:[1,0] neg_lo:[0,1] neg_hi:[0,1]
    v_pk_add_f32 v[58:59], v[42:43], v[84:85] op_sel:[0,0] op_sel_hi:[1,0] neg_lo:[0,1] neg_hi:[0,1]
    v_pk_add_f32 v[60:61], v[44:45], v[84:85] op_sel:[0,0] op_sel_hi:[1,0] neg_lo:[0,1] neg_hi:[0,1]
    v_pk_add_f32 v[62:63], v[46:47], v[84:85] op_sel:[0,0] op_sel_hi:[1,0] neg_lo:[0,1] neg_hi:[0,1]
    v_pk_mul_f32 v[48:49], v[48:49], v[84:85] op_sel:[0,1] op_sel_hi:[1,1]
    v_pk_mul_f32 v[50:51], v[50:51], v[84:85] op_sel:[0,1] op_sel_hi:[1,1]
    s_lshl_b32 s42, s62, 13
    ds_read_b64_tr_b16 a[166:167], v17 offset:13312
    global_load_lds_dwordx4 v9, s[12:13] offset:1024
    s_nop 0
    ds_read_b64_tr_b16 a[168:169], v18 offset:12288
    ds_read_b64_tr_b16 a[170:171], v18 offset:13312
    ds_read_b64_tr_b16 a[172:173], v19 offset:12288
    ds_read_b64_tr_b16 a[174:175], v19 offset:13312
    ds_read_b64_tr_b16 a[176:177], v16 offset:16384
    ds_read_b64_tr_b16 a[178:179], v16 offset:17408
    ds_read_b64_tr_b16 a[180:181], v17 offset:16384
    ds_read_b64_tr_b16 a[182:183], v17 offset:17408
    ds_read_b64_tr_b16 a[184:185], v18 offset:16384
    ds_read_b64_tr_b16 a[186:187], v18 offset:17408
    ds_read_b64_tr_b16 a[188:189], v19 offset:16384
    ds_read_b64_tr_b16 a[190:191], v19 offset:17408
    ds_read_b64_tr_b16 a[192:193], v16 offset:20480
    ds_read_b64_tr_b16 a[194:195], v16 offset:21504
    ds_read_b64_tr_b16 a[196:197], v17 offset:20480
    global_load_lds_dwordx4 v10, s[12:13] offset:2048
    ds_read_b64_tr_b16 a[198:199], v17 offset:21504
    ds_read_b64_tr_b16 a[200:201], v18 offset:20480
    v_pk_mul_f32 v[52:53], v[52:53], v[84:85] op_sel:[0,1] op_sel_hi:[1,1]
    v_pk_mul_f32 v[54:55], v[54:55], v[84:85] op_sel:[0,1] op_sel_hi:[1,1]
    v_pk_mul_f32 v[56:57], v[56:57], v[84:85] op_sel:[0,1] op_sel_hi:[1,1]
    v_pk_mul_f32 v[58:59], v[58:59], v[84:85] op_sel:[0,1] op_sel_hi:[1,1]
    ds_read_b64_tr_b16 a[202:203], v18 offset:21504
    ds_read_b64_tr_b16 a[204:205], v19 offset:20480
    ds_read_b64_tr_b16 a[206:207], v19 offset:21504
    ds_read_b64_tr_b16 a[208:209], v16 offset:24576
    ds_read_b64_tr_b16 a[210:211], v16 offset:25600
    v_pk_mul_f32 v[60:61], v[60:61], v[84:85] op_sel:[0,1] op_sel_hi:[1,1]
    v_pk_mul_f32 v[62:63], v[62:63], v[84:85] op_sel:[0,1] op_sel_hi:[1,1]
    v_add_u32 v21, 6291456, v1
    v_lshrrev_b32_e64 v248, 5, v0
    v_lshl_or_b32 v248, v248, 30, v1
    ds_read_b64_tr_b16 a[212:213], v17 offset:24576
    global_load_lds_dwordx4 v11, s[12:13] offset:3072
    ds_read_b64_tr_b16 a[214:215], v17 offset:25600
    ds_read_b64_tr_b16 a[216:217], v18 offset:24576
    ds_read_b64_tr_b16 a[218:219], v18 offset:25600
    ds_read_b64_tr_b16 a[220:221], v19 offset:24576
    ds_read_b64_tr_b16 a[222:223], v19 offset:25600
    ds_read_b64_tr_b16 v[136:137], v16 offset:28672
    ds_read_b64_tr_b16 v[138:139], v16 offset:29696
    ds_read_b64_tr_b16 v[140:141], v17 offset:28672
    ds_read_b64_tr_b16 v[142:143], v17 offset:29696
    ds_read_b64_tr_b16 v[144:145], v18 offset:28672
    ds_read_b64_tr_b16 v[146:147], v18 offset:29696
    ds_read_b64_tr_b16 v[148:149], v19 offset:28672
    ds_read_b64_tr_b16 v[150:151], v19 offset:29696
    ds_read_b64_tr_b16 v[152:153], v16 offset:32768
    ds_read_b64_tr_b16 v[154:155], v16 offset:33792
    ds_read_b64_tr_b16 v[156:157], v17 offset:32768
    ds_read_b64_tr_b16 v[158:159], v17 offset:33792
    ds_read_b64_tr_b16 v[160:161], v18 offset:32768
    ds_read_b64_tr_b16 v[162:163], v18 offset:33792
    ds_read_b64_tr_b16 v[164:165], v19 offset:32768
    ds_read_b64_tr_b16 v[166:167], v19 offset:33792
    ds_read_b64_tr_b16 v[168:169], v16 offset:36864
    ds_read_b64_tr_b16 v[170:171], v16 offset:37888
    ds_read_b64_tr_b16 v[172:173], v17 offset:36864
    ds_read_b64_tr_b16 v[174:175], v17 offset:37888
    ds_read_b64_tr_b16 v[176:177], v18 offset:36864
    ds_read_b64_tr_b16 v[178:179], v18 offset:37888
    ds_read_b64_tr_b16 v[180:181], v19 offset:36864
    ds_read_b64_tr_b16 v[182:183], v19 offset:37888
    ds_read_b64_tr_b16 v[216:217], v16 offset:40960
    ds_read_b64_tr_b16 v[218:219], v16 offset:41984
    ds_read_b64_tr_b16 v[220:221], v17 offset:40960
    ds_read_b64_tr_b16 v[222:223], v17 offset:41984
    s_barrier
    s_nop 0
    buffer_load_dwordx4 v[80:83], v21, s[16:19], s36 offen offset:0 sc1
    ds_read_b64_tr_b16 v[224:225], v18 offset:40960
    ds_read_b64_tr_b16 v[226:227], v18 offset:41984
    ds_read_b64_tr_b16 v[228:229], v19 offset:40960
    ds_read_b64_tr_b16 v[230:231], v19 offset:41984
    ds_read_b64_tr_b16 v[232:233], v16 offset:45056
    ds_read_b64_tr_b16 v[234:235], v16 offset:46080
    ds_read_b64_tr_b16 v[236:237], v17 offset:45056
    ds_read_b64_tr_b16 v[238:239], v17 offset:46080
    buffer_load_dwordx4 v[84:87], v21, s[16:19], s36 offen offset:1024 sc1
    ds_read_b64_tr_b16 v[240:241], v18 offset:45056
    ds_read_b64_tr_b16 v[242:243], v18 offset:46080
    ds_read_b64_tr_b16 v[244:245], v19 offset:45056
    ds_read_b64_tr_b16 v[246:247], v19 offset:46080
    ds_read_b64_tr_b16 v[184:185], v16 offset:49152
    ds_read_b64_tr_b16 v[186:187], v16 offset:50176
    ds_read_b64_tr_b16 v[188:189], v17 offset:49152
    ds_read_b64_tr_b16 v[190:191], v17 offset:50176
    buffer_load_dwordx4 v[88:91], v21, s[16:19], s37 offen offset:0 sc1
    ds_read_b64_tr_b16 v[192:193], v18 offset:49152
    ds_read_b64_tr_b16 v[194:195], v18 offset:50176
    ds_read_b64_tr_b16 v[196:197], v19 offset:49152
    ds_read_b64_tr_b16 v[198:199], v19 offset:50176
    ds_read_b64_tr_b16 v[200:201], v16 offset:53248
    ds_read_b64_tr_b16 v[202:203], v16 offset:54272
    ds_read_b64_tr_b16 v[204:205], v17 offset:53248
    ds_read_b64_tr_b16 v[206:207], v17 offset:54272
    buffer_load_dwordx4 v[92:95], v21, s[16:19], s37 offen offset:1024 sc1
    ds_read_b64_tr_b16 v[208:209], v18 offset:53248
    ds_read_b64_tr_b16 v[210:211], v18 offset:54272
    ds_read_b64_tr_b16 v[212:213], v19 offset:53248
    ds_read_b64_tr_b16 v[214:215], v19 offset:54272
    s_lshl_b32 s40, s32, 3
    s_add_u32 s40, s40, 1638400
    s_add_u32 s3, s42, 98304
    buffer_load_dwordx4 v[96:99], v21, s[16:19], s38 offen offset:0 sc1
    v_add_u32 v26, s3, v6
    v_add_u32_e64 v27, s3, v7
    s_waitcnt lgkmcnt(0)
    s_barrier
    buffer_load_dwordx4 v[100:103], v21, s[16:19], s38 offen offset:1024 sc1
    buffer_load_dwordx4 v[104:107], v21, s[16:19], s39 offen offset:0 sc1
    buffer_load_dwordx4 v[108:111], v21, s[16:19], s39 offen offset:1024 sc1
    s_waitcnt vmcnt(7)
    v_cmp_eq_u32_e64 vcc, -1, v80
    s_cbranch_vccnz L_p5_S0
L_p5_K0:
    v_mfma_f32_16x16x32_bf16 v[48:51], a[112:115], v[80:83], v[48:51]
    v_mfma_f32_16x16x32_bf16 v[52:55], a[116:119], v[80:83], v[52:55]
    v_mfma_f32_16x16x32_bf16 v[56:59], a[120:123], v[80:83], v[56:59]
    buffer_load_dwordx4 v[112:115], v21, s[16:19], s86 offen offset:0 sc1
    ds_read_b64_tr_b16 a[80:81], v22 offset:20480
    ds_read_b64_tr_b16 a[82:83], v22 offset:22528
    ds_read_b64_tr_b16 a[84:85], v23 offset:20480
    s_waitcnt vmcnt(7)
    v_cmp_eq_u32 vcc, -1, v84
    v_mfma_f32_16x16x32_bf16 v[60:63], a[124:127], v[80:83], v[60:63]
    s_cbranch_vccnz L_p5_S1
L_p5_K1:
    v_mfma_f32_16x16x32_bf16 v[48:51], a[128:131], v[84:87], v[48:51]
L_pg5:
    s_cbranch_execz L_pgt
    v_mfma_f32_16x16x32_bf16 v[52:55], a[132:135], v[84:87], v[52:55]
    buffer_load_dwordx4 v[116:119], v21, s[16:19], s86 offen offset:1024 sc1
    ds_read_b64_tr_b16 a[86:87], v23 offset:22528
    ds_read_b64_tr_b16 a[88:89], v22 offset:21504
    ds_read_b64_tr_b16 a[90:91], v22 offset:23552
    v_mfma_f32_16x16x32_bf16 v[56:59], a[136:139], v[84:87], v[56:59]
    ds_read_b64_tr_b16 a[92:93], v23 offset:21504
    s_waitcnt vmcnt(7)
    v_cmp_eq_u32_e64 vcc, -1, v88
    v_mfma_f32_16x16x32_bf16 v[60:63], a[140:143], v[84:87], v[60:63]
    s_cbranch_vccnz L_p5_S2
L_p5_K2:
    v_mfma_f32_16x16x32_bf16 v[48:51], a[144:147], v[88:91], v[48:51]
    buffer_load_dwordx4 v[120:123], v21, s[16:19], s41 offen offset:0 sc1
    ds_read_b64_tr_b16 a[94:95], v23 offset:23552
    v_mfma_f32_16x16x32_bf16 v[52:55], a[148:151], v[88:91], v[52:55]
    ds_read_b64_tr_b16 a[96:97], v22 offset:16384
    ds_read_b64_tr_b16 a[98:99], v22 offset:18432
    v_mfma_f32_16x16x32_bf16 v[56:59], a[152:155], v[88:91], v[56:59]
    s_waitcnt vmcnt(7)
    v_cmp_eq_u32 vcc, -1, v92
    v_mfma_f32_16x16x32_bf16 v[60:63], a[156:159], v[88:91], v[60:63]
    s_cbranch_vccnz L_p5_S3
L_p5_K3:
    v_mfma_f32_16x16x32_bf16 v[48:51], a[160:163], v[92:95], v[48:51]
    s_nop 0
    buffer_load_dwordx4 v[124:127], v21, s[16:19], s41 offen offset:1024 sc1
    ds_read_b64_tr_b16 a[100:101], v23 offset:16384
    ds_read_b64_tr_b16 a[102:103], v23 offset:18432
    v_mfma_f32_16x16x32_bf16 v[52:55], a[164:167], v[92:95], v[52:55]
    ds_read_b64_tr_b16 a[104:105], v22 offset:17408
    ds_read_b64_tr_b16 a[106:107], v22 offset:19456
    v_mfma_f32_16x16x32_bf16 v[56:59], a[168:171], v[92:95], v[56:59]
    s_waitcnt vmcnt(7)
    v_cmp_eq_u32 vcc, -1, v96
    v_mfma_f32_16x16x32_bf16 v[60:63], a[172:175], v[92:95], v[60:63]
    s_cbranch_vccnz L_p5_S4
L_p5_K4:
    v_mfma_f32_16x16x32_bf16 v[48:51], a[176:179], v[96:99], v[48:51]
    s_nop 0
    buffer_load_dwordx4 v[128:131], v21, s[16:19], s44 offen offset:0 sc1
    ds_read_b64_tr_b16 a[108:109], v23 offset:17408
    v_mfma_f32_16x16x32_bf16 v[52:55], a[180:183], v[96:99], v[52:55]
    ds_read_b64_tr_b16 a[110:111], v23 offset:19456
    ds_read_b64_tr_b16 a[112:113], v22 offset:0
    v_mfma_f32_16x16x32_bf16 v[56:59], a[184:187], v[96:99], v[56:59]
    s_waitcnt vmcnt(7)
    v_cmp_eq_u32_e64 vcc, -1, v100
    v_mfma_f32_16x16x32_bf16 v[60:63], a[188:191], v[96:99], v[60:63]
    s_cbranch_vccnz L_p5_S5
L_p5_K5:
    v_mfma_f32_16x16x32_bf16 v[48:51], a[192:195], v[100:103], v[48:51]
    buffer_load_dwordx4 v[132:135], v21, s[16:19], s44 offen offset:1024 sc1
    ds_read_b64_tr_b16 a[114:115], v22 offset:2048
    ds_read_b64_tr_b16 a[116:117], v23 offset:0
    v_mfma_f32_16x16x32_bf16 v[52:55], a[196:199], v[100:103], v[52:55]
    s_nop 0
    ds_read_b64_tr_b16 a[118:119], v23 offset:2048
    ds_read_b64_tr_b16 a[120:121], v22 offset:1024
    v_mfma_f32_16x16x32_bf16 v[56:59], a[200:203], v[100:103], v[56:59]
    s_waitcnt vmcnt(7)
    v_cmp_eq_u32 vcc, -1, v104
    v_mfma_f32_16x16x32_bf16 v[60:63], a[204:207], v[100:103], v[60:63]
    s_cbranch_vccnz L_p5_S6
L_p5_K6:
    ds_read_b64_tr_b16 a[122:123], v22 offset:3072
    ds_read_b64_tr_b16 a[124:125], v23 offset:1024
    v_mfma_f32_16x16x32_bf16 v[48:51], a[208:211], v[104:107], v[48:51]
    ds_read_b64_tr_b16 a[126:127], v23 offset:3072
    v_mfma_f32_16x16x32_bf16 v[52:55], a[212:215], v[104:107], v[52:55]
    v_mfma_f32_16x16x32_bf16 v[56:59], a[216:219], v[104:107], v[56:59]
    s_waitcnt vmcnt(6)
    v_cmp_eq_u32_e64 vcc, -1, v108
    v_mfma_f32_16x16x32_bf16 v[60:63], a[220:223], v[104:107], v[60:63]
    s_cbranch_vccnz L_p5_S7
L_p5_K7:
    ds_read_b64_tr_b16 a[128:129], v22 offset:4096
    ds_read_b64_tr_b16 a[130:131], v22 offset:6144
    v_mfma_f32_16x16x32_bf16 v[48:51], v[136:139], v[108:111], v[48:51]
    ds_read_b64_tr_b16 a[132:133], v23 offset:4096
    buffer_load_dwordx4 v[72:75], v248, s[16:19], s40 offen offset:0 sc1
    v_mfma_f32_16x16x32_bf16 v[52:55], v[140:143], v[108:111], v[52:55]
    buffer_load_dwordx4 v[76:79], v248, s[16:19], s40 offen offset:512 sc1
    v_mfma_f32_16x16x32_bf16 v[56:59], v[144:147], v[108:111], v[56:59]
    ds_read_b64_tr_b16 a[134:135], v23 offset:6144
    s_waitcnt vmcnt(7)
    v_cmp_eq_u32_e64 vcc, -1, v112
    v_mfma_f32_16x16x32_bf16 v[60:63], v[148:151], v[108:111], v[60:63]
    s_cbranch_vccnz L_p5_S8
L_p5_K8:
    ds_read_b64_tr_b16 a[136:137], v22 offset:5120
    ds_read_b64_tr_b16 a[138:139], v22 offset:7168
    v_mfma_f32_16x16x32_bf16 v[48:51], v[152:155], v[112:115], v[48:51]
    ds_read_b64_tr_b16 a[140:141], v23 offset:5120
    ds_read_b64_tr_b16 a[142:143], v23 offset:7168
    v_mfma_f32_16x16x32_bf16 v[52:55], v[156:159], v[112:115], v[52:55]
    v_mfma_f32_16x16x32_bf16 v[56:59], v[160:163], v[112:115], v[56:59]
    s_waitcnt vmcnt(6)
    v_cmp_eq_u32 vcc, -1, v116
    v_mfma_f32_16x16x32_bf16 v[60:63], v[164:167], v[112:115], v[60:63]
    s_cbranch_vccnz L_p5_S9
L_p5_K9:
    ds_read_b64_tr_b16 a[144:145], v22 offset:8192
    v_mfma_f32_16x16x32_bf16 v[48:51], v[168:171], v[116:119], v[48:51]
    v_mfma_f32_16x16x32_bf16 v[52:55], v[172:175], v[116:119], v[52:55]
    s_waitcnt lgkmcnt(9)
    s_add_u32 m0, s69, 20480
    s_add_u32 s12, s28, 1146880
    s_addc_u32 s13, s29, 0
    v_mfma_f32_16x16x32_bf16 v[56:59], v[176:179], v[116:119], v[56:59]
    global_load_lds_dwordx4 v8, s[12:13] offset:0
    ds_read_b64_tr_b16 a[146:147], v22 offset:10240
    ds_read_b64_tr_b16 a[148:149], v23 offset:8192
    s_waitcnt vmcnt(6)
    v_cmp_eq_u32 vcc, -1, v120
    v_mfma_f32_16x16x32_bf16 v[60:63], v[180:183], v[116:119], v[60:63]
    s_cbranch_vccnz L_p5_S10
L_p5_K10:
    ds_read_b64_tr_b16 a[150:151], v23 offset:10240
    ds_read_b64_tr_b16 a[152:153], v22 offset:9216
    v_mfma_f32_16x16x32_bf16 v[48:51], v[216:219], v[120:123], v[48:51]
    global_load_lds_dwordx4 v9, s[12:13] offset:1024
    ds_read_b64_tr_b16 a[154:155], v22 offset:11264
    v_mfma_f32_16x16x32_bf16 v[52:55], v[220:223], v[120:123], v[52:55]
    ds_read_b64_tr_b16 a[156:157], v23 offset:9216
    v_mfma_f32_16x16x32_bf16 v[56:59], v[224:227], v[120:123], v[56:59]
    s_waitcnt vmcnt(6)
    v_cmp_eq_u32_e64 vcc, -1, v124
    v_mfma_f32_16x16x32_bf16 v[60:63], v[228:231], v[120:123], v[60:63]
    s_cbranch_vccnz L_p5_S11
L_p5_K11:
    ds_read_b64_tr_b16 a[158:159], v23 offset:11264
    global_load_lds_dwordx4 v10, s[12:13] offset:2048
    v_mfma_f32_16x16x32_bf16 v[48:51], v[232:235], v[124:127], v[48:51]
    v_mfma_f32_16x16x32_bf16 v[52:55], v[236:239], v[124:127], v[52:55]
    v_mfma_f32_16x16x32_bf16 v[56:59], v[240:243], v[124:127], v[56:59]
    s_waitcnt vmcnt(6)
    v_cmp_eq_u32_e64 vcc, -1, v128
    v_mfma_f32_16x16x32_bf16 v[60:63], v[244:247], v[124:127], v[60:63]
    s_cbranch_vccnz L_p5_S12
L_p5_K12:
    global_load_lds_dwordx4 v11, s[12:13] offset:3072
    v_mfma_f32_16x16x32_bf16 v[48:51], v[184:187], v[128:131], v[48:51]
    v_mfma_f32_16x16x32_bf16 v[52:55], v[188:191], v[128:131], v[52:55]
    v_mfma_f32_16x16x32_bf16 v[56:59], v[192:195], v[128:131], v[56:59]
    s_waitcnt vmcnt(6)
    v_cmp_eq_u32 vcc, -1, v132
    v_mfma_f32_16x16x32_bf16 v[60:63], v[196:199], v[128:131], v[60:63]
    s_cbranch_vccnz L_p5_S13
L_p5_K13:
    v_mfma_f32_16x16x32_bf16 v[48:51], v[200:203], v[132:135], v[48:51]
    v_mfma_f32_16x16x32_bf16 v[52:55], v[204:207], v[132:135], v[52:55]
    s_add_u32 m0, s69, 16384
    s_add_u32 s12, s28, 1261568
    s_addc_u32 s13, s29, 0
    v_mfma_f32_16x16x32_bf16 v[56:59], v[208:211], v[132:135], v[56:59]
    global_load_lds_dwordx4 v8, s[12:13] offset:0
    v_mfma_f32_16x16x32_bf16 v[60:63], v[212:215], v[132:135], v[60:63]
    s_nop 0
    v_cvt_pk_bf16_f32 v80, v48, v49
    v_cvt_pk_bf16_f32 v81, v50, v51
    v_cvt_pk_bf16_f32 v82, v52, v53
    v_cvt_pk_bf16_f32 v83, v54, v55
    s_nop 0
    v_cvt_pk_bf16_f32 v84, v56, v57
    v_cvt_pk_bf16_f32 v85, v58, v59
    v_cvt_pk_bf16_f32 v86, v60, v61
    v_cvt_pk_bf16_f32 v87, v62, v63
    v_or_b32_sdwa v80, v48, 1 dst_sel:WORD_0 dst_unused:UNUSED_PRESERVE src0_sel:WORD_1 src1_sel:DWORD
    v_or_b32_sdwa v84, v56, 1 dst_sel:WORD_0 dst_unused:UNUSED_PRESERVE src0_sel:WORD_1 src1_sel:DWORD
    s_add_u32 s4, s93, 8388608
    s_cmp_eq_u32 s34, 0
    s_cbranch_scc1 L_rem_7
    buffer_store_dwordx4 v[80:83], v1, s[16:19], s4 offen offset:0
    buffer_store_dwordx4 v[84:87], v1, s[16:19], s4 offen offset:1024
L_std_8:
    s_and_b32 s37, s62, 1
    s_lshr_b32 s38, s62, 1
    s_add_u32 s10, s52, 28672
    s_addc_u32 s11, s53, 0
    v_add_f32 v64, v48, v50
    v_mul_f32 v66, v48, v48
    v_add_f32 v65, v49, v51
    v_mul_f32 v67, v49, v49
    v_fmac_f32 v66, v50, v50
    v_fmac_f32 v67, v51, v51
    v_add_f32 v64, v64, v52
    v_fmac_f32 v66, v52, v52
    v_add_f32 v65, v65, v53
    v_fmac_f32 v67, v53, v53
    v_add_f32 v64, v64, v54
    v_fmac_f32 v66, v54, v54
    v_add_f32 v65, v65, v55
    v_fmac_f32 v67, v55, v55
    v_add_f32 v64, v64, v56
    v_fmac_f32 v66, v56, v56
    v_add_f32 v65, v65, v57
    v_fmac_f32 v67, v57, v57
    v_add_f32 v64, v64, v58
    v_fmac_f32 v66, v58, v58
    v_add_f32 v65, v65, v59
    v_fmac_f32 v67, v59, v59
    v_add_f32 v64, v64, v60
    v_fmac_f32 v66, v60, v60
    v_add_f32 v65, v65, v61
    global_load_lds_dwordx4 v9, s[12:13] offset:1024
    global_load_lds_dwordx4 v10, s[12:13] offset:2048
    v_fmac_f32 v67, v61, v61
    v_add_f32 v64, v64, v62
    v_fmac_f32 v66, v62, v62
    v_add_f32 v65, v65, v63
    v_fmac_f32 v67, v63, v63
    v_add_f32 v64, v64, v65
    v_add_f32 v65, v66, v67
    v_mov_b32 v66, v64
    v_mov_b32 v67, v65
    s_nop 0
    v_permlane16_swap_b32 v64, v66
    v_permlane16_swap_b32 v65, v67
    v_add_f32 v64, v64, v66
    v_add_f32 v65, v65, v67
    v_mov_b32 v66, v64
    v_mov_b32 v67, v65
    s_nop 0
    global_load_lds_dwordx4 v11, s[12:13] offset:3072
    v_permlane32_swap_b32 v64, v66
    v_permlane32_swap_b32 v65, v67
    v_add_f32 v64, v64, v66
    v_add_f32 v65, v65, v67
    v_add_u32 v4, 12288, v2
    v_add_u32 v5, 18432, v2
    s_sub_u32 s3, s69, s77
    v_add_u32 v17, s3, v1
    s_lshl2_add_u32 s39, s66, s62
    s_mul_i32 s39, s39, 57344
    s_lshr_b32 s3, s77, 4
    s_sub_u32 s39, s39, s3
    s_lshr_b32 s84, s71, 4
    s_add_u32 s84, s84, s39
    s_lshr_b32 s85, s72, 4
    s_add_u32 s85, s85, s39
    s_lshr_b32 s86, s73, 4
    s_add_u32 s86, s86, s39
    s_lshr_b32 s87, s74, 4
    s_add_u32 s87, s87, s39
    s_lshr_b32 s88, s75, 4
    s_add_u32 s88, s88, s39
    v_add_u32 v21, 8388608, v1
    s_lshl_b32 s82, s68, 11
    s_add_u32 s82, s82, 33555456
    buffer_load_dwordx4 v[88:91], v21, s[16:19], s71 offen offset:0 sc1
    s_lshr_b32 s89, s76, 4
    s_add_u32 s89, s89, s39
    s_lshr_b32 s90, s70, 4
    s_add_u32 s90, s90, s39
    v_bfe_u32 v28, v0, 4, 1
    v_mul_u32_u24 v28, 24576, v28
    v_lshrrev_b32 v29, 5, v0
    v_lshl_add_u32 v28, v29, 8, v28
    v_and_b32 v29, 15, v0
    v_lshl_add_u32 v12, v29, 4, v28
    s_add_u32 s3, s69, 16384
    v_add_u32 v13, s3, v1
    s_lshl_b32 s3, s38, 6
    buffer_load_dwordx4 v[92:95], v21, s[16:19], s71 offen offset:1024 sc1
    v_xor_b32 v28, s3, v6
    s_lshl_b32 s3, s37, 15
    s_add_u32 s3, s3, 98304
    v_add_u32 v14, s3, v28
    s_lshl_b32 s3, s37, 13
    v_add_u32 v15, s3, v28
    v_add_u32 v16, 49152, v15
    s_lshl_b32 s3, s62, 8
    s_add_u32 s3, s3, 14336
    v_lshlrev_b32 v29, 4, v29
    v_add_u32 v18, s3, v29
    v_and_b32 v28, 31, v0
    s_cmp_eq_u32 s34, 0
    s_cbranch_scc1 L_rem_9
    s_add_u32 s4, s94, 33555456
    s_mov_b64 exec, 0xffff
    buffer_store_dwordx2 v[64:65], v20, s[16:19], s4 offen
    s_mov_b64 exec, -1
L_std_10:
    v_lshlrev_b32 v28, 4, v28
    v_add_u32 v19, 14336, v28
    s_add_u32 s3, s42, 98304
    buffer_load_dwordx4 v[96:99], v21, s[16:19], s72 offen offset:0 sc1
    v_add_u32 v249, s3, v1
    v_add_u32 v250, 16384, v1
    v_add_u32 v251, 65536, v1
    v_lshrrev_b32 v30, 5, v0
    v_lshlrev_b32 v30, 10, v30
    v_bfe_u32 v31, v0, 4, 1
    v_lshl_add_u32 v30, v31, 9, v30
    v_and_b32 v31, 15, v0
    v_lshl_add_u32 v30, v31, 4, v30
    s_lshl_b32 s3, s38, 13
    s_lshl_b32 s45, s37, 8
    s_add_u32 s3, s3, s45
    s_add_u32 s3, s3, 98304
    v_add_u32 v24, s3, v30
    v_add_f32 v32, v32, v48
    v_add_f32 v33, v33, v49
    v_add_f32 v34, v34, v50
    v_add_f32 v35, v35, v51
    v_add_f32 v36, v36, v52
    v_add_f32 v37, v37, v53
    v_add_f32 v38, v38, v54
    v_add_f32 v39, v39, v55
    v_add_f32 v40, v40, v56
    v_add_f32 v41, v41, v57
    buffer_load_dwordx4 v[100:103], v21, s[16:19], s72 offen offset:1024 sc1
    buffer_load_dwordx4 v[104:107], v21, s[16:19], s73 offen offset:0 sc1
    ds_write_b128 v24, v[32:35] offset:0
    ds_write_b128 v24, v[36:39] offset:2048
    v_add_f32 v42, v42, v58
    v_add_f32 v43, v43, v59
    v_add_f32 v44, v44, v60
    v_add_f32 v45, v45, v61
    v_add_f32 v46, v46, v62
    v_add_f32 v47, v47, v63
    ds_write_b128 v24, v[40:43] offset:16384
    buffer_load_dwordx4 v[108:111], v21, s[16:19], s73 offen offset:1024 sc1
    ds_write_b128 v24, v[44:47] offset:18432
    s_waitcnt lgkmcnt(4)
    v_add_u32 v25, s70, v17
    ds_write_b128 v25, v[80:83] offset:0
    buffer_load_dwordx4 v[112:115], v21, s[16:19], s74 offen offset:0 sc1
    ds_write_b128 v25, v[84:87] offset:1024
    buffer_load_dwordx4 v[116:119], v21, s[16:19], s74 offen offset:1024 sc1
    s_waitcnt vmcnt(8)
    v_cmp_eq_u32 vcc, -1, v88
    s_cbranch_vccnz L_p6_S0
L_p6_K0:
    v_add_u32 v25, s71, v17
    ds_write_b128 v25, v[88:91] offset:0
    buffer_load_dwordx4 v[120:123], v21, s[16:19], s75 offen offset:0 sc1
    s_waitcnt vmcnt(8)
    v_cmp_eq_u32 vcc, -1, v92
    s_cbranch_vccnz L_p6_S1
L_p6_K1:
    ds_write_b128 v25, v[92:95] offset:1024
    buffer_load_dwordx4 v[124:127], v21, s[16:19], s75 offen offset:1024 sc1
    s_waitcnt vmcnt(7)
    v_cmp_eq_u32 vcc, -1, v96
    s_cbranch_vccnz L_p6_S2
L_p6_K2:
    v_add_u32 v25, s72, v17
    ds_write_b128 v25, v[96:99] offset:0
    buffer_load_dwordx4 v[128:131], v21, s[16:19], s76 offen offset:0 sc1
    s_waitcnt vmcnt(7)
    v_cmp_eq_u32 vcc, -1, v100
    s_cbranch_vccnz L_p6_S3
L_p6_K3:
    ds_write_b128 v25, v[100:103] offset:1024
    buffer_load_dwordx4 v[132:135], v21, s[16:19], s76 offen offset:1024 sc1
    s_waitcnt vmcnt(7)
    v_cmp_eq_u32 vcc, -1, v104
    s_cbranch_vccnz L_p6_S4
L_p6_K4:
    v_add_u32 v25, s73, v17
    ds_write_b128 v25, v[104:107] offset:0
    buffer_load_dwordx4 v[28:31], v20, s[16:19], s82 offen sc1
    s_waitcnt vmcnt(7)
    v_cmp_eq_u32_e64 vcc, -1, v108
    s_cbranch_vccnz L_p6_S5
L_p6_K5:
    ds_write_b128 v25, v[108:111] offset:1024
    s_waitcnt vmcnt(6)
    v_cmp_eq_u32 vcc, -1, v112
    s_cbranch_vccnz L_p6_S6
L_p6_K6:
    v_add_u32 v25, s74, v17
    ds_write_b128 v25, v[112:115] offset:0
    s_waitcnt vmcnt(5)
    v_cmp_eq_u32_e64 vcc, -1, v116
    s_cbranch_vccnz L_p6_S7
L_p6_K7:
    ds_write_b128 v25, v[116:119] offset:1024
    s_add_u32 m0, s42, 131072
    s_add_u32 s12, s28, 1376256
    s_addc_u32 s13, s29, 0
    global_load_lds_dwordx4 v8, s[12:13] offset:0
    s_waitcnt vmcnt(5)
    v_cmp_eq_u32 vcc, -1, v120
    s_cbranch_vccnz L_p6_S8
L_p6_K8:
    v_add_u32 v25, s75, v17
    ds_write_b128 v25, v[120:123] offset:0
    s_waitcnt vmcnt(4)
    v_cmp_eq_u32 vcc, -1, v124
    s_cbranch_vccnz L_p6_S9
L_p6_K9:
    ds_write_b128 v25, v[124:127] offset:1024
    global_load_lds_dwordx4 v9, s[12:13] offset:1024
    s_waitcnt vmcnt(4)
    v_cmp_eq_u32 vcc, -1, v128
    s_cbranch_vccnz L_p6_S10
L_p6_K10:
    v_add_u32 v25, s76, v17
    ds_write_b128 v25, v[128:131] offset:0
    s_waitcnt vmcnt(3)
    v_cmp_eq_u32_e64 vcc, -1, v132
    s_cbranch_vccnz L_p6_S11
L_p6_K11:
    ds_write_b128 v25, v[132:135] offset:1024
    global_load_lds_dwordx4 v10, s[12:13] offset:2048
    s_waitcnt lgkmcnt(0)
    s_barrier
    ds_read_b128 v[136:139], v12 offset:0
    ds_read_b128 v[140:143], v12 offset:512
    ds_read_b128 v[144:147], v12 offset:1024
    ds_read_b128 v[148:151], v12 offset:1536
    global_load_lds_dwordx4 v11, s[12:13] offset:3072
    ds_read_b128 v[152:155], v12 offset:2048
    ds_read_b128 v[156:159], v12 offset:2560
    s_waitcnt lgkmcnt(5)
    v_mfma_f32_32x32x16_bf16 v[32:47], a[0:3], v[136:139], 0
    s_add_u32 m0, s42, 135168
    s_add_u32 s12, s28, 1490944
    s_addc_u32 s13, s29, 0
    global_load_lds_dwordx4 v8, s[12:13] offset:0
    ds_read_b128 v[160:163], v12 offset:3072
    ds_read_b128 v[164:167], v12 offset:3584
    v_mov_b32 v106, 0
    s_waitcnt lgkmcnt(6)
    v_mfma_f32_32x32x16_bf16 v[32:47], a[8:11], v[140:143], v[32:47]
    ds_read_b128 v[168:171], v12 offset:4096
    ds_read_b128 v[172:175], v12 offset:4608
    v_mov_b32 v107, 0
    v_mov_b32 v110, 0
    s_waitcnt lgkmcnt(7)
    v_mfma_f32_32x32x16_bf16 v[32:47], a[16:19], v[144:147], v[32:47]
    global_load_lds_dwordx4 v9, s[12:13] offset:1024
    ds_read_b128 v[176:179], v12 offset:5120
    ds_read_b128 v[180:183], v12 offset:5632
    v_mov_b32 v111, 0
L_cs3_C:
    v_cmp_ne_u32 vcc, s67, v74
    v_cmp_ne_u32 s[4:5], s67, v78
    s_nop 0
    s_or_b32 vcc_lo, vcc_lo, s4
    s_mov_b32 vcc_hi, 0
    s_cbranch_vccnz L_cs3_S
L_cs3_K:
    s_waitcnt lgkmcnt(8)
    v_mfma_f32_32x32x16_bf16 v[32:47], a[24:27], v[148:151], v[32:47]
    s_waitcnt lgkmcnt(7)
    ds_read_b128 v[184:187], v12 offset:6144
    ds_read_b128 v[188:191], v12 offset:6656
    s_lshr_b32 s49, s68, 2
    s_lshl_b32 s49, s49, 12
    s_add_u32 s49, s49, 10747904
    s_lshr_b32 s50, s32, 5
    v_mfma_f32_32x32x16_bf16 v[32:47], a[32:35], v[152:155], v[32:47]
    s_add_u32 s50, s50, s49
    s_waitcnt lgkmcnt(8)
    global_load_lds_dwordx4 v10, s[12:13] offset:2048
    ds_read_b128 v[192:195], v12 offset:7168
    ds_read_b128 v[196:199], v12 offset:7680
    v_min_u32 v252, 27, v0
    v_lshlrev_b32 v252, 2, v252
    v_mfma_f32_32x32x16_bf16 v[32:47], a[40:43], v[156:159], v[32:47]
    buffer_load_dword v253, v252, s[16:19], s49 offen sc1
    ds_read_b128 v[200:203], v12 offset:8192
    ds_read_b128 v[204:207], v12 offset:8704
    s_waitcnt vmcnt(8)
    s_mov_b32 exec_hi, 0xffff
    v_add_f32 v28, v28, v30
    v_add_f32 v29, v29, v31
    s_mov_b32 exec_hi, -1
    v_cmp_u_f32_e64 vcc, v28, v29
    s_cbranch_vccnz L_p6_S12
L_p6_K12:
    s_waitcnt lgkmcnt(10)
    v_mfma_f32_32x32x16_bf16 v[32:47], a[48:51], v[160:163], v[32:47]
    ds_read_b128 v[208:211], v12 offset:9216
    ds_read_b128 v[212:215], v12 offset:9728
    v_mov_b32 v30, v28
    v_mov_b32 v31, v29
    s_nop 0
    v_permlane16_swap_b32 v28, v30
    v_mfma_f32_32x32x16_bf16 v[32:47], a[56:59], v[164:167], v[32:47]
    s_waitcnt lgkmcnt(8)
    ds_read_b128 v[216:219], v12 offset:10240
    ds_read_b128 v[220:223], v12 offset:10752
    v_permlane16_swap_b32 v29, v31
    v_add_f32 v28, v28, v30
    v_add_f32 v29, v29, v31
    v_mfma_f32_32x32x16_bf16 v[32:47], a[64:67], v[168:171], v[32:47]
    global_load_lds_dwordx4 v11, s[12:13] offset:3072
    ds_read_b128 v[224:227], v12 offset:11264
    ds_read_b128 v[228:231], v12 offset:11776
    v_mov_b32 v30, v28
    v_mov_b32_e64 v31, v29
    s_nop 0
    v_mfma_f32_32x32x16_bf16 v[32:47], a[72:75], v[172:175], v[32:47]
    ds_read_b128 v[232:235], v12 offset:12288
    ds_read_b128 v[236:239], v12 offset:12800
    v_permlane32_swap_b32 v28, v30
    v_permlane32_swap_b32 v29, v31
    v_mfma_f32_32x32x16_bf16 v[32:47], a[80:83], v[176:179], v[32:47]
    s_add_u32 m0, s42, 102400
    s_add_u32 s8, s10, s84
    s_addc_u32 s9, s11, 0
    global_load_lds_dwordx4 v2, s[8:9] offset:0
    ds_read_b128 v[240:243], v12 offset:13312
    ds_read_b128 v[244:247], v12 offset:13824
    v_add_f32 v28, v28, v30
    v_mfma_f32_32x32x16_bf16 v[32:47], a[88:91], v[180:183], v[32:47]
    s_waitcnt lgkmcnt(10)
    ds_read_b128 a[224:227], v249 offset:0
    ds_read_b128 a[228:231], v249 offset:1024
    v_add_f32_e64 v29, v29, v31
    v_mul_f32 v28, 0x3b124925, v28
    v_mov_b32 v30, 0x3727c5ac
    v_fmac_f32 v30, 0x3b124925, v29
    v_mfma_f32_32x32x16_bf16 v[32:47], a[96:99], v[184:187], v[32:47]
    global_load_lds_dwordx4 v3, s[8:9] offset:1024
    ds_read_b128 a[232:235], v249 offset:2048
    ds_read_b128 a[236:239], v249 offset:3072
    v_fma_f32 v29, -v28, v28, v30
    v_rsq_f32_e64 v30, v29
    v_mfma_f32_32x32x16_bf16 v[32:47], a[104:107], v[188:191], v[32:47]
    v_cvt_pk_bf16_f32 v254, -v28, -v28
    v_and_b32 v254, 0xffff0000, v254
    v_add_f32 v254, v28, v254
    v_cvt_pk_bf16_f32 v28, -v28, -v254
    v_mul_f32 v31, v29, v30
    v_mul_f32 v29, 0xc0135761, v30
    v_mul_f32 v254, v30, v30
    v_mul_f32 v30, v254, v30
    v_mul_f32 v30, 0xbdd2d3e8, v30
    ds_write_b128 v18, v[28:31]
    global_load_lds_dwordx4 v4, s[8:9] offset:2048
    s_waitcnt lgkmcnt(0)
    v_mfma_f32_32x32x16_bf16 v[32:47], a[112:115], v[192:195], v[32:47]
    s_barrier
    ds_read_b128 v[96:99], v19 offset:0
    ds_read_b128 v[100:103], v19 offset:512
    global_load_lds_dwordx4 v5, s[8:9] offset:3072
    ds_read_b64_tr_b16 a[160:161], v22 offset:20480
    ds_read_b64_tr_b16 a[162:163], v22 offset:22528
    v_mfma_f32_32x32x16_bf16 v[32:47], a[120:123], v[196:199], v[32:47]
    ds_read_b64_tr_b16 a[164:165], v23 offset:20480
    ds_read_b64_tr_b16 a[166:167], v23 offset:22528
    ds_read_b64_tr_b16 a[168:169], v22 offset:21504
    ds_read_b64_tr_b16 a[170:171], v22 offset:23552
    ds_read_b64_tr_b16 a[172:173], v23 offset:21504
    ds_read_b64_tr_b16 a[174:175], v23 offset:23552
    v_mfma_f32_32x32x16_bf16 v[32:47], a[128:131], v[200:203], v[32:47]
    s_add_u32 m0, s42, 98304
    s_add_u32 s8, s52, s84
    s_addc_u32 s9, s53, 0
    global_load_lds_dwordx4 v2, s[8:9] offset:0
    ds_read_b64_tr_b16 a[176:177], v22 offset:16384
    ds_read_b64_tr_b16 a[178:179], v22 offset:18432
    v_mfma_f32_32x32x16_bf16 v[32:47], a[136:139], v[204:207], v[32:47]
    ds_read_b64_tr_b16 a[180:181], v23 offset:16384
    ds_read_b64_tr_b16 a[182:183], v23 offset:18432
    ds_read_b64_tr_b16 a[184:185], v22 offset:17408
    ds_read_b64_tr_b16 a[186:187], v22 offset:19456
    ds_read_b64_tr_b16 a[188:189], v23 offset:17408
    ds_read_b64_tr_b16 a[190:191], v23 offset:19456
    v_mfma_f32_32x32x16_bf16 v[32:47], a[144:147], v[208:211], v[32:47]
    v_mfma_f32_32x32x16_bf16 v[32:47], a[152:155], v[212:215], v[32:47]
    s_waitcnt vmcnt(10)
    ds_read_b64_tr_b16 a[192:193], v26 offset:32768
    ds_read_b64_tr_b16 a[194:195], v26 offset:34816
    ds_read_b64_tr_b16 a[196:197], v27 offset:32768
    s_waitcnt lgkmcnt(11)
    global_load_lds_dwordx4 v3, s[8:9] offset:1024
    ds_read_b64_tr_b16 a[198:199], v27 offset:34816
    v_mfma_f32_32x32x16_bf16 v[32:47], a[160:163], v[216:219], v[32:47]
    ds_read_b64_tr_b16 a[200:201], v26 offset:33792
    ds_read_b64_tr_b16 a[202:203], v26 offset:35840
    ds_read_b64_tr_b16 a[204:205], v27 offset:33792
    v_mfma_f32_32x32x16_bf16 v[32:47], a[168:171], v[220:223], v[32:47]
    s_waitcnt vmcnt(6)
    ds_read_b64_tr_b16 a[208:209], v26 offset:36864
    ds_read_b64_tr_b16 a[210:211], v26 offset:38912
    ds_read_b64_tr_b16 a[212:213], v27 offset:36864
    s_waitcnt lgkmcnt(10)
    global_load_lds_dwordx4 v4, s[8:9] offset:2048
    ds_read_b64_tr_b16 a[214:215], v27 offset:38912
    v_mfma_f32_32x32x16_bf16 v[32:47], a[176:179], v[224:227], v[32:47]
    ds_read_b64_tr_b16 a[216:217], v26 offset:37888
    ds_read_b64_tr_b16 a[218:219], v26 offset:39936
    ds_read_b64_tr_b16 a[220:221], v27 offset:37888
    ds_read_b64_tr_b16 a[222:223], v27 offset:39936
    ds_read_b64_tr_b16 a[206:207], v27 offset:35840
    v_mfma_f32_32x32x16_bf16 v[32:47], a[184:187], v[228:231], v[32:47]
    v_mov_b32 v104, v96
    v_mov_b32 v105, v96
    v_mov_b32 v108, v100
    v_mov_b32_e64 v109, v100
    s_waitcnt lgkmcnt(0)
    v_mfma_f32_32x32x16_bf16 v[32:47], a[192:195], v[232:235], v[32:47]
    global_load_lds_dwordx4 v5, s[8:9] offset:3072
    v_mfma_f32_32x32x16_bf16 v[32:47], a[200:203], v[236:239], v[32:47]
    v_mfma_f32_32x32x16_bf16 v[32:47], a[208:211], v[240:243], v[32:47]
    s_add_u32 m0, s42, 135168
    s_add_u32 s8, s10, s85
    s_addc_u32 s9, s11, 0
    global_load_lds_dwordx4 v2, s[8:9] offset:0
    v_mfma_f32_32x32x16_bf16 v[32:47], a[216:219], v[244:247], v[32:47]
    v_mfma_f32_32x32x16_bf16 v[32:47], v[72:75], v[104:107], v[32:47]
    global_load_lds_dwordx4 v3, s[8:9] offset:1024
    v_mfma_f32_32x32x16_bf16 v[48:63], a[4:7], v[136:139], 0
    ds_read_b128 v[136:139], v12 offset:49152
    v_mfma_f32_32x32x16_bf16 v[48:63], a[12:15], v[140:143], v[48:63]
    ds_read_b128 v[140:143], v12 offset:49664
    s_nop 6
    v_mul_f32 v80, v32, v32
    v_mul_f32_e64 v81, v33, v33
    v_fma_f32 v80, v80, v98, v97
    v_mul_f32_e64 v82, v34, v34
    v_fma_f32 v81, v81, v98, v97
    v_mfma_f32_32x32x16_bf16 v[48:63], a[20:23], v[144:147], v[48:63]
    global_load_lds_dwordx4 v4, s[8:9] offset:2048
    ds_read_b128 v[144:147], v12 offset:50176
    v_mul_f32 v80, v80, v32
    v_exp_f32 v80, v80
    v_mul_f32_e64 v83, v35, v35
    v_mfma_f32_32x32x16_bf16 v[48:63], a[28:31], v[148:151], v[48:63]
    ds_read_b128 v[148:151], v12 offset:50688
    v_fma_f32 v82, v82, v98, v97
    v_mul_f32 v81, v81, v33
    v_exp_f32 v81, v81
    v_mul_f32_e64 v84, v36, v36
    v_mfma_f32_32x32x16_bf16 v[48:63], a[36:39], v[152:155], v[48:63]
    global_load_lds_dwordx4 v5, s[8:9] offset:3072
    ds_read_b128 v[152:155], v12 offset:51200
    v_fma_f32 v83, v83, v98, v97
    v_mul_f32_e64 v82, v82, v34
    v_fma_f32 v80, v80, v99, v99
    v_mfma_f32_32x32x16_bf16 v[48:63], a[44:47], v[156:159], v[48:63]
    ds_read_b128 v[156:159], v12 offset:51712
    v_exp_f32 v82, v82
    v_mul_f32 v85, v37, v37
    v_fma_f32 v84, v84, v98, v97
    s_add_u32 m0, s42, 131072
    v_mfma_f32_32x32x16_bf16 v[48:63], a[52:55], v[160:163], v[48:63]
    s_add_u32 s8, s52, s85
    s_addc_u32 s9, s53, 0
    global_load_lds_dwordx4 v2, s[8:9] offset:0
    ds_read_b128 v[160:163], v12 offset:52224
    v_rcp_f32 v80, v80
    v_mfma_f32_32x32x16_bf16 v[48:63], a[60:63], v[164:167], v[48:63]
    ds_read_b128 v[164:167], v12 offset:52736
    v_mul_f32 v83, v83, v35
    v_fma_f32 v81, v81, v99, v99
    v_exp_f32 v83, v83
    v_mul_f32 v86, v38, v38
    v_mfma_f32_32x32x16_bf16 v[48:63], a[68:71], v[168:171], v[48:63]
    ds_read_b128 v[168:171], v12 offset:53248
    v_fma_f32 v85, v85, v98, v97
    v_rcp_f32 v81, v81
    v_mul_f32 v84, v84, v36
    v_fma_f32 v82, v82, v99, v99
    v_mfma_f32_32x32x16_bf16 v[48:63], a[76:79], v[172:175], v[48:63]
    global_load_lds_dwordx4 v3, s[8:9] offset:1024
    ds_read_b128 v[172:175], v12 offset:53760
    v_mul_f32 v80, v80, v32
    v_exp_f32 v84, v84
    v_mul_f32_e64 v87, v39, v39
    v_mfma_f32_32x32x16_bf16 v[48:63], a[84:87], v[176:179], v[48:63]
    ds_read_b128 v[176:179], v12 offset:54272
    v_fma_f32 v86, v86, v98, v97
    v_rcp_f32 v82, v82
    v_mul_f32 v85, v85, v37
    v_fma_f32 v83, v83, v99, v99
    v_mfma_f32_32x32x16_bf16 v[48:63], a[92:95], v[180:183], v[48:63]
L_pg6:
    s_cbranch_execz L_pgt
    global_load_lds_dwordx4 v4, s[8:9] offset:2048
    ds_read_b128 v[180:183], v12 offset:54784
    v_mul_f32 v81, v81, v33
    v_exp_f32 v85, v85
    v_mul_f32 v88, v40, v40
    v_mfma_f32_32x32x16_bf16 v[48:63], a[100:103], v[184:187], v[48:63]
    ds_read_b128 v[184:187], v12 offset:55296
    v_fma_f32 v87, v87, v98, v97
    v_rcp_f32 v83, v83
    v_mul_f32 v86, v86, v38
    v_fma_f32 v84, v84, v99, v99
    v_mfma_f32_32x32x16_bf16 v[48:63], a[108:111], v[188:191], v[48:63]
    global_load_lds_dwordx4 v5, s[8:9] offset:3072
    ds_read_b128 v[188:191], v12 offset:55808
    v_mul_f32 v82, v82, v34
    v_cvt_pk_bf16_f32 v112, v80, v81
    v_exp_f32 v86, v86
    v_mfma_f32_32x32x16_bf16 v[48:63], a[116:119], v[192:195], v[48:63]
    ds_read_b128 v[192:195], v12 offset:56320
    v_mul_f32 v89, v41, v41
    v_fma_f32 v88, v88, v98, v97
    v_rcp_f32 v84, v84
    v_mul_f32_e64 v87, v87, v39
    v_mfma_f32_32x32x16_bf16 v[48:63], a[124:127], v[196:199], v[48:63]
    ds_read_b128 v[196:199], v12 offset:56832
    v_fma_f32 v85, v85, v99, v99
    v_mul_f32 v83, v83, v35
    v_exp_f32 v87, v87
    v_mul_f32 v90, v42, v42
    v_mfma_f32_32x32x16_bf16 v[48:63], a[132:135], v[200:203], v[48:63]
    ds_read_b128 v[200:203], v12 offset:57344
    v_fma_f32 v89, v89, v98, v97
    v_rcp_f32 v85, v85
    v_mul_f32 v88, v88, v40
    v_fma_f32 v86, v86, v99, v99
    v_mfma_f32_32x32x16_bf16 v[48:63], a[140:143], v[204:207], v[48:63]
    ds_read_b128 v[204:207], v12 offset:57856
    v_mul_f32 v84, v84, v36
    v_cvt_pk_bf16_f32 v113, v82, v83
    v_exp_f32 v88, v88
    v_mul_f32 v91, v43, v43
    v_mfma_f32_32x32x16_bf16 v[48:63], a[148:151], v[208:211], v[48:63]
    ds_read_b128 v[208:211], v12 offset:58368
    v_fma_f32 v90, v90, v98, v97
    v_rcp_f32 v86, v86
    v_mul_f32 v89, v89, v41
    v_fma_f32 v87, v87, v99, v99
    v_mfma_f32_32x32x16_bf16 v[48:63], a[156:159], v[212:215], v[48:63]
    ds_read_b128 v[212:215], v12 offset:58880
    v_mul_f32 v85, v85, v37
    v_exp_f32 v89, v89
    v_mul_f32_e64 v92, v44, v44
    v_fma_f32 v91, v91, v98, v97
    v_mfma_f32_32x32x16_bf16 v[48:63], a[164:167], v[216:219], v[48:63]
    ds_read_b128 v[216:219], v12 offset:59392
    v_rcp_f32 v87, v87
    v_mul_f32 v90, v90, v42
    v_fma_f32 v88, v88, v99, v99
    v_mul_f32 v86, v86, v38
    v_mfma_f32_32x32x16_bf16 v[48:63], a[172:175], v[220:223], v[48:63]
    ds_read_b128 v[220:223], v12 offset:59904
    v_cvt_pk_bf16_f32 v114, v84, v85
    v_exp_f32 v90, v90
    v_mul_f32 v93, v45, v45
    v_fma_f32 v92, v92, v98, v97
    v_mfma_f32_32x32x16_bf16 v[48:63], a[180:183], v[224:227], v[48:63]
    ds_read_b128 v[224:227], v12 offset:60416
    v_rcp_f32 v88, v88
    v_mul_f32 v91, v91, v43
    v_fma_f32 v89, v89, v99, v99
    v_mul_f32 v87, v87, v39
    v_mfma_f32_32x32x16_bf16 v[48:63], a[188:191], v[228:231], v[48:63]
    ds_read_b128 v[228:231], v12 offset:60928
    v_exp_f32 v91, v91
    v_mul_f32 v94, v46, v46
    v_fma_f32 v93, v93, v98, v97
    v_mfma_f32_32x32x16_bf16 v[48:63], a[196:199], v[232:235], v[48:63]
    ds_read_b128 v[232:235], v12 offset:61440
    v_rcp_f32 v89, v89
    v_mul_f32 v92, v92, v44
    v_fma_f32 v90, v90, v99, v99
    v_mul_f32_e64 v88, v88, v40
    v_mfma_f32_32x32x16_bf16 v[48:63], a[204:207], v[236:239], v[48:63]
    ds_read_b128 v[236:239], v12 offset:61952
    v_cvt_pk_bf16_f32 v115, v86, v87
    v_exp_f32 v92, v92
    v_mul_f32 v95, v47, v47
    v_fma_f32 v94, v94, v98, v97
    v_mfma_f32_32x32x16_bf16 v[48:63], a[212:215], v[240:243], v[48:63]
    ds_read_b128 v[240:243], v12 offset:62464
    v_rcp_f32 v90, v90
    v_mul_f32 v93, v93, v45
    v_fma_f32 v91, v91, v99, v99
    v_mul_f32 v89, v89, v41
    v_mfma_f32_32x32x16_bf16 v[48:63], a[220:223], v[244:247], v[48:63]
    ds_read_b128 v[244:247], v12 offset:62976
    v_exp_f32 v93, v93
    v_fma_f32 v95, v95, v98, v97
    v_rcp_f32 v91, v91
    v_mfma_f32_32x32x16_bf16 v[48:63], v[76:79], v[104:107], v[48:63]
    s_waitcnt lgkmcnt(5)
    v_mul_f32 v94, v94, v46
    v_fma_f32 v92, v92, v99, v99
    v_mul_f32 v90, v90, v42
    v_cvt_pk_bf16_f32 v116, v88, v89
    v_exp_f32 v94, v94
    v_mfma_f32_32x32x16_bf16 v[120:135], a[0:3], v[136:139], 0
    v_rcp_f32 v92, v92
    v_mul_f32_e64 v95, v95, v47
    v_fma_f32 v93, v93, v99, v99
    v_mul_f32 v91, v91, v43
    v_mfma_f32_32x32x16_bf16 v[120:135], a[8:11], v[140:143], v[120:135]
    v_exp_f32 v95, v95
    v_rcp_f32_e64 v93, v93
    v_fma_f32 v94, v94, v99, v99
    v_mul_f32 v92, v92, v44
    v_mfma_f32_32x32x16_bf16 v[120:135], a[16:19], v[144:147], v[120:135]
    v_cvt_pk_bf16_f32 v117, v90, v91
    v_rcp_f32 v94, v94
    v_fma_f32 v95, v95, v99, v99
    v_mul_f32 v93, v93, v45
    v_mfma_f32_32x32x16_bf16 v[120:135], a[24:27], v[148:151], v[120:135]
    v_rcp_f32 v95, v95
    v_mul_f32_e64 v94, v94, v46
    v_cvt_pk_bf16_f32 v118, v92, v93
    v_mul_f32_e64 v95, v95, v47
    v_cvt_pk_bf16_f32 v119, v94, v95
    v_mfma_f32_32x32x16_bf16 v[120:135], a[32:35], v[152:155], v[120:135]
    ds_write_b128 v13, v[112:115] offset:0
    v_mfma_f32_32x32x16_bf16 v[120:135], a[40:43], v[156:159], v[120:135]
    ds_write_b128 v13, v[116:119] offset:2048
    v_mul_f32_e64 v80, v48, v48
    v_mfma_f32_32x32x16_bf16 v[120:135], a[48:51], v[160:163], v[120:135]
    v_mul_f32 v81, v49, v49
    v_fma_f32 v80, v80, v98, v97
    v_mul_f32 v82, v50, v50
    v_fma_f32 v81, v81, v98, v97
    v_mul_f32 v80, v80, v48
    v_mfma_f32_32x32x16_bf16 v[120:135], a[56:59], v[164:167], v[120:135]
    s_waitcnt lgkmcnt(2)
    v_exp_f32 v80, v80
    v_mul_f32 v83, v51, v51
    v_fma_f32 v82, v82, v98, v97
    v_mul_f32 v81, v81, v49
    s_waitcnt vmcnt(0)
    v_mfma_f32_32x32x16_bf16 v[120:135], a[64:67], v[168:171], v[120:135]
    s_barrier
    s_add_u32 m0, s69, 0
    s_add_u32 s8, s52, s86
    s_addc_u32 s9, s53, 0
    global_load_lds_dwordx4 v2, s[8:9] offset:0
    v_mfma_f32_32x32x16_bf16 v[120:135], a[72:75], v[172:175], v[120:135]
    ds_read_b64_tr_b16 a[0:1], v14 offset:0
    ds_read_b64_tr_b16 a[2:3], v14 offset:1024
    v_exp_f32 v81, v81
    v_mul_f32 v84, v52, v52
    v_fma_f32 v83, v83, v98, v97
    v_mfma_f32_32x32x16_bf16 v[120:135], a[80:83], v[176:179], v[120:135]
    ds_read_b64_tr_b16 a[8:9], v14 offset:2048
    ds_read_b64_tr_b16 a[10:11], v14 offset:3072
    global_load_lds_dwordx4 v3, s[8:9] offset:1024
    ds_read_b64_tr_b16 a[16:17], v14 offset:4096
    v_mul_f32_e64 v82, v82, v50
    v_fma_f32 v80, v80, v99, v99
    v_mfma_f32_32x32x16_bf16 v[120:135], a[88:91], v[180:183], v[120:135]
    ds_read_b64_tr_b16 a[18:19], v14 offset:5120
    ds_read_b64_tr_b16 a[24:25], v14 offset:6144
    v_exp_f32 v82, v82
    v_mul_f32 v85, v53, v53
    v_fma_f32 v84, v84, v98, v97
    v_mfma_f32_32x32x16_bf16 v[120:135], a[96:99], v[184:187], v[120:135]
    ds_read_b64_tr_b16 a[26:27], v14 offset:7168
    global_load_lds_dwordx4 v4, s[8:9] offset:2048
    ds_read_b64_tr_b16 a[32:33], v14 offset:8192
    v_rcp_f32 v80, v80
    v_mul_f32 v83, v83, v51
    v_mfma_f32_32x32x16_bf16 v[120:135], a[104:107], v[188:191], v[120:135]
    ds_read_b64_tr_b16 a[34:35], v14 offset:9216
    ds_read_b64_tr_b16 a[40:41], v14 offset:10240
    v_fma_f32 v81, v81, v99, v99
    v_exp_f32 v83, v83
    v_mul_f32 v86, v54, v54
    v_mfma_f32_32x32x16_bf16 v[120:135], a[112:115], v[192:195], v[120:135]
    ds_read_b64_tr_b16 a[42:43], v14 offset:11264
    global_load_lds_dwordx4 v5, s[8:9] offset:3072
    ds_read_b64_tr_b16 a[48:49], v14 offset:12288
    v_fma_f32 v85, v85, v98, v97
    v_rcp_f32_e64 v81, v81
    v_mfma_f32_32x32x16_bf16 v[120:135], a[120:123], v[196:199], v[120:135]
    ds_read_b64_tr_b16 a[50:51], v14 offset:13312
    ds_read_b64_tr_b16 a[56:57], v14 offset:14336
    ds_read_b64_tr_b16 a[58:59], v14 offset:15360
    v_mul_f32 v84, v84, v52
    v_fma_f32 v82, v82, v99, v99
    v_mul_f32 v80, v80, v48
    v_mfma_f32_32x32x16_bf16 v[120:135], a[128:131], v[200:203], v[120:135]
    ds_read_b64_tr_b16 a[64:65], v14 offset:16384
    ds_read_b64_tr_b16 a[66:67], v14 offset:17408
    v_exp_f32 v84, v84
    v_mul_f32 v87, v55, v55
    v_fma_f32 v86, v86, v98, v97
    v_mfma_f32_32x32x16_bf16 v[120:135], a[136:139], v[204:207], v[120:135]
    s_add_u32 m0, s69, 4096
    s_add_u32 s8, s10, s86
    s_addc_u32 s9, s11, 0
    global_load_lds_dwordx4 v2, s[8:9] offset:0
    ds_read_b64_tr_b16 a[72:73], v14 offset:18432
    ds_read_b64_tr_b16 a[74:75], v14 offset:19456
    v_mfma_f32_32x32x16_bf16 v[120:135], a[144:147], v[208:211], v[120:135]
    ds_read_b64_tr_b16 a[80:81], v14 offset:20480
    ds_read_b64_tr_b16 a[82:83], v14 offset:21504
    v_rcp_f32 v82, v82
    v_mul_f32 v85, v85, v53
    v_fma_f32 v83, v83, v99, v99
    v_mfma_f32_32x32x16_bf16 v[120:135], a[152:155], v[212:215], v[120:135]
    global_load_lds_dwordx4 v3, s[8:9] offset:1024
    ds_read_b64_tr_b16 a[88:89], v14 offset:22528
    ds_read_b64_tr_b16 a[90:91], v14 offset:23552
    v_mul_f32 v81, v81, v49
    v_exp_f32 v85, v85
    v_mfma_f32_32x32x16_bf16 v[120:135], a[160:163], v[216:219], v[120:135]
    ds_read_b64_tr_b16 a[96:97], v14 offset:24576
    ds_read_b64_tr_b16 a[98:99], v14 offset:25600
    v_mul_f32 v88, v56, v56
    v_fma_f32 v87, v87, v98, v97
    v_rcp_f32 v83, v83
    v_mfma_f32_32x32x16_bf16 v[120:135], a[168:171], v[220:223], v[120:135]
    global_load_lds_dwordx4 v4, s[8:9] offset:2048
    ds_read_b64_tr_b16 a[104:105], v14 offset:26624
    ds_read_b64_tr_b16 a[106:107], v14 offset:27648
    v_mul_f32 v86, v86, v54
    v_fma_f32 v84, v84, v99, v99
    v_mul_f32 v82, v82, v50
    v_mfma_f32_32x32x16_bf16 v[120:135], a[176:179], v[224:227], v[120:135]
    ds_read_b64_tr_b16 a[112:113], v14 offset:28672
    ds_read_b64_tr_b16 a[114:115], v14 offset:29696
    v_cvt_pk_bf16_f32 v112, v80, v81
    v_exp_f32 v86, v86
    v_mul_f32 v89, v57, v57
    v_mfma_f32_32x32x16_bf16 v[120:135], a[184:187], v[228:231], v[120:135]
    global_load_lds_dwordx4 v5, s[8:9] offset:3072
    ds_read_b64_tr_b16 a[120:121], v14 offset:30720
    ds_read_b64_tr_b16 a[122:123], v14 offset:31744
    v_fma_f32 v88, v88, v98, v97
    v_rcp_f32 v84, v84
    v_mfma_f32_32x32x16_bf16 v[120:135], a[192:195], v[232:235], v[120:135]
    v_mul_f32 v87, v87, v55
    v_fma_f32 v85, v85, v99, v99
    v_mul_f32 v83, v83, v51
    v_exp_f32 v87, v87
    v_mul_f32_e64 v90, v58, v58
    v_mfma_f32_32x32x16_bf16 v[120:135], a[200:203], v[236:239], v[120:135]
    v_fma_f32 v89, v89, v98, v97
    v_rcp_f32 v85, v85
    v_mul_f32 v88, v88, v56
    v_fma_f32 v86, v86, v99, v99
    v_mul_f32_e64 v84, v84, v52
    v_mfma_f32_32x32x16_bf16 v[120:135], a[208:211], v[240:243], v[120:135]
    s_add_u32 m0, s69, 8192
    s_add_u32 s8, s52, s87
    s_addc_u32 s9, s53, 0
    global_load_lds_dwordx4 v2, s[8:9] offset:0
    v_cvt_pk_bf16_f32 v113, v82, v83
    v_exp_f32 v88, v88
    v_mfma_f32_32x32x16_bf16 v[120:135], a[216:219], v[244:247], v[120:135]
    v_mul_f32 v91, v59, v59
    v_fma_f32 v90, v90, v98, v97
    v_rcp_f32 v86, v86
    v_mul_f32 v89, v89, v57
    v_fma_f32 v87, v87, v99, v99
    v_mfma_f32_32x32x16_bf16 v[120:135], v[72:75], v[108:111], v[120:135]
    global_load_lds_dwordx4 v3, s[8:9] offset:1024
    v_mul_f32 v85, v85, v53
    v_exp_f32 v89, v89
    v_mul_f32 v92, v60, v60
    v_fma_f32 v91, v91, v98, v97
    v_mfma_f32_32x32x16_bf16 v[32:47], a[4:7], v[136:139], 0
    v_rcp_f32 v87, v87
    v_mul_f32 v90, v90, v58
    v_fma_f32 v88, v88, v99, v99
    v_mul_f32 v86, v86, v54
    v_cvt_pk_bf16_f32 v114, v84, v85
    v_mfma_f32_32x32x16_bf16 v[32:47], a[12:15], v[140:143], v[32:47]
    global_load_lds_dwordx4 v4, s[8:9] offset:2048
    v_exp_f32 v90, v90
    v_mul_f32 v93, v61, v61
    v_fma_f32 v92, v92, v98, v97
    v_mfma_f32_32x32x16_bf16 v[32:47], a[20:23], v[144:147], v[32:47]
    v_rcp_f32 v88, v88
    v_mul_f32 v91, v91, v59
    v_fma_f32 v89, v89, v99, v99
    v_mul_f32_e64 v87, v87, v55
    v_mfma_f32_32x32x16_bf16 v[32:47], a[28:31], v[148:151], v[32:47]
    global_load_lds_dwordx4 v5, s[8:9] offset:3072
    v_exp_f32 v91, v91
    v_mul_f32 v94, v62, v62
    v_fma_f32 v93, v93, v98, v97
    v_mfma_f32_32x32x16_bf16 v[32:47], a[36:39], v[152:155], v[32:47]
    v_rcp_f32 v89, v89
    v_mul_f32 v92, v92, v60
    v_fma_f32 v90, v90, v99, v99
    v_mul_f32_e64 v88, v88, v56
    v_cvt_pk_bf16_f32 v115, v86, v87
    v_mfma_f32_32x32x16_bf16 v[32:47], a[44:47], v[156:159], v[32:47]
    v_exp_f32 v92, v92
    v_mul_f32 v95, v63, v63
    v_fma_f32 v94, v94, v98, v97
    v_rcp_f32_e64 v90, v90
    v_mfma_f32_32x32x16_bf16 v[32:47], a[52:55], v[160:163], v[32:47]
    s_add_u32 m0, s69, 12288
    s_add_u32 s8, s10, s87
    s_addc_u32 s9, s11, 0
    global_load_lds_dwordx4 v2, s[8:9] offset:0
    v_mul_f32_e64 v93, v93, v61
    v_fma_f32 v91, v91, v99, v99
    v_mul_f32 v89, v89, v57
    v_mfma_f32_32x32x16_bf16 v[32:47], a[60:63], v[164:167], v[32:47]
    v_exp_f32 v93, v93
    v_fma_f32 v95, v95, v98, v97
    v_rcp_f32 v91, v91
    v_mul_f32 v94, v94, v62
    v_mfma_f32_32x32x16_bf16 v[32:47], a[68:71], v[168:171], v[32:47]
    global_load_lds_dwordx4 v3, s[8:9] offset:1024
    v_fma_f32 v92, v92, v99, v99
    v_mul_f32 v90, v90, v58
    v_cvt_pk_bf16_f32 v116, v88, v89
    v_exp_f32 v94, v94
    v_mfma_f32_32x32x16_bf16 v[32:47], a[76:79], v[172:175], v[32:47]
    s_waitcnt lgkmcnt(0)
    v_rcp_f32 v92, v92
    v_mul_f32 v95, v95, v63
    v_fma_f32 v93, v93, v99, v99
    v_mul_f32 v91, v91, v59
    v_exp_f32 v95, v95
    v_rcp_f32 v93, v93
    v_fma_f32 v94, v94, v99, v99
    v_mul_f32 v92, v92, v60
    v_cvt_pk_bf16_f32 v117, v90, v91
    v_rcp_f32 v94, v94
    v_fma_f32 v95, v95, v99, v99
    v_mul_f32 v93, v93, v61
    v_rcp_f32 v95, v95
    v_mul_f32 v94, v94, v62
    v_cvt_pk_bf16_f32 v118, v92, v93
    v_mul_f32 v95, v95, v63
    v_cvt_pk_bf16_f32 v119, v94, v95
    global_load_lds_dwordx4 v4, s[8:9] offset:2048
    ds_write_b128 v13, v[112:115] offset:4096
    ds_write_b128 v13, v[116:119] offset:6144
    global_load_lds_dwordx4 v5, s[8:9] offset:3072
    s_waitcnt lgkmcnt(0)
    v_mfma_f32_32x32x16_bf16 v[32:47], a[84:87], v[176:179], v[32:47]
    s_barrier
    ds_read_b128 v[136:139], v250 offset:0
    v_mul_f32 v80, v120, v120
    v_mul_f32 v81, v121, v121
    v_fma_f32 v80, v80, v102, v101
    v_mul_f32 v82, v122, v122
    v_fma_f32 v81, v81, v102, v101
    v_mfma_f32_32x32x16_bf16 v[32:47], a[92:95], v[180:183], v[32:47]
    s_add_u32 m0, s42, 98304
    s_add_u32 s8, s52, s88
    s_addc_u32 s9, s53, 0
    global_load_lds_dwordx4 v2, s[8:9] offset:0
    ds_read_b128 v[140:143], v250 offset:2048
    v_mul_f32 v80, v80, v120
    v_mfma_f32_32x32x16_bf16 v[32:47], a[100:103], v[184:187], v[32:47]
    ds_read_b128 v[144:147], v250 offset:4096
    v_exp_f32 v80, v80
    v_mul_f32 v83, v123, v123
    v_fma_f32 v82, v82, v102, v101
    v_mul_f32 v81, v81, v121
    v_mfma_f32_32x32x16_bf16 v[32:47], a[108:111], v[188:191], v[32:47]
    global_load_lds_dwordx4 v3, s[8:9] offset:1024
    ds_read_b128 v[148:151], v250 offset:6144
    v_exp_f32 v81, v81
    v_mul_f32 v84, v124, v124
    v_fma_f32 v83, v83, v102, v101
    v_mfma_f32_32x32x16_bf16 v[32:47], a[116:119], v[192:195], v[32:47]
    ds_read_b128 v[152:155], v250 offset:24576
    v_mul_f32 v82, v82, v122
    v_fma_f32 v80, v80, v103, v103
    v_exp_f32 v82, v82
    v_mul_f32 v85, v125, v125
    v_mfma_f32_32x32x16_bf16 v[32:47], a[124:127], v[196:199], v[32:47]
    ds_read_b128 v[156:159], v250 offset:26624
    v_fma_f32 v84, v84, v102, v101
    v_rcp_f32 v80, v80
    v_mul_f32 v83, v83, v123
    v_fma_f32 v81, v81, v103, v103
    v_mfma_f32_32x32x16_bf16 v[32:47], a[132:135], v[200:203], v[32:47]
    global_load_lds_dwordx4 v4, s[8:9] offset:2048
    ds_read_b128 v[160:163], v250 offset:28672
    v_exp_f32 v83, v83
    v_mul_f32 v86, v126, v126
    v_fma_f32 v85, v85, v102, v101
    v_mfma_f32_32x32x16_bf16 v[32:47], a[140:143], v[204:207], v[32:47]
    ds_read_b128 v[164:167], v250 offset:30720
    v_rcp_f32 v81, v81
    v_mul_f32 v84, v84, v124
    v_fma_f32 v82, v82, v103, v103
    v_mul_f32 v80, v80, v120
    v_mfma_f32_32x32x16_bf16 v[32:47], a[148:151], v[208:211], v[32:47]
    global_load_lds_dwordx4 v5, s[8:9] offset:3072
    ds_read_b128 v[168:171], v251 offset:0
    v_exp_f32 v84, v84
    v_mul_f32 v87, v127, v127
    v_fma_f32 v86, v86, v102, v101
    v_mfma_f32_32x32x16_bf16 v[32:47], a[156:159], v[212:215], v[32:47]
    ds_read_b128 v[172:175], v251 offset:2048
    v_rcp_f32 v82, v82
    v_mul_f32 v85, v85, v125
    v_fma_f32 v83, v83, v103, v103
    v_mul_f32 v81, v81, v121
    v_mfma_f32_32x32x16_bf16 v[32:47], a[164:167], v[216:219], v[32:47]
    s_add_u32 m0, s42, 102400
    s_add_u32 s8, s10, s88
    s_addc_u32 s9, s11, 0
    global_load_lds_dwordx4 v2, s[8:9] offset:0
    v_exp_f32 v85, v85
    v_mfma_f32_32x32x16_bf16 v[32:47], a[172:175], v[220:223], v[32:47]
    ds_read_b128 v[176:179], v251 offset:4096
    v_mul_f32 v88, v128, v128
    v_fma_f32 v87, v87, v102, v101
    v_rcp_f32 v83, v83
    v_mul_f32 v86, v86, v126
    v_mfma_f32_32x32x16_bf16 v[32:47], a[180:183], v[224:227], v[32:47]
    ds_read_b128 v[180:183], v251 offset:6144
    global_load_lds_dwordx4 v3, s[8:9] offset:1024
    ds_read_b128 v[184:187], v251 offset:24576
    v_fma_f32 v84, v84, v103, v103
    v_mul_f32 v82, v82, v122
    v_cvt_pk_bf16_f32 v112, v80, v81
    v_mfma_f32_32x32x16_bf16 v[32:47], a[188:191], v[228:231], v[32:47]
    ds_read_b128 v[188:191], v251 offset:26624
    v_exp_f32 v86, v86
    v_mul_f32 v89, v129, v129
    v_fma_f32 v88, v88, v102, v101
    v_mfma_f32_32x32x16_bf16 v[32:47], a[196:199], v[232:235], v[32:47]
    ds_read_b128 v[192:195], v251 offset:28672
    v_rcp_f32 v84, v84
    v_mul_f32 v87, v87, v127
    v_fma_f32 v85, v85, v103, v103
    v_mul_f32 v83, v83, v123
    s_waitcnt vmcnt(6)
    v_mfma_f32_32x32x16_bf16 v[32:47], a[204:207], v[236:239], v[32:47]
    s_barrier
    global_load_lds_dwordx4 v4, s[8:9] offset:2048
    ds_read_b128 v[196:199], v251 offset:30720
    ds_read_b64_tr_b16 a[128:129], v15 offset:0
    v_exp_f32 v87, v87
    v_mul_f32 v90, v130, v130
    v_mfma_f32_32x32x16_bf16 v[32:47], a[212:215], v[240:243], v[32:47]
    ds_read_b64_tr_b16 a[130:131], v15 offset:1024
    ds_read_b64_tr_b16 a[136:137], v15 offset:2048
    v_fma_f32 v89, v89, v102, v101
    v_rcp_f32 v85, v85
    v_mul_f32 v88, v88, v128
    v_mfma_f32_32x32x16_bf16 v[32:47], a[220:223], v[244:247], v[32:47]
    global_load_lds_dwordx4 v5, s[8:9] offset:3072
    ds_read_b64_tr_b16 a[138:139], v15 offset:3072
    ds_read_b64_tr_b16 a[144:145], v15 offset:4096
    v_fma_f32 v86, v86, v103, v103
    v_mul_f32 v84, v84, v124
    v_cvt_pk_bf16_f32 v113, v82, v83
    v_mfma_f32_32x32x16_bf16 v[32:47], v[76:79], v[108:111], v[32:47]
    s_waitcnt lgkmcnt(8)
    ds_read_b64_tr_b16 a[146:147], v15 offset:5120
    ds_read_b64_tr_b16 a[152:153], v15 offset:6144
    v_exp_f32 v88, v88
    v_mul_f32 v91, v131, v131
    v_fma_f32 v90, v90, v102, v101
    v_mfma_f32_32x32x16_bf16 v[48:63], a[0:3], v[136:139], 0
    s_add_u32 m0, s42, 131072
    s_add_u32 s8, s52, s89
    s_addc_u32 s9, s53, 0
    global_load_lds_dwordx4 v2, s[8:9] offset:0
    ds_read_b64_tr_b16 a[154:155], v15 offset:7168
    ds_read_b64_tr_b16 a[160:161], v15 offset:24576
    v_mfma_f32_32x32x16_bf16 v[48:63], a[8:11], v[140:143], v[48:63]
    ds_read_b64_tr_b16 a[162:163], v15 offset:25600
    ds_read_b64_tr_b16 a[168:169], v15 offset:26624
    v_rcp_f32 v86, v86
    v_mul_f32 v89, v89, v129
    v_fma_f32 v87, v87, v103, v103
    v_mfma_f32_32x32x16_bf16 v[48:63], a[16:19], v[144:147], v[48:63]
    global_load_lds_dwordx4 v3, s[8:9] offset:1024
    ds_read_b64_tr_b16 a[170:171], v15 offset:27648
    ds_read_b64_tr_b16 a[176:177], v15 offset:28672
    v_mul_f32 v85, v85, v125
    v_exp_f32 v89, v89
    v_mfma_f32_32x32x16_bf16 v[48:63], a[24:27], v[148:151], v[48:63]
    ds_read_b64_tr_b16 a[178:179], v15 offset:29696
    ds_read_b64_tr_b16 a[184:185], v15 offset:30720
    v_mul_f32 v92, v132, v132
    v_fma_f32 v91, v91, v102, v101
    v_rcp_f32 v87, v87
    v_mfma_f32_32x32x16_bf16 v[48:63], a[32:35], v[152:155], v[48:63]
    global_load_lds_dwordx4 v4, s[8:9] offset:2048
    ds_read_b64_tr_b16 a[186:187], v15 offset:31744
    ds_read_b64_tr_b16 a[192:193], v16 offset:0
    v_mul_f32 v90, v90, v130
    v_fma_f32 v88, v88, v103, v103
    v_mul_f32 v86, v86, v126
    v_mfma_f32_32x32x16_bf16 v[48:63], a[40:43], v[156:159], v[48:63]
    ds_read_b64_tr_b16 a[194:195], v16 offset:1024
    ds_read_b64_tr_b16 a[200:201], v16 offset:2048
    v_cvt_pk_bf16_f32 v114, v84, v85
    v_exp_f32 v90, v90
    v_mul_f32 v93, v133, v133
    v_mfma_f32_32x32x16_bf16 v[48:63], a[48:51], v[160:163], v[48:63]
    ds_read_b64_tr_b16 a[202:203], v16 offset:3072
    ds_read_b64_tr_b16 a[208:209], v16 offset:4096
    v_fma_f32 v92, v92, v102, v101
    v_rcp_f32 v88, v88
    v_mul_f32 v91, v91, v131
    v_mfma_f32_32x32x16_bf16 v[48:63], a[56:59], v[164:167], v[48:63]
    global_load_lds_dwordx4 v5, s[8:9] offset:3072
    ds_read_b64_tr_b16 a[210:211], v16 offset:5120
    ds_read_b64_tr_b16 a[216:217], v16 offset:6144
    v_fma_f32 v89, v89, v103, v103
    v_mul_f32_e64 v87, v87, v127
    v_mfma_f32_32x32x16_bf16 v[48:63], a[64:67], v[168:171], v[48:63]
    ds_read_b64_tr_b16 a[218:219], v16 offset:7168
    ds_read_b64_tr_b16 a[4:5], v16 offset:24576
    v_exp_f32 v91, v91
    v_mul_f32 v94, v134, v134
    v_fma_f32 v93, v93, v102, v101
    v_mfma_f32_32x32x16_bf16 v[48:63], a[72:75], v[172:175], v[48:63]
    s_add_u32 m0, s42, 135168
    s_add_u32 s8, s10, s89
    s_addc_u32 s9, s11, 0
    global_load_lds_dwordx4 v2, s[8:9] offset:0
    ds_read_b64_tr_b16 a[6:7], v16 offset:25600
    ds_read_b64_tr_b16 a[12:13], v16 offset:26624
    v_mfma_f32_32x32x16_bf16 v[48:63], a[80:83], v[176:179], v[48:63]
    ds_read_b64_tr_b16 a[14:15], v16 offset:27648
    ds_read_b64_tr_b16 a[20:21], v16 offset:28672
    v_rcp_f32 v89, v89
    v_mul_f32 v92, v92, v132
    v_fma_f32 v90, v90, v103, v103
    v_mfma_f32_32x32x16_bf16 v[48:63], a[88:91], v[180:183], v[48:63]
    global_load_lds_dwordx4 v3, s[8:9] offset:1024
    ds_read_b64_tr_b16 a[22:23], v16 offset:29696
    ds_read_b64_tr_b16 a[28:29], v16 offset:30720
    v_mul_f32 v88, v88, v128
    v_cvt_pk_bf16_f32 v115, v86, v87
    v_mfma_f32_32x32x16_bf16 v[48:63], a[96:99], v[184:187], v[48:63]
    s_waitcnt lgkmcnt(14)
    ds_read_b64_tr_b16 a[30:31], v16 offset:31744
    v_exp_f32 v92, v92
    v_mul_f32 v95, v135, v135
    v_fma_f32 v94, v94, v102, v101
    v_mfma_f32_32x32x16_bf16 v[48:63], a[104:107], v[188:191], v[48:63]
    global_load_lds_dwordx4 v4, s[8:9] offset:2048
    v_rcp_f32 v90, v90
    v_mul_f32 v93, v93, v133
    v_fma_f32 v91, v91, v103, v103
    v_mul_f32 v89, v89, v129
    v_mfma_f32_32x32x16_bf16 v[48:63], a[112:115], v[192:195], v[48:63]
    v_exp_f32 v93, v93
    v_fma_f32 v95, v95, v102, v101
    v_rcp_f32 v91, v91
    v_mul_f32 v94, v94, v134
    v_mfma_f32_32x32x16_bf16 v[48:63], a[120:123], v[196:199], v[48:63]
    v_fma_f32 v92, v92, v103, v103
    v_mul_f32 v90, v90, v130
    v_cvt_pk_bf16_f32 v116, v88, v89
    v_exp_f32 v94, v94
    v_mfma_f32_32x32x16_bf16 v[64:79], a[128:131], v[136:139], 0
    global_load_lds_dwordx4 v5, s[8:9] offset:3072
    v_rcp_f32 v92, v92
    v_mul_f32 v95, v95, v135
    v_fma_f32 v93, v93, v103, v103
    v_mul_f32 v91, v91, v131
    v_mfma_f32_32x32x16_bf16 v[64:79], a[136:139], v[140:143], v[64:79]
    v_exp_f32 v95, v95
    v_rcp_f32 v93, v93
    v_fma_f32 v94, v94, v103, v103
    v_mul_f32 v92, v92, v132
    v_mfma_f32_32x32x16_bf16 v[64:79], a[144:147], v[144:147], v[64:79]
    v_add_u32 v48, 0x10000, v48
    v_and_b32 v48, 0xfffe0000, v48
    v_add_u32 v56, 0x10000, v56
    v_and_b32 v56, 0xfffe0000, v56
    v_cvt_pk_bf16_f32 v48, v48, v49
    v_cvt_pk_bf16_f32 v49, v50, v51
    v_mfma_f32_32x32x16_bf16 v[64:79], a[152:155], v[148:151], v[64:79]
    v_cvt_pk_bf16_f32 v50, v52, v53
    v_cvt_pk_bf16_f32 v51, v54, v55
    v_cvt_pk_bf16_f32 v52, v56, v57
    v_cvt_pk_bf16_f32 v53, v58, v59
    v_cvt_pk_bf16_f32 v54, v60, v61
    v_cvt_pk_bf16_f32 v55, v62, v63
    v_mfma_f32_32x32x16_bf16 v[64:79], a[160:163], v[152:155], v[64:79]
    s_add_u32 s3, s93, 16777216
    buffer_store_dwordx4 v[48:51], v1, s[16:19], s3 offen offset:0 sc1
    v_mfma_f32_32x32x16_bf16 v[64:79], a[168:171], v[156:159], v[64:79]
    buffer_store_dwordx4 v[52:55], v1, s[16:19], s3 offen offset:1024 sc1
    v_mfma_f32_32x32x16_bf16 v[64:79], a[176:179], v[160:163], v[64:79]
    v_cvt_pk_bf16_f32 v117, v90, v91
    v_rcp_f32_e64 v94, v94
    v_fma_f32 v95, v95, v103, v103
    v_mul_f32 v93, v93, v133
    v_mfma_f32_32x32x16_bf16 v[64:79], a[184:187], v[164:167], v[64:79]
    s_waitcnt lgkmcnt(0)
    v_rcp_f32 v95, v95
    v_mul_f32 v94, v94, v134
    v_cvt_pk_bf16_f32 v118, v92, v93
    v_mul_f32_e64 v95, v95, v135
    v_cvt_pk_bf16_f32 v119, v94, v95
    v_mfma_f32_32x32x16_bf16 v[64:79], a[192:195], v[168:171], v[64:79]
    ds_write_b128 v13, v[112:115] offset:1024
    v_mfma_f32_32x32x16_bf16 v[64:79], a[200:203], v[172:175], v[64:79]
    ds_write_b128 v13, v[116:119] offset:3072
    v_mul_f32 v80, v32, v32
    s_waitcnt lgkmcnt(0)
    s_barrier
    v_mfma_f32_32x32x16_bf16 v[64:79], a[208:211], v[176:179], v[64:79]
    s_add_u32 m0, s69, 0
    s_add_u32 s8, s52, s90
    s_addc_u32 s9, s53, 0
    global_load_lds_dwordx4 v2, s[8:9] offset:0
    ds_read_b128 v[200:203], v250 offset:1024
    v_mul_f32_e64 v81, v33, v33
    v_mfma_f32_32x32x16_bf16 v[64:79], a[216:219], v[180:183], v[64:79]
    ds_read_b128 v[204:207], v250 offset:3072
    ds_read_b128 v[208:211], v250 offset:25600
    v_fma_f32 v80, v80, v102, v101
    v_mul_f32 v82, v34, v34
    v_fma_f32 v81, v81, v102, v101
    v_mul_f32 v80, v80, v32
    v_mfma_f32_32x32x16_bf16 v[64:79], a[4:7], v[184:187], v[64:79]
L_pg7:
    s_cbranch_execz L_pgt
    ds_read_b128 v[212:215], v250 offset:27648
    global_load_lds_dwordx4 v3, s[8:9] offset:1024
    ds_read_b128 v[216:219], v251 offset:1024
    v_exp_f32 v80, v80
    v_mul_f32_e64 v83, v35, v35
    v_mfma_f32_32x32x16_bf16 v[64:79], a[12:15], v[188:191], v[64:79]
    ds_read_b128 v[220:223], v251 offset:3072
    ds_read_b128 v[224:227], v251 offset:25600
    v_fma_f32 v82, v82, v102, v101
    v_mul_f32 v81, v81, v33
    v_exp_f32 v81, v81
    v_mfma_f32_32x32x16_bf16 v[64:79], a[20:23], v[192:195], v[64:79]
    ds_read_b128 v[228:231], v251 offset:27648
    global_load_lds_dwordx4 v4, s[8:9] offset:2048
    v_mul_f32 v84, v36, v36
    v_fma_f32 v83, v83, v102, v101
    v_mul_f32 v82, v82, v34
    v_fma_f32 v80, v80, v103, v103
    v_mfma_f32_32x32x16_bf16 v[64:79], a[28:31], v[196:199], v[64:79]
    s_waitcnt lgkmcnt(7)
    v_exp_f32 v82, v82
    v_mul_f32_e64 v85, v37, v37
    v_fma_f32 v84, v84, v102, v101
    v_rcp_f32 v80, v80
    v_mfma_f32_32x32x16_bf16 v[48:63], a[0:3], v[200:203], 0
    s_waitcnt lgkmcnt(6)
    global_load_lds_dwordx4 v5, s[8:9] offset:3072
    v_mul_f32_e64 v83, v83, v35
    v_fma_f32 v81, v81, v103, v103
    v_exp_f32_e64 v83, v83
    v_mul_f32_e64 v86, v38, v38
    v_mfma_f32_32x32x16_bf16 v[48:63], a[8:11], v[204:207], v[48:63]
    s_waitcnt lgkmcnt(4)
    v_fma_f32 v85, v85, v102, v101
    v_rcp_f32 v81, v81
    v_mul_f32_e64 v84, v84, v36
    v_fma_f32 v82, v82, v103, v103
    v_mul_f32 v80, v80, v32
    v_mfma_f32_32x32x16_bf16 v[48:63], a[32:35], v[208:211], v[48:63]
    s_add_u32 m0, s69, 4096
    s_add_u32 s8, s10, s90
    s_addc_u32 s9, s11, 0
    global_load_lds_dwordx4 v2, s[8:9] offset:0
    v_add_u32 v64, 0x10000, v64
    v_and_b32 v64, 0xfffe0000, v64
    v_add_u32 v72, 0x10000, v72
    v_mfma_f32_32x32x16_bf16 v[48:63], a[40:43], v[212:215], v[48:63]
    s_waitcnt lgkmcnt(0)
    v_and_b32 v72, 0xfffe0000, v72
    v_cvt_pk_bf16_f32 v64, v64, v65
    v_cvt_pk_bf16_f32 v65, v66, v67
    v_cvt_pk_bf16_f32 v66, v68, v69
    v_cvt_pk_bf16_f32 v67, v70, v71
    v_cvt_pk_bf16_f32 v68, v72, v73
    v_mfma_f32_32x32x16_bf16 v[48:63], a[64:67], v[216:219], v[48:63]
    global_load_lds_dwordx4 v3, s[8:9] offset:1024
    v_cvt_pk_bf16_f32 v69, v74, v75
    v_cvt_pk_bf16_f32 v70, v76, v77
    v_cvt_pk_bf16_f32 v71, v78, v79
    s_add_u32 s3, s93, 18874368
    v_mfma_f32_32x32x16_bf16 v[48:63], a[72:75], v[220:223], v[48:63]
    buffer_store_dwordx4 v[64:67], v1, s[16:19], s3 offen offset:0 sc1
    v_mfma_f32_32x32x16_bf16 v[48:63], a[96:99], v[224:227], v[48:63]
    buffer_store_dwordx4 v[68:71], v1, s[16:19], s3 offen offset:1024 sc1
    v_mfma_f32_32x32x16_bf16 v[48:63], a[104:107], v[228:231], v[48:63]
    v_exp_f32 v84, v84
    v_mul_f32 v87, v39, v39
    v_fma_f32 v86, v86, v102, v101
    v_rcp_f32 v82, v82
    v_mfma_f32_32x32x16_bf16 v[64:79], a[128:131], v[200:203], 0
    v_mul_f32 v85, v85, v37
    v_fma_f32 v83, v83, v103, v103
    v_mul_f32 v81, v81, v33
    v_exp_f32 v85, v85
    v_mul_f32 v88, v40, v40
    v_mfma_f32_32x32x16_bf16 v[64:79], a[136:139], v[204:207], v[64:79]
    v_fma_f32 v87, v87, v102, v101
    v_rcp_f32 v83, v83
    v_mul_f32 v86, v86, v38
    v_fma_f32 v84, v84, v103, v103
    v_mul_f32 v82, v82, v34
    v_mfma_f32_32x32x16_bf16 v[64:79], a[160:163], v[208:211], v[64:79]
    v_cvt_pk_bf16_f32 v112, v80, v81
    v_exp_f32 v86, v86
    v_mul_f32 v89, v41, v41
    v_fma_f32 v88, v88, v102, v101
    v_mfma_f32_32x32x16_bf16 v[64:79], a[168:171], v[212:215], v[64:79]
    global_load_lds_dwordx4 v4, s[8:9] offset:2048
    v_rcp_f32 v84, v84
    v_mul_f32 v87, v87, v39
    v_fma_f32 v85, v85, v103, v103
    v_mul_f32 v83, v83, v35
    v_mfma_f32_32x32x16_bf16 v[64:79], a[192:195], v[216:219], v[64:79]
    v_exp_f32 v87, v87
    v_mul_f32 v90, v42, v42
    v_fma_f32 v89, v89, v102, v101
    v_rcp_f32 v85, v85
    v_mfma_f32_32x32x16_bf16 v[64:79], a[200:203], v[220:223], v[64:79]
    global_load_lds_dwordx4 v5, s[8:9] offset:3072
    v_mul_f32 v88, v88, v40
    v_fma_f32 v86, v86, v103, v103
    v_mul_f32 v84, v84, v36
    v_cvt_pk_bf16_f32 v113, v82, v83
    v_exp_f32 v88, v88
    v_mul_f32 v91, v43, v43
    v_fma_f32 v90, v90, v102, v101
    v_rcp_f32 v86, v86
    v_mul_f32 v89, v89, v41
    v_fma_f32 v87, v87, v103, v103
    v_mul_f32 v85, v85, v37
    v_exp_f32 v89, v89
    v_mul_f32 v92, v44, v44
    v_fma_f32 v91, v91, v102, v101
    v_rcp_f32 v87, v87
    v_mul_f32 v90, v90, v42
    v_fma_f32 v88, v88, v103, v103
    v_mul_f32 v86, v86, v38
    v_cvt_pk_bf16_f32 v114, v84, v85
    v_exp_f32 v90, v90
    v_mul_f32 v93, v45, v45
    v_fma_f32 v92, v92, v102, v101
    v_rcp_f32 v88, v88
    v_mul_f32 v91, v91, v43
    v_fma_f32 v89, v89, v103, v103
    v_mul_f32 v87, v87, v39
    v_exp_f32 v91, v91
    v_mul_f32_e64 v94, v46, v46
    v_fma_f32 v93, v93, v102, v101
    v_rcp_f32_e64 v89, v89
    v_mul_f32 v92, v92, v44
    v_fma_f32 v90, v90, v103, v103
    v_mul_f32 v88, v88, v40
    v_cvt_pk_bf16_f32 v115, v86, v87
    v_exp_f32 v92, v92
    v_mul_f32 v95, v47, v47
    v_fma_f32 v94, v94, v102, v101
    v_rcp_f32 v90, v90
    v_mul_f32 v93, v93, v45
    v_fma_f32 v91, v91, v103, v103
    v_mul_f32 v89, v89, v41
    v_exp_f32 v93, v93
    v_fma_f32 v95, v95, v102, v101
    v_rcp_f32 v91, v91
    v_mul_f32 v94, v94, v46
    v_fma_f32 v92, v92, v103, v103
    v_mul_f32 v90, v90, v42
    v_cvt_pk_bf16_f32 v116, v88, v89
    v_exp_f32 v94, v94
    v_rcp_f32 v92, v92
    v_mul_f32 v95, v95, v47
    v_fma_f32 v93, v93, v103, v103
    v_mul_f32 v91, v91, v43
    v_exp_f32 v95, v95
    v_rcp_f32 v93, v93
    v_fma_f32 v94, v94, v103, v103
    v_mul_f32 v92, v92, v44
    v_cvt_pk_bf16_f32 v117, v90, v91
    v_rcp_f32 v94, v94
    v_fma_f32 v95, v95, v103, v103
    v_mul_f32 v93, v93, v45
    v_rcp_f32 v95, v95
    v_mul_f32 v94, v94, v46
    v_cvt_pk_bf16_f32 v118, v92, v93
    v_mul_f32_e64 v95, v95, v47
    v_cvt_pk_bf16_f32 v119, v94, v95
    ds_write_b128 v13, v[112:115] offset:5120
    ds_write_b128 v13, v[116:119] offset:7168
    s_waitcnt vmcnt(12) lgkmcnt(0)
    v_mfma_f32_32x32x16_bf16 v[64:79], a[4:7], v[224:227], v[64:79]
    s_barrier
    ds_read_b128 v[232:235], v250 offset:5120
    ds_read_b128 v[236:239], v250 offset:7168
    ds_read_b128 v[240:243], v250 offset:29696
    ds_read_b128 v[244:247], v250 offset:31744
    v_mfma_f32_32x32x16_bf16 v[64:79], a[12:15], v[228:231], v[64:79]
    s_waitcnt vmcnt(2)
    s_cmp_eq_u32 s34, 0
    s_cbranch_scc1 L_rem_11
    s_mov_b64 exec, 1
    buffer_store_dword a244, off, s[16:19], s50
    s_mov_b64 exec, -1
L_std_12:
    s_waitcnt lgkmcnt(3)
    v_mfma_f32_32x32x16_bf16 v[48:63], a[16:19], v[232:235], v[48:63]
    s_nop 0
    ds_read_b128 v[120:123], v251 offset:5120
    ds_read_b128 v[124:127], v251 offset:7168
    s_waitcnt lgkmcnt(4)
    ds_read_b128 v[128:131], v251 offset:29696
    ds_read_b128 v[132:135], v251 offset:31744
    v_mfma_f32_32x32x16_bf16 v[48:63], a[24:27], v[236:239], v[48:63]
    v_bfe_u32 v30, v0, 3, 2
    v_bfe_u32 v31, v0, 1, 1
    v_lshl_add_u32 v30, v30, 1, v31
    v_lshrrev_b32 v31, 3, v0
    s_waitcnt lgkmcnt(5)
    v_mfma_f32_32x32x16_bf16 v[48:63], a[48:51], v[240:243], v[48:63]
    ds_read_b64_tr_b16 a[36:37], v14 offset:0
    ds_read_b64_tr_b16 a[38:39], v14 offset:1024
    v_xor_b32 v31, v31, v0
    v_and_b32 v31, 4, v31
    v_lshl_add_u32 v30, v31, 1, v30
    v_and_b32 v31, 1, v0
    s_waitcnt lgkmcnt(6)
    v_mfma_f32_32x32x16_bf16 v[48:63], a[56:59], v[244:247], v[48:63]
    ds_read_b64_tr_b16 a[44:45], v14 offset:2048
    ds_read_b64_tr_b16 a[46:47], v14 offset:3072
    v_lshlrev_b32_e64 v31, 4, v31
    v_mov_b32 v29, 0x3f80
    v_lshlrev_b32 v31, v31, v29
    v_lshlrev_b32 v30, v30, 1
    s_waitcnt lgkmcnt(7)
    v_mfma_f32_32x32x16_bf16 v[48:63], a[80:83], v[120:123], v[48:63]
    s_waitcnt lgkmcnt(6)
    ds_read_b64_tr_b16 a[52:53], v14 offset:4096
    ds_read_b64_tr_b16 a[54:55], v14 offset:5120
    v_bfe_i32 v112, v30, 0, 1
    v_and_b32 v112, v31, v112
    v_bfe_i32 v113, v30, 1, 1
    v_and_b32 v113, v31, v113
    v_bfe_i32 v114, v30, 2, 1
    v_mfma_f32_32x32x16_bf16 v[48:63], a[88:91], v[124:127], v[48:63]
    s_waitcnt lgkmcnt(7)
    ds_read_b64_tr_b16 a[60:61], v14 offset:6144
    ds_read_b64_tr_b16 a[62:63], v14 offset:7168
    v_and_b32_e64 v114, v31, v114
    v_bfe_i32 v115, v30, 3, 1
    v_and_b32 v115, v31, v115
    v_bfe_i32 v116, v30, 4, 1
    v_mfma_f32_32x32x16_bf16 v[48:63], a[112:115], v[128:131], v[48:63]
    s_waitcnt lgkmcnt(8)
    ds_read_b64_tr_b16 a[68:69], v14 offset:8192
    ds_read_b64_tr_b16 a[70:71], v14 offset:9216
    v_and_b32 v116, v31, v116
    v_bfe_i32 v117, v30, 5, 1
    v_and_b32 v117, v31, v117
    v_bfe_i32 v118, v30, 6, 1
    v_mfma_f32_32x32x16_bf16 v[48:63], a[120:123], v[132:135], v[48:63]
    ds_read_b64_tr_b16 a[76:77], v14 offset:10240
    ds_read_b64_tr_b16 a[78:79], v14 offset:11264
    v_and_b32_e64 v118, v31, v118
    v_bfe_i32 v119, v30, 7, 1
    v_and_b32_e64 v119, v31, v119
    v_mfma_f32_32x32x16_bf16 v[64:79], a[144:147], v[232:235], v[64:79]
    ds_read_b64_tr_b16 a[84:85], v14 offset:12288
    ds_read_b64_tr_b16 a[86:87], v14 offset:13312
    ds_read_b64_tr_b16 a[92:93], v14 offset:14336
    ds_read_b64_tr_b16 a[94:95], v14 offset:15360
    v_mfma_f32_32x32x16_bf16 v[64:79], a[152:155], v[236:239], v[64:79]
    ds_read_b64_tr_b16 a[100:101], v14 offset:16384
    ds_read_b64_tr_b16 a[102:103], v14 offset:17408
    v_mfma_f32_32x32x16_bf16 v[64:79], a[176:179], v[240:243], v[64:79]
    v_add_u32 v48, 0x10000, v48
    v_and_b32 v48, 0xfffe0000, v48
    v_add_u32 v56, 0x10000, v56
    v_and_b32 v56, 0xfffe0000, v56
    v_mfma_f32_32x32x16_bf16 v[64:79], a[184:187], v[244:247], v[64:79]
    ds_read_b64_tr_b16 a[108:109], v14 offset:18432
    ds_read_b64_tr_b16 a[110:111], v14 offset:19456
    v_cvt_pk_bf16_f32 v48, v48, v49
    v_cvt_pk_bf16_f32 v49, v50, v51
    v_cvt_pk_bf16_f32 v50, v52, v53
    v_cvt_pk_bf16_f32 v51, v54, v55
    v_mfma_f32_32x32x16_bf16 v[64:79], a[208:211], v[120:123], v[64:79]
    ds_read_b64_tr_b16 a[116:117], v14 offset:20480
    ds_read_b64_tr_b16 a[118:119], v14 offset:21504
    v_cvt_pk_bf16_f32 v52, v56, v57
    v_cvt_pk_bf16_f32 v53, v58, v59
    v_cvt_pk_bf16_f32 v54, v60, v61
    v_cvt_pk_bf16_f32 v55, v62, v63
    v_mfma_f32_32x32x16_bf16 v[64:79], a[216:219], v[124:127], v[64:79]
    ds_read_b64_tr_b16 a[124:125], v14 offset:22528
    ds_read_b64_tr_b16 a[126:127], v14 offset:23552
    s_add_u32 s3, s93, 2097152
    ds_read_b64_tr_b16 a[132:133], v14 offset:24576
    ds_read_b64_tr_b16 a[134:135], v14 offset:25600
    v_mfma_f32_32x32x16_bf16 v[64:79], a[20:23], v[128:131], v[64:79]
    v_mfma_f32_32x32x16_bf16 v[64:79], a[28:31], v[132:135], v[64:79]
    s_waitcnt lgkmcnt(8)
    ds_read_b64_tr_b16 a[140:141], v14 offset:26624
    ds_read_b64_tr_b16 a[142:143], v14 offset:27648
    buffer_store_dwordx4 v[48:51], v1, s[16:19], s3 offen offset:0 sc1
    buffer_store_dwordx4 v[52:55], v1, s[16:19], s3 offen offset:1024 sc1
    v_mfma_f32_32x32x16_bf16 v[32:47], a[36:39], v[136:139], 0
    s_nop 0
    ds_read_b64_tr_b16 a[148:149], v14 offset:28672
    ds_read_b64_tr_b16 a[150:151], v14 offset:29696
    s_mul_i32 s45, s37, -14694400
    s_add_u32 s36, s76, s45
    s_add_u32 s36, s36, 16777216
    s_add_u32 s41, s75, s45
    s_add_u32 s41, s41, 16791552
    v_mfma_f32_32x32x16_bf16 v[32:47], a[44:47], v[140:143], v[32:47]
    s_mul_i32 s45, s37, -14694400
    ds_read_b64_tr_b16 a[156:157], v14 offset:30720
    ds_read_b64_tr_b16 a[158:159], v14 offset:31744
    s_add_u32 s43, s74, s45
    s_add_u32 s43, s43, 18874368
    s_add_u32 s44, s73, s45
    s_add_u32 s44, s44, 18888704
    v_mfma_f32_32x32x16_bf16 v[32:47], a[52:55], v[144:147], v[32:47]
    s_mul_i32 s45, s37, 2082816
    v_add_u32 v64, 0x10000, v64
    v_and_b32 v64, 0xfffe0000, v64
    v_add_u32 v72, 0x10000, v72
    v_and_b32 v72, 0xfffe0000, v72
    v_cvt_pk_bf16_f32 v64, v64, v65
    v_cvt_pk_bf16_f32 v65, v66, v67
    v_mfma_f32_32x32x16_bf16 v[32:47], a[60:63], v[148:151], v[32:47]
    v_cvt_pk_bf16_f32 v66, v68, v69
    v_cvt_pk_bf16_f32 v67, v70, v71
    v_cvt_pk_bf16_f32 v68, v72, v73
    v_cvt_pk_bf16_f32 v69, v74, v75
    v_cvt_pk_bf16_f32 v70, v76, v77
    v_cvt_pk_bf16_f32 v71, v78, v79
    v_mfma_f32_32x32x16_bf16 v[32:47], a[68:71], v[152:155], v[32:47]
    buffer_load_dword v253, v252, s[16:19], s49 offen sc1
    s_add_u32 s3, s93, 4194304
    s_cmp_eq_u32 s34, 0
    s_cbranch_scc1 L_rem_13
    buffer_store_dwordx4 v[64:67], v1, s[16:19], s3 offen offset:0
    buffer_store_dwordx4 v[68:71], v1, s[16:19], s3 offen offset:1024
L_std_14:
    s_add_u32 s46, s72, s45
    s_add_u32 s46, s46, 6291456
    s_add_u32 s47, s71, s45
    s_add_u32 s47, s47, 6305792
    s_mov_b32 s24, s54
    s_mov_b32 s25, s55
    s_mov_b32 s26, 1835008
    s_lshr_b32 s45, s68, 2
    s_lshl1_add_u32 s45, s45, s37
    s_mul_i32 s45, s45, 28672
    s_lshl1_add_u32 s65, s66, s38
    s_lshl_b32 s65, s65, 6
    s_add_u32 s48, s45, s65
    v_and_b32_e64 v30, 31, v0
    v_mul_u32_u24 v30, 896, v30
    v_lshrrev_b32 v31, 5, v0
    v_lshl_add_u32 v17, v31, 4, v30
    s_mov_b32 s6, 0x3f80
    s_mov_b32 s7, 0x3f800000
    s_lshl_b32 s45, s37, 13
    s_lshl_b32 s65, s37, 10
    v_subrev_u32 v15, s45, v15
    v_add_u32 v250, s65, v250
    v_subrev_u32 v16, s45, v16
    v_add_u32_e64 v251, s65, v251
    s_waitcnt vmcnt(6)
    v_mfma_f32_32x32x16_bf16 v[32:47], a[76:79], v[156:159], v[32:47]
    s_barrier
    ds_read_b64_tr_b16 a[0:1], v15 offset:0
    ds_read_b64_tr_b16 a[2:3], v15 offset:1024
    ds_read_b64_tr_b16 a[8:9], v15 offset:2048
    ds_read_b64_tr_b16 a[10:11], v15 offset:3072
    v_mfma_f32_32x32x16_bf16 v[32:47], a[84:87], v[160:163], v[32:47]
    ds_read_b64_tr_b16 a[16:17], v15 offset:4096
    ds_read_b64_tr_b16 a[18:19], v15 offset:5120
    v_mfma_f32_32x32x16_bf16 v[32:47], a[92:95], v[164:167], v[32:47]
    v_mfma_f32_32x32x16_bf16 v[32:47], a[100:103], v[168:171], v[32:47]
    s_waitcnt lgkmcnt(6)
    ds_read_b64_tr_b16 a[24:25], v15 offset:6144
    ds_read_b64_tr_b16 a[26:27], v15 offset:7168
    ds_read_b64_tr_b16 a[32:33], v15 offset:24576
    ds_read_b64_tr_b16 a[34:35], v15 offset:25600
    v_mfma_f32_32x32x16_bf16 v[32:47], a[108:111], v[172:175], v[32:47]
    s_nop 0
    ds_read_b64_tr_b16 a[40:41], v15 offset:26624
    ds_read_b64_tr_b16 a[42:43], v15 offset:27648
    v_mfma_f32_32x32x16_bf16 v[32:47], a[116:119], v[176:179], v[32:47]
    ds_read_b64_tr_b16 a[48:49], v15 offset:28672
    ds_read_b64_tr_b16 a[50:51], v15 offset:29696
    v_mfma_f32_32x32x16_bf16 v[32:47], a[124:127], v[180:183], v[32:47]
    ds_read_b64_tr_b16 a[56:57], v15 offset:30720
    ds_read_b64_tr_b16 a[58:59], v15 offset:31744
    v_mfma_f32_32x32x16_bf16 v[32:47], a[132:135], v[184:187], v[32:47]
    ds_read_b64_tr_b16 a[64:65], v16 offset:0
    ds_read_b64_tr_b16 a[66:67], v16 offset:1024
    v_mfma_f32_32x32x16_bf16 v[32:47], a[140:143], v[188:191], v[32:47]
    ds_read_b64_tr_b16 a[72:73], v16 offset:2048
    ds_read_b64_tr_b16 a[74:75], v16 offset:3072
    v_mfma_f32_32x32x16_bf16 v[32:47], a[148:151], v[192:195], v[32:47]
    ds_read_b64_tr_b16 a[80:81], v16 offset:4096
    ds_read_b64_tr_b16 a[82:83], v16 offset:5120
    v_mfma_f32_32x32x16_bf16 v[32:47], a[156:159], v[196:199], v[32:47]
    s_waitcnt vmcnt(2)
L_f1_C:
    v_cmp_ne_u32_e64 vcc, s67, v253
    s_cbranch_vccnz L_f1_S
L_f1_K:
    buffer_load_dwordx4 v[80:83], v1, s[16:19], s36 offen offset:0 sc1
    ds_read_b64_tr_b16 a[88:89], v16 offset:6144
    v_mfma_f32_32x32x16_bf16 v[48:63], a[36:39], v[200:203], 0
    ds_read_b64_tr_b16 a[90:91], v16 offset:7168
    ds_read_b64_tr_b16 a[96:97], v16 offset:24576
    ds_read_b64_tr_b16 a[98:99], v16 offset:25600
    v_mfma_f32_32x32x16_bf16 v[48:63], a[44:47], v[204:207], v[48:63]
    buffer_load_dwordx4 v[84:87], v1, s[16:19], s36 offen offset:1024 sc1
    ds_read_b64_tr_b16 a[104:105], v16 offset:26624
    ds_read_b64_tr_b16 a[106:107], v16 offset:27648
    v_mfma_f32_32x32x16_bf16 v[48:63], a[52:55], v[232:235], v[48:63]
    v_add_u32 v32, 0x10000, v32
    v_and_b32 v32, 0xfffe0000, v32
    ds_read_b64_tr_b16 a[112:113], v16 offset:28672
    ds_read_b64_tr_b16 a[114:115], v16 offset:29696
    v_mfma_f32_32x32x16_bf16 v[48:63], a[60:63], v[236:239], v[48:63]
    v_add_u32 v40, 0x10000, v40
    v_and_b32 v40, 0xfffe0000, v40
    v_cvt_pk_bf16_f32 v32, v32, v33
    v_cvt_pk_bf16_f32 v33, v34, v35
    v_mfma_f32_32x32x16_bf16 v[48:63], a[68:71], v[208:211], v[48:63]
    buffer_load_dwordx4 v[88:91], v1, s[16:19], s41 offen offset:0 sc1
    ds_read_b64_tr_b16 a[120:121], v16 offset:30720
    ds_read_b64_tr_b16 a[122:123], v16 offset:31744
    v_cvt_pk_bf16_f32 v34, v36, v37
    v_cvt_pk_bf16_f32 v35, v38, v39
    v_mfma_f32_32x32x16_bf16 v[48:63], a[76:79], v[212:215], v[48:63]
    ds_read_b128 v[136:139], v250 offset:0
    ds_read_b128 v[140:143], v250 offset:2048
    v_cvt_pk_bf16_f32 v36, v40, v41
    v_cvt_pk_bf16_f32 v37, v42, v43
    v_cvt_pk_bf16_f32 v38, v44, v45
    v_cvt_pk_bf16_f32 v39, v46, v47
    v_mfma_f32_32x32x16_bf16 v[48:63], a[84:87], v[240:243], v[48:63]
    buffer_load_dwordx4 v[92:95], v1, s[16:19], s41 offen offset:1024 sc1
    ds_read_b128 v[144:147], v250 offset:4096
    ds_read_b128 v[148:151], v250 offset:6144
    s_add_u32 s3, s93, 6291456
    s_cmp_eq_u32 s34, 0
    s_cbranch_scc1 L_rem_15
    buffer_store_dwordx4 v[32:35], v1, s[16:19], s3 offen offset:0
    buffer_store_dwordx4 v[36:39], v1, s[16:19], s3 offen offset:1024
L_std_16:
    v_mfma_f32_32x32x16_bf16 v[48:63], a[92:95], v[244:247], v[48:63]
    ds_read_b128 v[152:155], v250 offset:24576
    ds_read_b128 v[156:159], v250 offset:26624
    v_accvgpr_read_b32 v64, a224
    v_accvgpr_read_b32 v65, a225
    v_accvgpr_read_b32 v66, a226
    v_accvgpr_read_b32 v67, a227
    v_mfma_f32_32x32x16_bf16 v[48:63], a[100:103], v[216:219], v[48:63]
    ds_read_b128 v[160:163], v250 offset:28672
    ds_read_b128 v[164:167], v250 offset:30720
    v_accvgpr_read_b32 v68, a228
    v_accvgpr_read_b32 v69, a229
    v_accvgpr_read_b32 v70, a230
    v_accvgpr_read_b32 v71, a231
    v_mfma_f32_32x32x16_bf16 v[48:63], a[108:111], v[220:223], v[48:63]
    ds_read_b128 v[168:171], v251 offset:0
    ds_read_b128 v[172:175], v251 offset:2048
    v_accvgpr_read_b32 v72, a232
    v_accvgpr_read_b32 v73, a233
    v_accvgpr_read_b32 v74, a234
    v_accvgpr_read_b32 v75, a235
    v_mfma_f32_32x32x16_bf16 v[48:63], a[116:119], v[120:123], v[48:63]
    ds_read_b128 v[176:179], v251 offset:4096
    ds_read_b128 v[180:183], v251 offset:6144
    v_accvgpr_read_b32 v76, a236
    v_accvgpr_read_b32 v77, a237
    v_accvgpr_read_b32 v78, a238
    v_accvgpr_read_b32 v79, a239
    v_mfma_f32_32x32x16_bf16 v[48:63], a[124:127], v[124:127], v[48:63]
    buffer_load_dwordx4 v[96:99], v1, s[16:19], s43 offen offset:0 sc1
    ds_read_b128 v[184:187], v251 offset:24576
    ds_read_b128 v[188:191], v251 offset:26624
    ds_read_b128 v[192:195], v251 offset:28672
    ds_read_b128 v[196:199], v251 offset:30720
    v_mfma_f32_32x32x16_bf16 v[48:63], a[132:135], v[224:227], v[48:63]
    v_mfma_f32_32x32x16_bf16 v[48:63], a[140:143], v[228:231], v[48:63]
    v_mfma_f32_32x32x16_bf16 v[48:63], a[148:151], v[128:131], v[48:63]
    s_nop 0
    buffer_load_dwordx4 v[100:103], v1, s[16:19], s43 offen offset:1024 sc1
    v_mfma_f32_32x32x16_bf16 v[48:63], a[156:159], v[132:135], v[48:63]
    s_waitcnt lgkmcnt(15)
    buffer_load_dwordx4 v[104:107], v1, s[16:19], s44 offen offset:0 sc1
    buffer_load_dwordx4 v[108:111], v1, s[16:19], s44 offen offset:1024 sc1
    v_mfma_f32_32x32x16_bf16 v[64:79], a[0:3], v[136:139], v[64:79]
    s_waitcnt lgkmcnt(6)
    v_mfma_f32_32x32x16_bf16 v[64:79], a[8:11], v[140:143], v[64:79]
    v_mfma_f32_32x32x16_bf16 v[64:79], a[16:19], v[144:147], v[64:79]
    s_nop 4
    v_add_u32 v48, 0x10000, v48
    v_and_b32 v48, 0xfffe0000, v48
    v_add_u32 v56, 0x10000, v56
    v_and_b32 v56, 0xfffe0000, v56
    v_cvt_pk_bf16_f32 v48, v48, v49
    v_cvt_pk_bf16_f32 v49, v50, v51
    v_mfma_f32_32x32x16_bf16 v[64:79], a[24:27], v[148:151], v[64:79]
    v_cvt_pk_bf16_f32 v50, v52, v53
    v_cvt_pk_bf16_f32 v51, v54, v55
    v_cvt_pk_bf16_f32 v52, v56, v57
    v_cvt_pk_bf16_f32 v53, v58, v59
    v_cvt_pk_bf16_f32 v54, v60, v61
    v_cvt_pk_bf16_f32 v55, v62, v63
    v_mfma_f32_32x32x16_bf16 v[64:79], a[32:35], v[152:155], v[64:79]
    s_add_u32 s3, s93, 8388608
    s_cmp_eq_u32 s34, 0
    s_cbranch_scc1 L_rem_17
    buffer_store_dwordx4 v[48:51], v1, s[16:19], s3 offen offset:0
    buffer_store_dwordx4 v[52:55], v1, s[16:19], s3 offen offset:1024
L_std_18:
    v_mfma_f32_32x32x16_bf16 v[64:79], a[40:43], v[156:159], v[64:79]
    v_mfma_f32_32x32x16_bf16 v[64:79], a[48:51], v[160:163], v[64:79]
    v_mfma_f32_32x32x16_bf16 v[64:79], a[56:59], v[164:167], v[64:79]
    v_mfma_f32_32x32x16_bf16 v[64:79], a[64:67], v[168:171], v[64:79]
    v_mfma_f32_32x32x16_bf16 v[64:79], a[72:75], v[172:175], v[64:79]
    s_waitcnt lgkmcnt(0)
    v_mfma_f32_32x32x16_bf16 v[64:79], a[80:83], v[176:179], v[64:79]
    v_mfma_f32_32x32x16_bf16 v[64:79], a[88:91], v[180:183], v[64:79]
    v_mfma_f32_32x32x16_bf16 v[64:79], a[96:99], v[184:187], v[64:79]
    v_mfma_f32_32x32x16_bf16 v[64:79], a[104:107], v[188:191], v[64:79]
    s_waitcnt vmcnt(8)
L_fa_C:
    v_or3_b32 v28, v80, v84, v88
    v_or_b32 v28, v28, v92
    v_and_b32 v28, 1, v28
    v_cmp_ne_u32 vcc, 0, v28
    v_mfma_f32_32x32x16_bf16 v[64:79], a[112:115], v[192:195], v[64:79]
    s_cbranch_vccnz L_fa_S
L_fa_K:
    s_waitcnt vmcnt(2)
L_fb_C:
    v_or3_b32 v28, v96, v100, v104
    v_or_b32 v28, v28, v108
    v_and_b32 v28, 1, v28
    v_cmp_ne_u32_e64 vcc, 0, v28
    v_mfma_f32_32x32x16_bf16 v[64:79], a[120:123], v[196:199], v[64:79]
    s_cbranch_vccnz L_fb_S
L_fb_K:
    buffer_load_dwordx4 v[200:203], v1, s[16:19], s46 offen offset:0 sc1
    buffer_load_dwordx4 v[204:207], v1, s[16:19], s46 offen offset:1024 sc1
    v_mfma_f32_32x32x16_bf16 v[64:79], v[112:115], v[80:83], v[64:79]
    buffer_load_dwordx4 v[208:211], v1, s[16:19], s47 offen offset:0 sc1
    v_mfma_f32_32x32x16_bf16 v[64:79], v[116:119], v[84:87], v[64:79]
    buffer_load_dwordx4 v[212:215], v1, s[16:19], s47 offen offset:1024 sc1
    v_mfma_f32_32x32x16_bf16 v[64:79], v[112:115], v[88:91], v[64:79]
    v_mfma_f32_32x32x16_bf16 v[64:79], v[116:119], v[92:95], v[64:79]
    v_mfma_f32_32x32x16_bf16 v[64:79], v[112:115], v[96:99], v[64:79]
    v_mfma_f32_32x32x16_bf16 v[64:79], v[116:119], v[100:103], v[64:79]
    v_mfma_f32_32x32x16_bf16 v[64:79], v[112:115], v[104:107], v[64:79]
    v_mfma_f32_32x32x16_bf16 v[64:79], v[116:119], v[108:111], v[64:79]
    s_waitcnt vmcnt(0)
L_fl_C:
    v_or3_b32 v28, v200, v204, v208
    v_or_b32 v28, v28, v212
    v_and_b32 v28, 1, v28
    v_cmp_ne_u32 vcc, 0, v28
    s_cbranch_vccnz L_fl_S
L_fl_K:
    v_mfma_f32_32x32x16_bf16 v[64:79], v[112:115], v[200:203], v[64:79]
    v_mfma_f32_32x32x16_bf16 v[64:79], v[116:119], v[204:207], v[64:79]
    v_mfma_f32_32x32x16_bf16 v[64:79], v[112:115], v[208:211], v[64:79]
    v_mfma_f32_32x32x16_bf16 v[64:79], v[116:119], v[212:215], v[64:79]
    s_nop 11
    v_cvt_pk_bf16_f32 v112, v64, v65
    v_cvt_pk_bf16_f32 v113, v66, v67
    v_cvt_pk_bf16_f32 v114, v68, v69
    v_cvt_pk_bf16_f32 v115, v70, v71
    v_cvt_pk_bf16_f32 v116, v72, v73
    v_cvt_pk_bf16_f32 v117, v74, v75
    v_cvt_pk_bf16_f32 v118, v76, v77
    v_cvt_pk_bf16_f32 v119, v78, v79
    v_permlane32_swap_b32 v112, v114
    v_permlane32_swap_b32 v113, v115
    v_permlane32_swap_b32 v116, v118
    v_permlane32_swap_b32 v117, v119
    buffer_store_dwordx4 v[112:115], v17, s[24:27], s48 offen offset:0
    buffer_store_dwordx4 v[116:119], v17, s[24:27], s48 offen offset:32
L_fin:
L_end:
    s_endpgm
L_fl_S:
    s_add_u32 s81, s81, 1
    s_cmp_ge_u32 s81, 32768
    s_cbranch_scc1 L_fl_K
    buffer_load_dwordx4 v[200:203], v1, s[16:19], s46 offen offset:0 sc1
    buffer_load_dwordx4 v[204:207], v1, s[16:19], s46 offen offset:1024 sc1
    buffer_load_dwordx4 v[208:211], v1, s[16:19], s47 offen offset:0 sc1
    buffer_load_dwordx4 v[212:215], v1, s[16:19], s47 offen offset:1024 sc1
    s_waitcnt vmcnt(0)
    v_or3_b32 v28, v200, v204, v208
    v_or_b32 v28, v28, v212
    v_and_b32 v28, 1, v28
    v_cmp_ne_u32 vcc, 0, v28
    s_cbranch_vccnz L_fl_S
    s_branch L_fl_K
L_spare:
    s_sub_u32 s91, s91, 112
    s_lshl2_add_u32 s4, s60, s61
    s_sub_u32 s4, s4, 28
    s_cmp_ge_u32 s4, 28
    s_cbranch_scc1 L_spf
    s_mul_i32 s5, s62, 401408
    s_lshl_b32 s6, s4, 7
    s_add_u32 s5, s5, s6
    v_lshrrev_b32 v2, 3, v0
    v_mul_u32_u24 v2, 3584, v2
    v_and_b32_e64 v3, 7, v0
    v_lshl_add_u32 v2, v3, 4, v2
    buffer_load_dwordx4 v[32:35], v2, s[28:31], s5 offen
    s_add_u32 s5, s5, 28672
    buffer_load_dwordx4 v[36:39], v2, s[28:31], s5 offen
    s_add_u32 s5, s5, 28672
    buffer_load_dwordx4 v[40:43], v2, s[28:31], s5 offen
    s_add_u32 s5, s5, 28672
    buffer_load_dwordx4 v[44:47], v2, s[28:31], s5 offen
    s_add_u32 s5, s5, 28672
    buffer_load_dwordx4 v[48:51], v2, s[28:31], s5 offen
    s_add_u32 s5, s5, 28672
L_pg8:
    s_cbranch_execz L_pgt
    buffer_load_dwordx4 v[52:55], v2, s[28:31], s5 offen
    s_add_u32 s5, s5, 28672
    buffer_load_dwordx4 v[56:59], v2, s[28:31], s5 offen
    s_nop 0
    s_add_u32 s5, s5, 28672
    buffer_load_dwordx4 v[60:63], v2, s[28:31], s5 offen
    s_add_u32 s5, s5, 28672
    buffer_load_dwordx4 v[64:67], v2, s[28:31], s5 offen
    s_add_u32 s5, s5, 28672
    buffer_load_dwordx4 v[68:71], v2, s[28:31], s5 offen
    s_add_u32 s5, s5, 28672
    buffer_load_dwordx4 v[72:75], v2, s[28:31], s5 offen
    s_add_u32 s5, s5, 28672
    buffer_load_dwordx4 v[76:79], v2, s[28:31], s5 offen
    s_add_u32 s5, s5, 28672
    buffer_load_dwordx4 v[80:83], v2, s[28:31], s5 offen
    s_add_u32 s5, s5, 28672
    buffer_load_dwordx4 v[84:87], v2, s[28:31], s5 offen
    s_mov_b32 s6, 0x3f80
    s_mov_b32 s7, 0x3f800000
    v_mov_b32 v96, 0
    v_mov_b32 v97, 0
    v_mov_b32 v98, 0
    v_mov_b32 v99, 0
    v_mov_b32 v100, 0
    v_mov_b32 v101, 0
    v_mov_b32 v102, 0
    v_mov_b32 v103, 0
    v_lshlrev_b32 v3, 5, v0
    v_add_u32 v3, s69, v3
    v_lshlrev_b32 v4, 2, v0
    v_add_u32 v5, 49152, v4
    s_waitcnt vmcnt(13)
    v_dot2c_f32_bf16 v96, s6, v32
    v_dot2c_f32_bf16 v97, s7, v32
    v_dot2c_f32_bf16 v98, s6, v33
    v_dot2c_f32_bf16 v99, s7, v33
    v_dot2c_f32_bf16 v100, s6, v34
    v_dot2c_f32_bf16 v101, s7, v34
    v_dot2c_f32_bf16 v102, s6, v35
    v_dot2c_f32_bf16 v103, s7, v35
    s_waitcnt vmcnt(12)
    v_dot2c_f32_bf16 v96, s6, v36
    v_dot2c_f32_bf16 v97, s7, v36
    v_dot2c_f32_bf16 v98, s6, v37
    v_dot2c_f32_bf16 v99, s7, v37
    v_dot2c_f32_bf16 v100, s6, v38
    v_dot2c_f32_bf16 v101, s7, v38
    v_dot2c_f32_bf16 v102, s6, v39
    v_dot2c_f32_bf16 v103, s7, v39
    s_waitcnt vmcnt(11)
    v_dot2c_f32_bf16 v96, s6, v40
    v_dot2c_f32_bf16 v97, s7, v40
    v_dot2c_f32_bf16 v98, s6, v41
    v_dot2c_f32_bf16 v99, s7, v41
    v_dot2c_f32_bf16 v100, s6, v42
    v_dot2c_f32_bf16 v101, s7, v42
    v_dot2c_f32_bf16 v102, s6, v43
    v_dot2c_f32_bf16 v103, s7, v43
    s_waitcnt vmcnt(10)
    v_dot2c_f32_bf16 v96, s6, v44
    v_dot2c_f32_bf16 v97, s7, v44
    v_dot2c_f32_bf16 v98, s6, v45
    v_dot2c_f32_bf16 v99, s7, v45
    v_dot2c_f32_bf16 v100, s6, v46
    v_dot2c_f32_bf16 v101, s7, v46
    v_dot2c_f32_bf16 v102, s6, v47
    v_dot2c_f32_bf16 v103, s7, v47
    s_waitcnt vmcnt(9)
    v_dot2c_f32_bf16 v96, s6, v48
    v_dot2c_f32_bf16 v97, s7, v48
    v_dot2c_f32_bf16 v98, s6, v49
    v_dot2c_f32_bf16 v99, s7, v49
    v_dot2c_f32_bf16 v100, s6, v50
    v_dot2c_f32_bf16 v101, s7, v50
    v_dot2c_f32_bf16 v102, s6, v51
    v_dot2c_f32_bf16 v103, s7, v51
    s_waitcnt vmcnt(8)
    v_dot2c_f32_bf16 v96, s6, v52
    v_dot2c_f32_bf16 v97, s7, v52
    v_dot2c_f32_bf16 v98, s6, v53
    v_dot2c_f32_bf16 v99, s7, v53
    v_dot2c_f32_bf16 v100, s6, v54
    v_dot2c_f32_bf16 v101, s7, v54
    v_dot2c_f32_bf16 v102, s6, v55
    v_dot2c_f32_bf16 v103, s7, v55
    s_waitcnt vmcnt(7)
    v_dot2c_f32_bf16 v96, s6, v56
    v_dot2c_f32_bf16 v97, s7, v56
    v_dot2c_f32_bf16 v98, s6, v57
    v_dot2c_f32_bf16 v99, s7, v57
    v_dot2c_f32_bf16 v100, s6, v58
    v_dot2c_f32_bf16 v101, s7, v58
    v_dot2c_f32_bf16 v102, s6, v59
    v_dot2c_f32_bf16 v103, s7, v59
    s_waitcnt vmcnt(6)
    v_dot2c_f32_bf16 v96, s6, v60
    v_dot2c_f32_bf16 v97, s7, v60
    v_dot2c_f32_bf16 v98, s6, v61
    v_dot2c_f32_bf16 v99, s7, v61
    v_dot2c_f32_bf16 v100, s6, v62
    v_dot2c_f32_bf16 v101, s7, v62
    v_dot2c_f32_bf16 v102, s6, v63
    v_dot2c_f32_bf16 v103, s7, v63
    s_waitcnt vmcnt(5)
    v_dot2c_f32_bf16 v96, s6, v64
    v_dot2c_f32_bf16 v97, s7, v64
    v_dot2c_f32_bf16 v98, s6, v65
    v_dot2c_f32_bf16 v99, s7, v65
    v_dot2c_f32_bf16 v100, s6, v66
    v_dot2c_f32_bf16 v101, s7, v66
    v_dot2c_f32_bf16 v102, s6, v67
    v_dot2c_f32_bf16 v103, s7, v67
    s_waitcnt vmcnt(4)
    v_dot2c_f32_bf16 v96, s6, v68
    v_dot2c_f32_bf16 v97, s7, v68
    v_dot2c_f32_bf16 v98, s6, v69
    v_dot2c_f32_bf16 v99, s7, v69
    v_dot2c_f32_bf16 v100, s6, v70
    v_dot2c_f32_bf16 v101, s7, v70
    v_dot2c_f32_bf16 v102, s6, v71
    v_dot2c_f32_bf16 v103, s7, v71
    s_waitcnt vmcnt(3)
    v_dot2c_f32_bf16 v96, s6, v72
    v_dot2c_f32_bf16 v97, s7, v72
    v_dot2c_f32_bf16 v98, s6, v73
    v_dot2c_f32_bf16 v99, s7, v73
    v_dot2c_f32_bf16 v100, s6, v74
    v_dot2c_f32_bf16 v101, s7, v74
    v_dot2c_f32_bf16 v102, s6, v75
    v_dot2c_f32_bf16 v103, s7, v75
    s_waitcnt vmcnt(2)
    v_dot2c_f32_bf16 v96, s6, v76
    v_dot2c_f32_bf16 v97, s7, v76
    v_dot2c_f32_bf16 v98, s6, v77
    v_dot2c_f32_bf16 v99, s7, v77
    v_dot2c_f32_bf16 v100, s6, v78
    v_dot2c_f32_bf16 v101, s7, v78
    v_dot2c_f32_bf16 v102, s6, v79
    v_dot2c_f32_bf16 v103, s7, v79
    s_waitcnt vmcnt(1)
    v_dot2c_f32_bf16 v96, s6, v80
    v_dot2c_f32_bf16 v97, s7, v80
    v_dot2c_f32_bf16 v98, s6, v81
    v_dot2c_f32_bf16 v99, s7, v81
    v_dot2c_f32_bf16 v100, s6, v82
    v_dot2c_f32_bf16 v101, s7, v82
    v_dot2c_f32_bf16 v102, s6, v83
    v_dot2c_f32_bf16 v103, s7, v83
    s_waitcnt vmcnt(0)
    v_dot2c_f32_bf16 v96, s6, v84
    v_dot2c_f32_bf16 v97, s7, v84
    v_dot2c_f32_bf16 v98, s6, v85
    v_dot2c_f32_bf16 v99, s7, v85
    v_dot2c_f32_bf16 v100, s6, v86
    v_dot2c_f32_bf16 v101, s7, v86
    v_dot2c_f32_bf16 v102, s6, v87
    v_dot2c_f32_bf16 v103, s7, v87
    s_waitcnt lgkmcnt(0)
    ds_write_b128 v3, v[96:99] offset:0
    s_nop 0
    ds_write_b128 v3, v[100:103] offset:16
    s_waitcnt lgkmcnt(0)
    s_barrier
    s_cmp_lg_u32 s62, 0
    s_cbranch_scc1 L_spf
    ds_read_b32 v32, v4 offset:0
    ds_read_b32 v33, v4 offset:256
    ds_read_b32 v34, v4 offset:512
    ds_read_b32 v35, v4 offset:768
    ds_read_b32 v36, v4 offset:1024
    ds_read_b32 v37, v4 offset:1280
    ds_read_b32 v38, v4 offset:1536
    ds_read_b32 v39, v4 offset:1792
    ds_read_b32 v40, v4 offset:24576
    ds_read_b32 v41, v4 offset:24832
    ds_read_b32 v42, v4 offset:25088
    ds_read_b32 v43, v4 offset:25344
    ds_read_b32 v44, v4 offset:25600
    ds_read_b32 v45, v4 offset:25856
    ds_read_b32 v46, v4 offset:26112
    ds_read_b32 v47, v4 offset:26368
    ds_read_b32 v48, v5 offset:0
    ds_read_b32 v49, v5 offset:256
    ds_read_b32 v50, v5 offset:512
    ds_read_b32 v51, v5 offset:768
    ds_read_b32 v52, v5 offset:1024
    ds_read_b32 v53, v5 offset:1280
    ds_read_b32 v54, v5 offset:1536
    ds_read_b32 v55, v5 offset:1792
    ds_read_b32 v56, v5 offset:24576
    ds_read_b32 v57, v5 offset:24832
    ds_read_b32 v58, v5 offset:25088
    ds_read_b32 v59, v5 offset:25344
    ds_read_b32 v60, v5 offset:25600
    ds_read_b32 v61, v5 offset:25856
    ds_read_b32 v62, v5 offset:26112
    ds_read_b32 v63, v5 offset:26368
    s_waitcnt lgkmcnt(0)
    v_add_f32 v32, v32, v48
    v_add_f32 v33, v33, v49
    v_add_f32 v34, v34, v50
    v_add_f32 v35, v35, v51
    v_add_f32 v36, v36, v52
    v_add_f32 v37, v37, v53
    v_add_f32 v38, v38, v54
    v_add_f32 v39, v39, v55
    v_add_f32 v40, v40, v56
    v_add_f32 v41, v41, v57
    v_add_f32 v42, v42, v58
    v_add_f32 v43, v43, v59
    v_add_f32 v44, v44, v60
    v_add_f32 v45, v45, v61
    v_add_f32 v46, v46, v62
    v_add_f32 v47, v47, v63
    v_add_f32 v32, v32, v40
    v_add_f32 v33, v33, v41
    v_add_f32 v34, v34, v42
    v_add_f32 v35, v35, v43
    v_add_f32 v36, v36, v44
    v_add_f32 v37, v37, v45
    v_add_f32 v38, v38, v46
    v_add_f32 v39, v39, v47
    v_add_f32 v32, v32, v36
    v_add_f32 v33, v33, v37
    v_add_f32 v34, v34, v38
    v_add_f32 v35, v35, v39
    v_add_f32 v32, v32, v34
    v_add_f32 v33, v33, v35
    v_add_f32 v32, v32, v33
    v_cvt_pk_bf16_f32 v36, v32, v32
    v_and_b32 v33, 0xffff0000, v36
    v_sub_f32_e64 v33, v32, v33
    v_cvt_pk_bf16_f32 v37, v33, v33
    v_mov_b32_e64 v38, s67
    v_mov_b32_e64 v39, s67
    s_lshl_b32 s4, s4, 10
    s_add_u32 s4, s4, 1638400
    buffer_store_dwordx4 v[36:39], v1, s[16:19], s4 offen sc1
L_spf:
    s_mov_b32 s24, s50
    s_mov_b32 s25, s51
    s_mov_b32 s26, 1605632
    s_lshl_b32 s83, s91, 13
    s_add_u32 s83, s83, 917504
    buffer_load_dword v253, v252, s[24:27], s83 offen
    s_add_u32 s83, s83, 131072
    buffer_load_dword v253, v252, s[24:27], s83 offen
    s_add_u32 s83, s83, 131072
    buffer_load_dword v253, v252, s[24:27], s83 offen
    s_waitcnt vmcnt(2)
    s_add_u32 s83, s83, 131072
    buffer_load_dword v253, v252, s[24:27], s83 offen
    s_waitcnt vmcnt(2)
    s_add_u32 s83, s83, 131072
    buffer_load_dword v253, v252, s[24:27], s83 offen
    s_waitcnt vmcnt(2)
    s_add_u32 s83, s83, 131072
    buffer_load_dword v253, v252, s[24:27], s83 offen
    s_waitcnt vmcnt(2)
    s_mov_b32 s24, s52
    s_mov_b32 s25, s53
    s_lshl3_add_u32 s83, s91, s60
    s_mul_i32 s83, s83, 12544
    s_add_u32 s83, s83, 0
    s_add_u32 s26, s83, 6272
    s_min_u32 s26, s26, 1605632
    buffer_load_dword v253, v252, s[24:27], s83 offen
    s_add_u32 s83, s83, 6272
    s_add_u32 s26, s83, 6272
    s_min_u32 s26, s26, 1605632
    buffer_load_dword v253, v252, s[24:27], s83 offen
L_spe:
    s_waitcnt vmcnt(0)
    s_branch L_fin
L_non_s:
    s_add_u32 s81, s81, 1
    s_cmp_ge_u32 s81, 32768
    s_cbranch_scc1 L_non_k
    s_mov_b32 s24, s56
    s_mov_b32 s25, s57
    s_mov_b32 s26, 256
    buffer_load_dword v244, off, s[24:27], 0 sc1
    s_waitcnt vmcnt(0)
    s_branch L_non_c
L_d1_S:
    s_add_u32 s81, s81, 1
    s_cmp_ge_u32 s81, 32768
    s_cbranch_scc1 L_d1_K
    buffer_load_dwordx2 v[236:237], v251, s[16:19], 0 offen sc1
    s_waitcnt vmcnt(0)
    s_branch L_d1_C
L_redo:
    s_add_u32 s83, s93, 6291456
    buffer_store_dwordx4 a[252:255], v1, s[16:19], s83 offen offset:0 sc1
    buffer_store_dwordx4 a[252:255], v1, s[16:19], s83 offen offset:1024 sc1
    buffer_store_dwordx4 a[252:255], v24, s[16:19], 0 offen sc1
    buffer_store_dwordx4 a[252:255], v25, s[16:19], 0 offen sc1
    buffer_store_dwordx2 a[252:253], v26, s[16:19], 0 offen sc1
    s_add_u32 s83, s93, 4194304
    buffer_store_dwordx4 a[252:255], v1, s[16:19], s83 offen offset:0 sc1
    buffer_store_dwordx4 a[252:255], v1, s[16:19], s83 offen offset:1024 sc1
    s_add_u32 s83, s93, 8388608
    buffer_store_dwordx4 a[252:255], v1, s[16:19], s83 offen offset:0 sc1
    buffer_store_dwordx4 a[252:255], v1, s[16:19], s83 offen offset:1024 sc1
    s_branch L_redone
L_kv1_S:
    s_add_u32 s81, s81, 1
    s_cmp_ge_u32 s81, 32768
    s_cbranch_scc1 L_kv1_K
    buffer_load_dwordx4 v[32:35], v204, s[16:19], s84 offen sc1
    s_waitcnt vmcnt(0)
    s_branch L_kv1_C
L_kv2_S:
    s_add_u32 s81, s81, 1
    s_cmp_ge_u32 s81, 32768
    s_cbranch_scc1 L_kv2_K
    buffer_load_dwordx4 v[108:111], v249, s[16:19], s85 offen offset:0 sc1
    buffer_load_dwordx4 v[112:115], v249, s[16:19], s85 offen offset:512 sc1
    buffer_load_dwordx4 v[116:119], v249, s[16:19], s86 offen offset:0 sc1
    buffer_load_dwordx4 v[120:123], v249, s[16:19], s86 offen offset:512 sc1
    s_waitcnt vmcnt(0)
    s_branch L_kv2_C
L_rem_1:
    s_nop 1
    buffer_store_dwordx4 v[48:51], v24, s[16:19], 0 offen sc1
    buffer_store_dwordx4 v[52:55], v25, s[16:19], 0 offen sc1
    buffer_store_dwordx2 v[52:53], v26, s[16:19], 0 offen sc1
    s_nop 1
    s_branch L_std_2
L_d2_S:
    s_add_u32 s81, s81, 1
    s_cmp_ge_u32 s81, 32768
    s_cbranch_scc1 L_d2_K
    buffer_load_dword v73, v72, s[16:19], 0 offen sc1
    s_waitcnt vmcnt(0)
    s_branch L_d2_C
L_p3_S0:
    s_add_u32 s81, s81, 1
    s_cmp_ge_u32 s81, 32768
    s_cbranch_scc1 L_p3_K0
    buffer_load_dwordx4 v[80:83], v21, s[16:19], s77 offen offset:0 sc1
    buffer_load_dwordx4 v[84:87], v21, s[16:19], s88 offen offset:0 sc1
    buffer_load_dwordx4 v[88:91], v21, s[16:19], s89 offen offset:0 sc1
    buffer_load_dwordx4 v[92:95], v21, s[16:19], s77 offen offset:3072 sc1
    buffer_load_dwordx4 v[96:99], v21, s[16:19], s88 offen offset:3072 sc1
    buffer_load_dwordx4 v[100:103], v21, s[16:19], s89 offen offset:3072 sc1
    s_waitcnt vmcnt(5)
    v_max_u32 v254, v80, v82
    v_cmp_eq_u32 vcc, -1, v254
    s_cbranch_vccnz L_p3_S0
    s_branch L_p3_K0
L_p3_S1:
    s_add_u32 s81, s81, 1
    s_cmp_ge_u32 s81, 32768
    s_cbranch_scc1 L_p3_K1
    buffer_load_dwordx4 v[84:87], v21, s[16:19], s88 offen offset:0 sc1
    buffer_load_dwordx4 v[88:91], v21, s[16:19], s89 offen offset:0 sc1
    buffer_load_dwordx4 v[92:95], v21, s[16:19], s77 offen offset:3072 sc1
    buffer_load_dwordx4 v[96:99], v21, s[16:19], s88 offen offset:3072 sc1
    buffer_load_dwordx4 v[100:103], v21, s[16:19], s89 offen offset:3072 sc1
    buffer_load_dwordx4 v[104:107], v21, s[16:19], s77 offen offset:2048 sc1
    s_waitcnt vmcnt(5)
    v_max_u32 v254, v84, v86
    v_cmp_eq_u32 vcc, -1, v254
    s_cbranch_vccnz L_p3_S1
    s_branch L_p3_K1
L_p3_S2:
    s_add_u32 s81, s81, 1
    s_cmp_ge_u32 s81, 32768
    s_cbranch_scc1 L_p3_K2
    buffer_load_dwordx4 v[88:91], v21, s[16:19], s89 offen offset:0 sc1
    buffer_load_dwordx4 v[92:95], v21, s[16:19], s77 offen offset:3072 sc1
    buffer_load_dwordx4 v[96:99], v21, s[16:19], s88 offen offset:3072 sc1
    buffer_load_dwordx4 v[100:103], v21, s[16:19], s89 offen offset:3072 sc1
    buffer_load_dwordx4 v[104:107], v21, s[16:19], s77 offen offset:2048 sc1
    buffer_load_dwordx4 v[108:111], v21, s[16:19], s88 offen offset:2048 sc1
    s_waitcnt vmcnt(5)
    v_max_u32 v254, v88, v90
    v_cmp_eq_u32 vcc, -1, v254
    s_cbranch_vccnz L_p3_S2
    s_branch L_p3_K2
L_p3_S3:
    s_add_u32 s81, s81, 1
    s_cmp_ge_u32 s81, 32768
    s_cbranch_scc1 L_p3_K3
    buffer_load_dwordx4 v[92:95], v21, s[16:19], s77 offen offset:3072 sc1
    buffer_load_dwordx4 v[96:99], v21, s[16:19], s88 offen offset:3072 sc1
    buffer_load_dwordx4 v[100:103], v21, s[16:19], s89 offen offset:3072 sc1
    buffer_load_dwordx4 v[104:107], v21, s[16:19], s77 offen offset:2048 sc1
    buffer_load_dwordx4 v[108:111], v21, s[16:19], s88 offen offset:2048 sc1
    buffer_load_dwordx4 v[112:115], v21, s[16:19], s89 offen offset:2048 sc1
    s_waitcnt vmcnt(5)
    v_max_u32 v254, v92, v94
    v_cmp_eq_u32 vcc, -1, v254
    s_cbranch_vccnz L_p3_S3
    s_branch L_p3_K3
L_p3_S4:
    s_add_u32 s81, s81, 1
    s_cmp_ge_u32 s81, 32768
    s_cbranch_scc1 L_p3_K4
    buffer_load_dwordx4 v[96:99], v21, s[16:19], s88 offen offset:3072 sc1
    buffer_load_dwordx4 v[100:103], v21, s[16:19], s89 offen offset:3072 sc1
    buffer_load_dwordx4 v[104:107], v21, s[16:19], s77 offen offset:2048 sc1
    buffer_load_dwordx4 v[108:111], v21, s[16:19], s88 offen offset:2048 sc1
    buffer_load_dwordx4 v[112:115], v21, s[16:19], s89 offen offset:2048 sc1
    buffer_load_dwordx4 v[116:119], v21, s[16:19], s90 offen offset:0 sc1
    s_waitcnt vmcnt(5)
    v_max_u32 v254, v96, v98
    v_cmp_eq_u32_e64 vcc, -1, v254
    s_cbranch_vccnz L_p3_S4
    s_branch L_p3_K4
L_p3_S5:
    s_add_u32 s81, s81, 1
    s_cmp_ge_u32 s81, 32768
    s_cbranch_scc1 L_p3_K5
    buffer_load_dwordx4 v[100:103], v21, s[16:19], s89 offen offset:3072 sc1
    buffer_load_dwordx4 v[104:107], v21, s[16:19], s77 offen offset:2048 sc1
    buffer_load_dwordx4 v[108:111], v21, s[16:19], s88 offen offset:2048 sc1
    buffer_load_dwordx4 v[112:115], v21, s[16:19], s89 offen offset:2048 sc1
    buffer_load_dwordx4 v[116:119], v21, s[16:19], s90 offen offset:0 sc1
    buffer_load_dwordx4 v[120:123], v21, s[16:19], s77 offen offset:1024 sc1
    s_waitcnt vmcnt(5)
    v_max_u32 v254, v100, v102
    v_cmp_eq_u32 vcc, -1, v254
    s_cbranch_vccnz L_p3_S5
    s_branch L_p3_K5
L_p3_S6:
    s_add_u32 s81, s81, 1
    s_cmp_ge_u32 s81, 32768
    s_cbranch_scc1 L_p3_K6
    buffer_load_dwordx4 v[104:107], v21, s[16:19], s77 offen offset:2048 sc1
    buffer_load_dwordx4 v[108:111], v21, s[16:19], s88 offen offset:2048 sc1
    buffer_load_dwordx4 v[112:115], v21, s[16:19], s89 offen offset:2048 sc1
    buffer_load_dwordx4 v[116:119], v21, s[16:19], s90 offen offset:0 sc1
    buffer_load_dwordx4 v[120:123], v21, s[16:19], s77 offen offset:1024 sc1
    buffer_load_dwordx4 v[124:127], v21, s[16:19], s88 offen offset:1024 sc1
    s_waitcnt vmcnt(5)
    v_max_u32 v254, v104, v106
    v_cmp_eq_u32 vcc, -1, v254
    s_cbranch_vccnz L_p3_S6
    s_branch L_p3_K6
L_p3_S7:
    s_add_u32 s81, s81, 1
    s_cmp_ge_u32 s81, 32768
    s_cbranch_scc1 L_p3_K7
    buffer_load_dwordx4 v[108:111], v21, s[16:19], s88 offen offset:2048 sc1
    buffer_load_dwordx4 v[112:115], v21, s[16:19], s89 offen offset:2048 sc1
    buffer_load_dwordx4 v[116:119], v21, s[16:19], s90 offen offset:0 sc1
    buffer_load_dwordx4 v[120:123], v21, s[16:19], s77 offen offset:1024 sc1
    buffer_load_dwordx4 v[124:127], v21, s[16:19], s88 offen offset:1024 sc1
    buffer_load_dwordx4 v[128:131], v21, s[16:19], s89 offen offset:1024 sc1
    s_waitcnt vmcnt(5)
    v_max_u32 v254, v108, v110
    v_cmp_eq_u32_e64 vcc, -1, v254
    s_cbranch_vccnz L_p3_S7
    s_branch L_p3_K7
L_p3_S8:
    s_add_u32 s81, s81, 1
    s_cmp_ge_u32 s81, 32768
    s_cbranch_scc1 L_p3_K8
    buffer_load_dwordx4 v[112:115], v21, s[16:19], s89 offen offset:2048 sc1
    buffer_load_dwordx4 v[116:119], v21, s[16:19], s90 offen offset:0 sc1
    buffer_load_dwordx4 v[120:123], v21, s[16:19], s77 offen offset:1024 sc1
    buffer_load_dwordx4 v[124:127], v21, s[16:19], s88 offen offset:1024 sc1
    buffer_load_dwordx4 v[128:131], v21, s[16:19], s89 offen offset:1024 sc1
    buffer_load_dwordx4 v[132:135], v21, s[16:19], s90 offen offset:1024 sc1
    s_waitcnt vmcnt(0)
    v_max_u32 v254, v112, v114
    v_cmp_eq_u32_e64 vcc, -1, v254
    s_cbranch_vccnz L_p3_S8
    s_branch L_p3_K8
L_p3_S9:
    s_add_u32 s81, s81, 1
    s_cmp_ge_u32 s81, 32768
    s_cbranch_scc1 L_p3_K9
    buffer_load_dwordx4 v[116:119], v21, s[16:19], s90 offen offset:0 sc1
    buffer_load_dwordx4 v[120:123], v21, s[16:19], s77 offen offset:1024 sc1
    buffer_load_dwordx4 v[124:127], v21, s[16:19], s88 offen offset:1024 sc1
    buffer_load_dwordx4 v[128:131], v21, s[16:19], s89 offen offset:1024 sc1
    buffer_load_dwordx4 v[132:135], v21, s[16:19], s90 offen offset:1024 sc1
    s_waitcnt vmcnt(0)
    v_max_u32 v254, v116, v118
    v_cmp_eq_u32_e64 vcc, -1, v254
    s_cbranch_vccnz L_p3_S9
    s_branch L_p3_K9
L_p3_S10:
    s_add_u32 s81, s81, 1
    s_cmp_ge_u32 s81, 32768
    s_cbranch_scc1 L_p3_K10
    buffer_load_dwordx4 v[120:123], v21, s[16:19], s77 offen offset:1024 sc1
    buffer_load_dwordx4 v[124:127], v21, s[16:19], s88 offen offset:1024 sc1
    buffer_load_dwordx4 v[128:131], v21, s[16:19], s89 offen offset:1024 sc1
    buffer_load_dwordx4 v[132:135], v21, s[16:19], s90 offen offset:1024 sc1
    s_waitcnt vmcnt(0)
    v_max_u32 v254, v120, v122
    v_cmp_eq_u32 vcc, -1, v254
    s_cbranch_vccnz L_p3_S10
    s_branch L_p3_K10
L_p3_S11:
    s_add_u32 s81, s81, 1
    s_cmp_ge_u32 s81, 32768
    s_cbranch_scc1 L_p3_K11
    buffer_load_dwordx4 v[124:127], v21, s[16:19], s88 offen offset:1024 sc1
    buffer_load_dwordx4 v[128:131], v21, s[16:19], s89 offen offset:1024 sc1
    buffer_load_dwordx4 v[132:135], v21, s[16:19], s90 offen offset:1024 sc1
    s_waitcnt vmcnt(0)
    v_max_u32 v254, v124, v126
    v_cmp_eq_u32_e64 vcc, -1, v254
    s_cbranch_vccnz L_p3_S11
    s_branch L_p3_K11
L_p3_S12:
    s_add_u32 s81, s81, 1
    s_cmp_ge_u32 s81, 32768
    s_cbranch_scc1 L_p3_K12
    buffer_load_dwordx4 v[128:131], v21, s[16:19], s89 offen offset:1024 sc1
    buffer_load_dwordx4 v[132:135], v21, s[16:19], s90 offen offset:1024 sc1
    s_waitcnt vmcnt(0)
    v_max_u32_e64 v254, v128, v130
    v_cmp_eq_u32_e64 vcc, -1, v254
    s_cbranch_vccnz L_p3_S12
    s_branch L_p3_K12
L_p3_S13:
    s_add_u32 s81, s81, 1
    s_cmp_ge_u32 s81, 32768
    s_cbranch_scc1 L_p3_K13
    buffer_load_dwordx4 v[132:135], v21, s[16:19], s90 offen offset:1024 sc1
    s_waitcnt vmcnt(0)
    v_max_u32_e64 v254, v132, v134
    v_cmp_eq_u32_e64 vcc, -1, v254
    s_cbranch_vccnz L_p3_S13
    s_branch L_p3_K13
L_rem_3:
    s_nop 1
    buffer_store_dwordx4 v[80:83], v1, s[16:19], s4 offen offset:0 sc1
    buffer_store_dwordx4 v[84:87], v1, s[16:19], s4 offen offset:1024 sc1
    s_nop 1
    s_branch L_std_4
L_rem_5:
    s_nop 1
    s_add_u32 s4, s94, 33554432
    s_mov_b64 exec, 0xffff
    buffer_store_dwordx2 v[48:49], v20, s[16:19], s4 offen sc1
    s_mov_b64 exec, -1
    s_nop 1
    s_branch L_std_6
L_p4_S0:
    s_add_u32 s81, s81, 1
    s_cmp_ge_u32 s81, 32768
    s_cbranch_scc1 L_p4_K0
    buffer_load_dwordx4 v[88:91], v21, s[16:19], s71 offen offset:0 sc1
    buffer_load_dwordx4 v[92:95], v21, s[16:19], s71 offen offset:1024 sc1
    buffer_load_dwordx4 v[96:99], v21, s[16:19], s72 offen offset:0 sc1
    buffer_load_dwordx4 v[100:103], v21, s[16:19], s72 offen offset:1024 sc1
    buffer_load_dwordx4 v[104:107], v21, s[16:19], s73 offen offset:0 sc1
    buffer_load_dwordx4 v[108:111], v21, s[16:19], s73 offen offset:1024 sc1
    buffer_load_dwordx4 v[112:115], v21, s[16:19], s74 offen offset:0 sc1
    buffer_load_dwordx4 v[116:119], v21, s[16:19], s74 offen offset:1024 sc1
    s_waitcnt vmcnt(7)
    v_cmp_eq_u32 vcc, -1, v88
    s_cbranch_vccnz L_p4_S0
    s_branch L_p4_K0
L_p4_S1:
    s_add_u32 s81, s81, 1
    s_cmp_ge_u32 s81, 32768
    s_cbranch_scc1 L_p4_K1
    buffer_load_dwordx4 v[92:95], v21, s[16:19], s71 offen offset:1024 sc1
    buffer_load_dwordx4 v[96:99], v21, s[16:19], s72 offen offset:0 sc1
    buffer_load_dwordx4 v[100:103], v21, s[16:19], s72 offen offset:1024 sc1
    buffer_load_dwordx4 v[104:107], v21, s[16:19], s73 offen offset:0 sc1
    buffer_load_dwordx4 v[108:111], v21, s[16:19], s73 offen offset:1024 sc1
    buffer_load_dwordx4 v[112:115], v21, s[16:19], s74 offen offset:0 sc1
    buffer_load_dwordx4 v[116:119], v21, s[16:19], s74 offen offset:1024 sc1
    buffer_load_dwordx4 v[28:31], v20, s[16:19], s82 offen sc1
    s_waitcnt vmcnt(7)
    v_cmp_eq_u32 vcc, -1, v92
    s_cbranch_vccnz L_p4_S1
    s_branch L_p4_K1
L_p4_S2:
    s_add_u32 s81, s81, 1
    s_cmp_ge_u32 s81, 32768
    s_cbranch_scc1 L_p4_K2
    buffer_load_dwordx4 v[96:99], v21, s[16:19], s72 offen offset:0 sc1
    buffer_load_dwordx4 v[100:103], v21, s[16:19], s72 offen offset:1024 sc1
    buffer_load_dwordx4 v[104:107], v21, s[16:19], s73 offen offset:0 sc1
    buffer_load_dwordx4 v[108:111], v21, s[16:19], s73 offen offset:1024 sc1
    buffer_load_dwordx4 v[112:115], v21, s[16:19], s74 offen offset:0 sc1
    buffer_load_dwordx4 v[116:119], v21, s[16:19], s74 offen offset:1024 sc1
    buffer_load_dwordx4 v[28:31], v20, s[16:19], s82 offen sc1
    buffer_load_dwordx4 v[120:123], v21, s[16:19], s75 offen offset:0 sc1
    s_waitcnt vmcnt(7)
    v_cmp_eq_u32 vcc, -1, v96
    s_cbranch_vccnz L_p4_S2
    s_branch L_p4_K2
L_p4_S3:
    s_add_u32 s81, s81, 1
    s_cmp_ge_u32 s81, 32768
    s_cbranch_scc1 L_p4_K3
    buffer_load_dwordx4 v[100:103], v21, s[16:19], s72 offen offset:1024 sc1
    buffer_load_dwordx4 v[104:107], v21, s[16:19], s73 offen offset:0 sc1
    buffer_load_dwordx4 v[108:111], v21, s[16:19], s73 offen offset:1024 sc1
    buffer_load_dwordx4 v[112:115], v21, s[16:19], s74 offen offset:0 sc1
    buffer_load_dwordx4 v[116:119], v21, s[16:19], s74 offen offset:1024 sc1
    buffer_load_dwordx4 v[28:31], v20, s[16:19], s82 offen sc1
    buffer_load_dwordx4 v[120:123], v21, s[16:19], s75 offen offset:0 sc1
    buffer_load_dwordx4 v[124:127], v21, s[16:19], s75 offen offset:1024 sc1
    s_waitcnt vmcnt(7)
    v_cmp_eq_u32 vcc, -1, v100
    s_cbranch_vccnz L_p4_S3
    s_branch L_p4_K3
L_p4_S4:
    s_add_u32 s81, s81, 1
    s_cmp_ge_u32 s81, 32768
    s_cbranch_scc1 L_p4_K4
    buffer_load_dwordx4 v[104:107], v21, s[16:19], s73 offen offset:0 sc1
    buffer_load_dwordx4 v[108:111], v21, s[16:19], s73 offen offset:1024 sc1
    buffer_load_dwordx4 v[112:115], v21, s[16:19], s74 offen offset:0 sc1
    buffer_load_dwordx4 v[116:119], v21, s[16:19], s74 offen offset:1024 sc1
    buffer_load_dwordx4 v[28:31], v20, s[16:19], s82 offen sc1
    buffer_load_dwordx4 v[120:123], v21, s[16:19], s75 offen offset:0 sc1
    buffer_load_dwordx4 v[124:127], v21, s[16:19], s75 offen offset:1024 sc1
    buffer_load_dwordx4 v[128:131], v21, s[16:19], s76 offen offset:0 sc1
    s_waitcnt vmcnt(7)
    v_cmp_eq_u32 vcc, -1, v104
    s_cbranch_vccnz L_p4_S4
    s_branch L_p4_K4
L_p4_S5:
    s_add_u32 s81, s81, 1
    s_cmp_ge_u32 s81, 32768
    s_cbranch_scc1 L_p4_K5
    buffer_load_dwordx4 v[108:111], v21, s[16:19], s73 offen offset:1024 sc1
    buffer_load_dwordx4 v[112:115], v21, s[16:19], s74 offen offset:0 sc1
    buffer_load_dwordx4 v[116:119], v21, s[16:19], s74 offen offset:1024 sc1
    buffer_load_dwordx4 v[28:31], v20, s[16:19], s82 offen sc1
    buffer_load_dwordx4 v[120:123], v21, s[16:19], s75 offen offset:0 sc1
    buffer_load_dwordx4 v[124:127], v21, s[16:19], s75 offen offset:1024 sc1
    buffer_load_dwordx4 v[128:131], v21, s[16:19], s76 offen offset:0 sc1
    buffer_load_dwordx4 v[132:135], v21, s[16:19], s76 offen offset:1024 sc1
    s_waitcnt vmcnt(0)
    v_cmp_eq_u32 vcc, -1, v108
    s_cbranch_vccnz L_p4_S5
    s_branch L_p4_K5
L_p4_S6:
    s_add_u32 s81, s81, 1
    s_cmp_ge_u32 s81, 32768
    s_cbranch_scc1 L_p4_K6
    buffer_load_dwordx4 v[112:115], v21, s[16:19], s74 offen offset:0 sc1
    buffer_load_dwordx4 v[116:119], v21, s[16:19], s74 offen offset:1024 sc1
    buffer_load_dwordx4 v[28:31], v20, s[16:19], s82 offen sc1
    buffer_load_dwordx4 v[120:123], v21, s[16:19], s75 offen offset:0 sc1
    buffer_load_dwordx4 v[124:127], v21, s[16:19], s75 offen offset:1024 sc1
    buffer_load_dwordx4 v[128:131], v21, s[16:19], s76 offen offset:0 sc1
    buffer_load_dwordx4 v[132:135], v21, s[16:19], s76 offen offset:1024 sc1
    s_waitcnt vmcnt(0)
    v_cmp_eq_u32 vcc, -1, v112
    s_cbranch_vccnz L_p4_S6
    s_branch L_p4_K6
L_p4_S7:
    s_add_u32 s81, s81, 1
    s_cmp_ge_u32 s81, 32768
    s_cbranch_scc1 L_p4_K7
    buffer_load_dwordx4 v[116:119], v21, s[16:19], s74 offen offset:1024 sc1
    buffer_load_dwordx4 v[28:31], v20, s[16:19], s82 offen sc1
    buffer_load_dwordx4 v[120:123], v21, s[16:19], s75 offen offset:0 sc1
    buffer_load_dwordx4 v[124:127], v21, s[16:19], s75 offen offset:1024 sc1
    buffer_load_dwordx4 v[128:131], v21, s[16:19], s76 offen offset:0 sc1
    buffer_load_dwordx4 v[132:135], v21, s[16:19], s76 offen offset:1024 sc1
    s_waitcnt vmcnt(0)
    v_cmp_eq_u32 vcc, -1, v116
    s_cbranch_vccnz L_p4_S7
    s_branch L_p4_K7
L_p4_S8:
    s_add_u32 s81, s81, 1
    s_cmp_ge_u32 s81, 32768
    s_cbranch_scc1 L_p4_K8
    buffer_load_dwordx4 v[28:31], v20, s[16:19], s82 offen sc1
    buffer_load_dwordx4 v[120:123], v21, s[16:19], s75 offen offset:0 sc1
    buffer_load_dwordx4 v[124:127], v21, s[16:19], s75 offen offset:1024 sc1
    buffer_load_dwordx4 v[128:131], v21, s[16:19], s76 offen offset:0 sc1
    buffer_load_dwordx4 v[132:135], v21, s[16:19], s76 offen offset:1024 sc1
    s_waitcnt vmcnt(0)
    s_mov_b32 exec_hi, 0xffff
    v_add_f32 v28, v28, v30
    v_add_f32 v29, v29, v31
    s_mov_b32 exec_hi, -1
    v_cmp_u_f32_e64 vcc, v28, v29
    s_cbranch_vccnz L_p4_S8
    s_branch L_p4_K8
L_p4_S9:
    s_add_u32 s81, s81, 1
    s_cmp_ge_u32 s81, 32768
    s_cbranch_scc1 L_p4_K9
    buffer_load_dwordx4 v[120:123], v21, s[16:19], s75 offen offset:0 sc1
    buffer_load_dwordx4 v[124:127], v21, s[16:19], s75 offen offset:1024 sc1
    buffer_load_dwordx4 v[128:131], v21, s[16:19], s76 offen offset:0 sc1
    buffer_load_dwordx4 v[132:135], v21, s[16:19], s76 offen offset:1024 sc1
    s_waitcnt vmcnt(0)
    v_cmp_eq_u32 vcc, -1, v120
    s_cbranch_vccnz L_p4_S9
    s_branch L_p4_K9
L_p4_S10:
    s_add_u32 s81, s81, 1
    s_cmp_ge_u32 s81, 32768
    s_cbranch_scc1 L_p4_K10
    buffer_load_dwordx4 v[124:127], v21, s[16:19], s75 offen offset:1024 sc1
    buffer_load_dwordx4 v[128:131], v21, s[16:19], s76 offen offset:0 sc1
    buffer_load_dwordx4 v[132:135], v21, s[16:19], s76 offen offset:1024 sc1
    s_waitcnt vmcnt(0)
    v_cmp_eq_u32 vcc, -1, v124
    s_cbranch_vccnz L_p4_S10
    s_branch L_p4_K10
L_p4_S11:
    s_add_u32 s81, s81, 1
    s_cmp_ge_u32 s81, 32768
    s_cbranch_scc1 L_p4_K11
    buffer_load_dwordx4 v[128:131], v21, s[16:19], s76 offen offset:0 sc1
    buffer_load_dwordx4 v[132:135], v21, s[16:19], s76 offen offset:1024 sc1
    s_waitcnt vmcnt(0)
    v_cmp_eq_u32 vcc, -1, v128
    s_cbranch_vccnz L_p4_S11
    s_branch L_p4_K11
L_p4_S12:
    s_add_u32 s81, s81, 1
    s_cmp_ge_u32 s81, 32768
    s_cbranch_scc1 L_p4_K12
    buffer_load_dwordx4 v[132:135], v21, s[16:19], s76 offen offset:1024 sc1
    s_waitcnt vmcnt(0)
    v_cmp_eq_u32 vcc, -1, v132
    s_cbranch_vccnz L_p4_S12
    s_branch L_p4_K12
L_p5_S0:
    s_add_u32 s81, s81, 1
    s_cmp_ge_u32 s81, 32768
    s_cbranch_scc1 L_p5_K0
    buffer_load_dwordx4 v[80:83], v21, s[16:19], s36 offen offset:0 sc1
    buffer_load_dwordx4 v[84:87], v21, s[16:19], s36 offen offset:1024 sc1
    buffer_load_dwordx4 v[88:91], v21, s[16:19], s37 offen offset:0 sc1
    buffer_load_dwordx4 v[92:95], v21, s[16:19], s37 offen offset:1024 sc1
    buffer_load_dwordx4 v[96:99], v21, s[16:19], s38 offen offset:0 sc1
    buffer_load_dwordx4 v[100:103], v21, s[16:19], s38 offen offset:1024 sc1
    buffer_load_dwordx4 v[104:107], v21, s[16:19], s39 offen offset:0 sc1
    buffer_load_dwordx4 v[108:111], v21, s[16:19], s39 offen offset:1024 sc1
    s_waitcnt vmcnt(7)
    v_cmp_eq_u32 vcc, -1, v80
    s_cbranch_vccnz L_p5_S0
    s_branch L_p5_K0
L_p5_S1:
    s_add_u32 s81, s81, 1
    s_cmp_ge_u32 s81, 32768
    s_cbranch_scc1 L_p5_K1
    buffer_load_dwordx4 v[84:87], v21, s[16:19], s36 offen offset:1024 sc1
    buffer_load_dwordx4 v[88:91], v21, s[16:19], s37 offen offset:0 sc1
    buffer_load_dwordx4 v[92:95], v21, s[16:19], s37 offen offset:1024 sc1
    buffer_load_dwordx4 v[96:99], v21, s[16:19], s38 offen offset:0 sc1
    buffer_load_dwordx4 v[100:103], v21, s[16:19], s38 offen offset:1024 sc1
    buffer_load_dwordx4 v[104:107], v21, s[16:19], s39 offen offset:0 sc1
    buffer_load_dwordx4 v[108:111], v21, s[16:19], s39 offen offset:1024 sc1
    buffer_load_dwordx4 v[112:115], v21, s[16:19], s86 offen offset:0 sc1
    s_waitcnt vmcnt(7)
    v_cmp_eq_u32 vcc, -1, v84
    s_cbranch_vccnz L_p5_S1
    s_branch L_p5_K1
L_p5_S2:
    s_add_u32 s81, s81, 1
    s_cmp_ge_u32 s81, 32768
    s_cbranch_scc1 L_p5_K2
    buffer_load_dwordx4 v[88:91], v21, s[16:19], s37 offen offset:0 sc1
    buffer_load_dwordx4 v[92:95], v21, s[16:19], s37 offen offset:1024 sc1
    buffer_load_dwordx4 v[96:99], v21, s[16:19], s38 offen offset:0 sc1
    buffer_load_dwordx4 v[100:103], v21, s[16:19], s38 offen offset:1024 sc1
    buffer_load_dwordx4 v[104:107], v21, s[16:19], s39 offen offset:0 sc1
    buffer_load_dwordx4 v[108:111], v21, s[16:19], s39 offen offset:1024 sc1
    buffer_load_dwordx4 v[112:115], v21, s[16:19], s86 offen offset:0 sc1
    buffer_load_dwordx4 v[116:119], v21, s[16:19], s86 offen offset:1024 sc1
    s_waitcnt vmcnt(7)
    v_cmp_eq_u32 vcc, -1, v88
    s_cbranch_vccnz L_p5_S2
    s_branch L_p5_K2
L_p5_S3:
    s_add_u32 s81, s81, 1
    s_cmp_ge_u32 s81, 32768
    s_cbranch_scc1 L_p5_K3
    buffer_load_dwordx4 v[92:95], v21, s[16:19], s37 offen offset:1024 sc1
    buffer_load_dwordx4 v[96:99], v21, s[16:19], s38 offen offset:0 sc1
    buffer_load_dwordx4 v[100:103], v21, s[16:19], s38 offen offset:1024 sc1
    buffer_load_dwordx4 v[104:107], v21, s[16:19], s39 offen offset:0 sc1
    buffer_load_dwordx4 v[108:111], v21, s[16:19], s39 offen offset:1024 sc1
    buffer_load_dwordx4 v[112:115], v21, s[16:19], s86 offen offset:0 sc1
    buffer_load_dwordx4 v[116:119], v21, s[16:19], s86 offen offset:1024 sc1
    buffer_load_dwordx4 v[120:123], v21, s[16:19], s41 offen offset:0 sc1
    s_waitcnt vmcnt(7)
    v_cmp_eq_u32 vcc, -1, v92
    s_cbranch_vccnz L_p5_S3
    s_branch L_p5_K3
L_p5_S4:
    s_add_u32 s81, s81, 1
    s_cmp_ge_u32 s81, 32768
    s_cbranch_scc1 L_p5_K4
    buffer_load_dwordx4 v[96:99], v21, s[16:19], s38 offen offset:0 sc1
    buffer_load_dwordx4 v[100:103], v21, s[16:19], s38 offen offset:1024 sc1
    buffer_load_dwordx4 v[104:107], v21, s[16:19], s39 offen offset:0 sc1
    buffer_load_dwordx4 v[108:111], v21, s[16:19], s39 offen offset:1024 sc1
    buffer_load_dwordx4 v[112:115], v21, s[16:19], s86 offen offset:0 sc1
    buffer_load_dwordx4 v[116:119], v21, s[16:19], s86 offen offset:1024 sc1
    buffer_load_dwordx4 v[120:123], v21, s[16:19], s41 offen offset:0 sc1
    buffer_load_dwordx4 v[124:127], v21, s[16:19], s41 offen offset:1024 sc1
    s_waitcnt vmcnt(7)
    v_cmp_eq_u32 vcc, -1, v96
    s_cbranch_vccnz L_p5_S4
    s_branch L_p5_K4
L_p5_S5:
    s_add_u32 s81, s81, 1
    s_cmp_ge_u32 s81, 32768
    s_cbranch_scc1 L_p5_K5
    buffer_load_dwordx4 v[100:103], v21, s[16:19], s38 offen offset:1024 sc1
    buffer_load_dwordx4 v[104:107], v21, s[16:19], s39 offen offset:0 sc1
    buffer_load_dwordx4 v[108:111], v21, s[16:19], s39 offen offset:1024 sc1
    buffer_load_dwordx4 v[112:115], v21, s[16:19], s86 offen offset:0 sc1
    buffer_load_dwordx4 v[116:119], v21, s[16:19], s86 offen offset:1024 sc1
    buffer_load_dwordx4 v[120:123], v21, s[16:19], s41 offen offset:0 sc1
    buffer_load_dwordx4 v[124:127], v21, s[16:19], s41 offen offset:1024 sc1
    buffer_load_dwordx4 v[128:131], v21, s[16:19], s44 offen offset:0 sc1
    s_waitcnt vmcnt(7)
    v_cmp_eq_u32 vcc, -1, v100
    s_cbranch_vccnz L_p5_S5
    s_branch L_p5_K5
L_p5_S6:
    s_add_u32 s81, s81, 1
    s_cmp_ge_u32 s81, 32768
    s_cbranch_scc1 L_p5_K6
    buffer_load_dwordx4 v[104:107], v21, s[16:19], s39 offen offset:0 sc1
    buffer_load_dwordx4 v[108:111], v21, s[16:19], s39 offen offset:1024 sc1
    buffer_load_dwordx4 v[112:115], v21, s[16:19], s86 offen offset:0 sc1
    buffer_load_dwordx4 v[116:119], v21, s[16:19], s86 offen offset:1024 sc1
    buffer_load_dwordx4 v[120:123], v21, s[16:19], s41 offen offset:0 sc1
    buffer_load_dwordx4 v[124:127], v21, s[16:19], s41 offen offset:1024 sc1
    buffer_load_dwordx4 v[128:131], v21, s[16:19], s44 offen offset:0 sc1
    buffer_load_dwordx4 v[132:135], v21, s[16:19], s44 offen offset:1024 sc1
    s_waitcnt vmcnt(7)
    v_cmp_eq_u32 vcc, -1, v104
    s_cbranch_vccnz L_p5_S6
    s_branch L_p5_K6
L_p5_S7:
    s_add_u32 s81, s81, 1
    s_cmp_ge_u32 s81, 32768
    s_cbranch_scc1 L_p5_K7
    buffer_load_dwordx4 v[108:111], v21, s[16:19], s39 offen offset:1024 sc1
    buffer_load_dwordx4 v[112:115], v21, s[16:19], s86 offen offset:0 sc1
    buffer_load_dwordx4 v[116:119], v21, s[16:19], s86 offen offset:1024 sc1
    buffer_load_dwordx4 v[120:123], v21, s[16:19], s41 offen offset:0 sc1
    buffer_load_dwordx4 v[124:127], v21, s[16:19], s41 offen offset:1024 sc1
    buffer_load_dwordx4 v[128:131], v21, s[16:19], s44 offen offset:0 sc1
    buffer_load_dwordx4 v[132:135], v21, s[16:19], s44 offen offset:1024 sc1
    s_waitcnt vmcnt(6)
    v_cmp_eq_u32 vcc, -1, v108
    s_cbranch_vccnz L_p5_S7
    s_branch L_p5_K7
L_p5_S8:
    s_add_u32 s81, s81, 1
    s_cmp_ge_u32 s81, 32768
    s_cbranch_scc1 L_p5_K8
    buffer_load_dwordx4 v[112:115], v21, s[16:19], s86 offen offset:0 sc1
    buffer_load_dwordx4 v[116:119], v21, s[16:19], s86 offen offset:1024 sc1
    buffer_load_dwordx4 v[120:123], v21, s[16:19], s41 offen offset:0 sc1
    buffer_load_dwordx4 v[124:127], v21, s[16:19], s41 offen offset:1024 sc1
    buffer_load_dwordx4 v[128:131], v21, s[16:19], s44 offen offset:0 sc1
    buffer_load_dwordx4 v[132:135], v21, s[16:19], s44 offen offset:1024 sc1
    s_waitcnt vmcnt(0)
    v_cmp_eq_u32 vcc, -1, v112
    s_cbranch_vccnz L_p5_S8
    s_branch L_p5_K8
L_p5_S9:
    s_add_u32 s81, s81, 1
    s_cmp_ge_u32 s81, 32768
    s_cbranch_scc1 L_p5_K9
    buffer_load_dwordx4 v[116:119], v21, s[16:19], s86 offen offset:1024 sc1
    buffer_load_dwordx4 v[120:123], v21, s[16:19], s41 offen offset:0 sc1
    buffer_load_dwordx4 v[124:127], v21, s[16:19], s41 offen offset:1024 sc1
    buffer_load_dwordx4 v[128:131], v21, s[16:19], s44 offen offset:0 sc1
    buffer_load_dwordx4 v[132:135], v21, s[16:19], s44 offen offset:1024 sc1
    s_waitcnt vmcnt(0)
    v_cmp_eq_u32 vcc, -1, v116
    s_cbranch_vccnz L_p5_S9
    s_branch L_p5_K9
L_p5_S10:
    s_add_u32 s81, s81, 1
    s_cmp_ge_u32 s81, 32768
    s_cbranch_scc1 L_p5_K10
    buffer_load_dwordx4 v[120:123], v21, s[16:19], s41 offen offset:0 sc1
    buffer_load_dwordx4 v[124:127], v21, s[16:19], s41 offen offset:1024 sc1
    buffer_load_dwordx4 v[128:131], v21, s[16:19], s44 offen offset:0 sc1
    buffer_load_dwordx4 v[132:135], v21, s[16:19], s44 offen offset:1024 sc1
    s_waitcnt vmcnt(0)
    v_cmp_eq_u32 vcc, -1, v120
    s_cbranch_vccnz L_p5_S10
    s_branch L_p5_K10
L_p5_S11:
    s_add_u32 s81, s81, 1
    s_cmp_ge_u32 s81, 32768
    s_cbranch_scc1 L_p5_K11
    buffer_load_dwordx4 v[124:127], v21, s[16:19], s41 offen offset:1024 sc1
    buffer_load_dwordx4 v[128:131], v21, s[16:19], s44 offen offset:0 sc1
    buffer_load_dwordx4 v[132:135], v21, s[16:19], s44 offen offset:1024 sc1
    s_waitcnt vmcnt(0)
    v_cmp_eq_u32 vcc, -1, v124
    s_cbranch_vccnz L_p5_S11
    s_branch L_p5_K11
L_p5_S12:
    s_add_u32 s81, s81, 1
    s_cmp_ge_u32 s81, 32768
    s_cbranch_scc1 L_p5_K12
    buffer_load_dwordx4 v[128:131], v21, s[16:19], s44 offen offset:0 sc1
    buffer_load_dwordx4 v[132:135], v21, s[16:19], s44 offen offset:1024 sc1
    s_waitcnt vmcnt(0)
    v_cmp_eq_u32_e64 vcc, -1, v128
    s_cbranch_vccnz L_p5_S12
    s_branch L_p5_K12
L_p5_S13:
    s_add_u32 s81, s81, 1
    s_cmp_ge_u32 s81, 32768
    s_cbranch_scc1 L_p5_K13
    buffer_load_dwordx4 v[132:135], v21, s[16:19], s44 offen offset:1024 sc1
    s_waitcnt vmcnt(0)
    v_cmp_eq_u32 vcc, -1, v132
    s_cbranch_vccnz L_p5_S13
    s_branch L_p5_K13
L_rem_7:
    s_nop 1
    buffer_store_dwordx4 v[80:83], v1, s[16:19], s4 offen offset:0 sc1
    buffer_store_dwordx4 v[84:87], v1, s[16:19], s4 offen offset:1024 sc1
    s_nop 1
    s_branch L_std_8
L_rem_9:
    s_nop 1
    s_add_u32 s4, s94, 33555456
    s_mov_b64 exec, 0xffff
    buffer_store_dwordx2 v[64:65], v20, s[16:19], s4 offen sc1
    s_mov_b64 exec, -1
    s_nop 1
    s_branch L_std_10
L_p6_S0:
    s_add_u32 s81, s81, 1
    s_cmp_ge_u32 s81, 32768
    s_cbranch_scc1 L_p6_K0
    buffer_load_dwordx4 v[88:91], v21, s[16:19], s71 offen offset:0 sc1
    buffer_load_dwordx4 v[92:95], v21, s[16:19], s71 offen offset:1024 sc1
    buffer_load_dwordx4 v[96:99], v21, s[16:19], s72 offen offset:0 sc1
    buffer_load_dwordx4 v[100:103], v21, s[16:19], s72 offen offset:1024 sc1
    buffer_load_dwordx4 v[104:107], v21, s[16:19], s73 offen offset:0 sc1
    buffer_load_dwordx4 v[108:111], v21, s[16:19], s73 offen offset:1024 sc1
    buffer_load_dwordx4 v[112:115], v21, s[16:19], s74 offen offset:0 sc1
    buffer_load_dwordx4 v[116:119], v21, s[16:19], s74 offen offset:1024 sc1
    s_waitcnt vmcnt(0)
    v_cmp_eq_u32 vcc, -1, v88
    s_cbranch_vccnz L_p6_S0
    s_branch L_p6_K0
L_p6_S1:
    s_add_u32 s81, s81, 1
    s_cmp_ge_u32 s81, 32768
    s_cbranch_scc1 L_p6_K1
    buffer_load_dwordx4 v[92:95], v21, s[16:19], s71 offen offset:1024 sc1
    buffer_load_dwordx4 v[96:99], v21, s[16:19], s72 offen offset:0 sc1
    buffer_load_dwordx4 v[100:103], v21, s[16:19], s72 offen offset:1024 sc1
    buffer_load_dwordx4 v[104:107], v21, s[16:19], s73 offen offset:0 sc1
    buffer_load_dwordx4 v[108:111], v21, s[16:19], s73 offen offset:1024 sc1
    buffer_load_dwordx4 v[112:115], v21, s[16:19], s74 offen offset:0 sc1
    buffer_load_dwordx4 v[116:119], v21, s[16:19], s74 offen offset:1024 sc1
    buffer_load_dwordx4 v[120:123], v21, s[16:19], s75 offen offset:0 sc1
    s_waitcnt vmcnt(0)
    v_cmp_eq_u32 vcc, -1, v92
    s_cbranch_vccnz L_p6_S1
    s_branch L_p6_K1
L_p6_S2:
    s_add_u32 s81, s81, 1
    s_cmp_ge_u32 s81, 32768
    s_cbranch_scc1 L_p6_K2
    buffer_load_dwordx4 v[96:99], v21, s[16:19], s72 offen offset:0 sc1
    buffer_load_dwordx4 v[100:103], v21, s[16:19], s72 offen offset:1024 sc1
    buffer_load_dwordx4 v[104:107], v21, s[16:19], s73 offen offset:0 sc1
    buffer_load_dwordx4 v[108:111], v21, s[16:19], s73 offen offset:1024 sc1
    buffer_load_dwordx4 v[112:115], v21, s[16:19], s74 offen offset:0 sc1
    buffer_load_dwordx4 v[116:119], v21, s[16:19], s74 offen offset:1024 sc1
    buffer_load_dwordx4 v[120:123], v21, s[16:19], s75 offen offset:0 sc1
    buffer_load_dwordx4 v[124:127], v21, s[16:19], s75 offen offset:1024 sc1
    s_waitcnt vmcnt(7)
    v_cmp_eq_u32 vcc, -1, v96
    s_cbranch_vccnz L_p6_S2
    s_branch L_p6_K2
L_p6_S3:
    s_add_u32 s81, s81, 1
    s_cmp_ge_u32 s81, 32768
    s_cbranch_scc1 L_p6_K3
    buffer_load_dwordx4 v[100:103], v21, s[16:19], s72 offen offset:1024 sc1
    buffer_load_dwordx4 v[104:107], v21, s[16:19], s73 offen offset:0 sc1
    buffer_load_dwordx4 v[108:111], v21, s[16:19], s73 offen offset:1024 sc1
    buffer_load_dwordx4 v[112:115], v21, s[16:19], s74 offen offset:0 sc1
    buffer_load_dwordx4 v[116:119], v21, s[16:19], s74 offen offset:1024 sc1
    buffer_load_dwordx4 v[120:123], v21, s[16:19], s75 offen offset:0 sc1
    buffer_load_dwordx4 v[124:127], v21, s[16:19], s75 offen offset:1024 sc1
    buffer_load_dwordx4 v[128:131], v21, s[16:19], s76 offen offset:0 sc1
    s_waitcnt vmcnt(7)
    v_cmp_eq_u32 vcc, -1, v100
    s_cbranch_vccnz L_p6_S3
    s_branch L_p6_K3
L_p6_S4:
    s_add_u32 s81, s81, 1
    s_cmp_ge_u32 s81, 32768
    s_cbranch_scc1 L_p6_K4
    buffer_load_dwordx4 v[104:107], v21, s[16:19], s73 offen offset:0 sc1
    buffer_load_dwordx4 v[108:111], v21, s[16:19], s73 offen offset:1024 sc1
    buffer_load_dwordx4 v[112:115], v21, s[16:19], s74 offen offset:0 sc1
    buffer_load_dwordx4 v[116:119], v21, s[16:19], s74 offen offset:1024 sc1
    buffer_load_dwordx4 v[120:123], v21, s[16:19], s75 offen offset:0 sc1
    buffer_load_dwordx4 v[124:127], v21, s[16:19], s75 offen offset:1024 sc1
    buffer_load_dwordx4 v[128:131], v21, s[16:19], s76 offen offset:0 sc1
    buffer_load_dwordx4 v[132:135], v21, s[16:19], s76 offen offset:1024 sc1
    s_waitcnt vmcnt(7)
    v_cmp_eq_u32 vcc, -1, v104
    s_cbranch_vccnz L_p6_S4
    s_branch L_p6_K4
L_p6_S5:
    s_add_u32 s81, s81, 1
    s_cmp_ge_u32 s81, 32768
    s_cbranch_scc1 L_p6_K5
    buffer_load_dwordx4 v[108:111], v21, s[16:19], s73 offen offset:1024 sc1
    buffer_load_dwordx4 v[112:115], v21, s[16:19], s74 offen offset:0 sc1
    buffer_load_dwordx4 v[116:119], v21, s[16:19], s74 offen offset:1024 sc1
    buffer_load_dwordx4 v[120:123], v21, s[16:19], s75 offen offset:0 sc1
    buffer_load_dwordx4 v[124:127], v21, s[16:19], s75 offen offset:1024 sc1
    buffer_load_dwordx4 v[128:131], v21, s[16:19], s76 offen offset:0 sc1
    buffer_load_dwordx4 v[132:135], v21, s[16:19], s76 offen offset:1024 sc1
    buffer_load_dwordx4 v[28:31], v20, s[16:19], s82 offen sc1
    s_waitcnt vmcnt(7)
    v_cmp_eq_u32 vcc, -1, v108
    s_cbranch_vccnz L_p6_S5
    s_branch L_p6_K5
L_p6_S6:
    s_add_u32 s81, s81, 1
    s_cmp_ge_u32 s81, 32768
    s_cbranch_scc1 L_p6_K6
    buffer_load_dwordx4 v[112:115], v21, s[16:19], s74 offen offset:0 sc1
    buffer_load_dwordx4 v[116:119], v21, s[16:19], s74 offen offset:1024 sc1
    buffer_load_dwordx4 v[120:123], v21, s[16:19], s75 offen offset:0 sc1
    buffer_load_dwordx4 v[124:127], v21, s[16:19], s75 offen offset:1024 sc1
    buffer_load_dwordx4 v[128:131], v21, s[16:19], s76 offen offset:0 sc1
    buffer_load_dwordx4 v[132:135], v21, s[16:19], s76 offen offset:1024 sc1
    buffer_load_dwordx4 v[28:31], v20, s[16:19], s82 offen sc1
    s_waitcnt vmcnt(6)
    v_cmp_eq_u32 vcc, -1, v112
    s_cbranch_vccnz L_p6_S6
    s_branch L_p6_K6
L_p6_S7:
    s_add_u32 s81, s81, 1
    s_cmp_ge_u32 s81, 32768
    s_cbranch_scc1 L_p6_K7
    buffer_load_dwordx4 v[116:119], v21, s[16:19], s74 offen offset:1024 sc1
    buffer_load_dwordx4 v[120:123], v21, s[16:19], s75 offen offset:0 sc1
    buffer_load_dwordx4 v[124:127], v21, s[16:19], s75 offen offset:1024 sc1
    buffer_load_dwordx4 v[128:131], v21, s[16:19], s76 offen offset:0 sc1
    buffer_load_dwordx4 v[132:135], v21, s[16:19], s76 offen offset:1024 sc1
    buffer_load_dwordx4 v[28:31], v20, s[16:19], s82 offen sc1
    s_waitcnt vmcnt(5)
    v_cmp_eq_u32 vcc, -1, v116
    s_cbranch_vccnz L_p6_S7
    s_branch L_p6_K7
L_p6_S8:
    s_add_u32 s81, s81, 1
    s_cmp_ge_u32 s81, 32768
    s_cbranch_scc1 L_p6_K8
    buffer_load_dwordx4 v[120:123], v21, s[16:19], s75 offen offset:0 sc1
    buffer_load_dwordx4 v[124:127], v21, s[16:19], s75 offen offset:1024 sc1
    buffer_load_dwordx4 v[128:131], v21, s[16:19], s76 offen offset:0 sc1
    buffer_load_dwordx4 v[132:135], v21, s[16:19], s76 offen offset:1024 sc1
    buffer_load_dwordx4 v[28:31], v20, s[16:19], s82 offen sc1
    s_waitcnt vmcnt(0)
    v_cmp_eq_u32 vcc, -1, v120
    s_cbranch_vccnz L_p6_S8
    s_branch L_p6_K8
L_p6_S9:
    s_add_u32 s81, s81, 1
    s_cmp_ge_u32 s81, 32768
    s_cbranch_scc1 L_p6_K9
    buffer_load_dwordx4 v[124:127], v21, s[16:19], s75 offen offset:1024 sc1
    buffer_load_dwordx4 v[128:131], v21, s[16:19], s76 offen offset:0 sc1
    buffer_load_dwordx4 v[132:135], v21, s[16:19], s76 offen offset:1024 sc1
    buffer_load_dwordx4 v[28:31], v20, s[16:19], s82 offen sc1
    s_waitcnt vmcnt(0)
    v_cmp_eq_u32 vcc, -1, v124
    s_cbranch_vccnz L_p6_S9
    s_branch L_p6_K9
L_p6_S10:
    s_add_u32 s81, s81, 1
    s_cmp_ge_u32 s81, 32768
    s_cbranch_scc1 L_p6_K10
    buffer_load_dwordx4 v[128:131], v21, s[16:19], s76 offen offset:0 sc1
    buffer_load_dwordx4 v[132:135], v21, s[16:19], s76 offen offset:1024 sc1
    buffer_load_dwordx4 v[28:31], v20, s[16:19], s82 offen sc1
    s_waitcnt vmcnt(0)
    v_cmp_eq_u32 vcc, -1, v128
    s_cbranch_vccnz L_p6_S10
    s_branch L_p6_K10
L_p6_S11:
    s_add_u32 s81, s81, 1
    s_cmp_ge_u32 s81, 32768
    s_cbranch_scc1 L_p6_K11
    buffer_load_dwordx4 v[132:135], v21, s[16:19], s76 offen offset:1024 sc1
    buffer_load_dwordx4 v[28:31], v20, s[16:19], s82 offen sc1
    s_waitcnt vmcnt(0)
    v_cmp_eq_u32 vcc, -1, v132
    s_cbranch_vccnz L_p6_S11
    s_branch L_p6_K11
L_cs3_S:
    s_add_u32 s81, s81, 1
    s_cmp_ge_u32 s81, 32768
    s_cbranch_scc1 L_cs3_K
    buffer_load_dwordx4 v[72:75], v248, s[16:19], s40 offen offset:0 sc1
    buffer_load_dwordx4 v[76:79], v248, s[16:19], s40 offen offset:512 sc1
    s_waitcnt vmcnt(0)
    s_branch L_cs3_C
L_p6_S12:
    s_add_u32 s81, s81, 1
    s_cmp_ge_u32 s81, 32768
    s_cbranch_scc1 L_p6_K12
    buffer_load_dwordx4 v[28:31], v20, s[16:19], s82 offen sc1
    s_waitcnt vmcnt(0)
    s_mov_b32 exec_hi, 0xffff
    v_add_f32_e64 v28, v28, v30
    v_add_f32_e64 v29, v29, v31
    s_mov_b32 exec_hi, -1
    v_cmp_u_f32_e64 vcc, v28, v29
    s_cbranch_vccnz L_p6_S12
    s_branch L_p6_K12
L_rem_11:
    s_nop 1
    s_mov_b64 exec, 1
    buffer_store_dword a244, off, s[16:19], s50 sc1
    s_mov_b64 exec, -1
    s_nop 1
    s_branch L_std_12
L_rem_13:
    s_nop 1
    buffer_store_dwordx4 v[64:67], v1, s[16:19], s3 offen offset:0 sc1
    buffer_store_dwordx4 v[68:71], v1, s[16:19], s3 offen offset:1024 sc1
    s_nop 1
    s_branch L_std_14
L_f1_S:
    s_add_u32 s81, s81, 1
    s_cmp_ge_u32 s81, 32768
    s_cbranch_scc1 L_f1_K
    buffer_load_dword v253, v252, s[16:19], s49 offen sc1
    s_waitcnt vmcnt(0)
    s_branch L_f1_C
L_rem_15:
    s_nop 1
    buffer_store_dwordx4 v[32:35], v1, s[16:19], s3 offen offset:0 sc1
    buffer_store_dwordx4 v[36:39], v1, s[16:19], s3 offen offset:1024 sc1
    s_nop 1
    s_branch L_std_16
L_rem_17:
    s_nop 1
    buffer_store_dwordx4 v[48:51], v1, s[16:19], s3 offen offset:0 sc1
    buffer_store_dwordx4 v[52:55], v1, s[16:19], s3 offen offset:1024 sc1
    s_nop 1
    s_branch L_std_18
L_fa_S:
    s_add_u32 s81, s81, 1
    s_cmp_ge_u32 s81, 32768
    s_cbranch_scc1 L_fa_K
    buffer_load_dwordx4 v[80:83], v1, s[16:19], s36 offen offset:0 sc1
    buffer_load_dwordx4 v[84:87], v1, s[16:19], s36 offen offset:1024 sc1
    buffer_load_dwordx4 v[88:91], v1, s[16:19], s41 offen offset:0 sc1
    buffer_load_dwordx4 v[92:95], v1, s[16:19], s41 offen offset:1024 sc1
    s_waitcnt vmcnt(0)
    v_or3_b32 v28, v80, v84, v88
    v_or_b32 v28, v28, v92
    v_and_b32 v28, 1, v28
    v_cmp_ne_u32 vcc, 0, v28
    s_cbranch_vccnz L_fa_S
    s_branch L_fa_K
L_fb_S:
    s_add_u32 s81, s81, 1
    s_cmp_ge_u32 s81, 32768
    s_cbranch_scc1 L_fb_K
    buffer_load_dwordx4 v[96:99], v1, s[16:19], s43 offen offset:0 sc1
    buffer_load_dwordx4 v[100:103], v1, s[16:19], s43 offen offset:1024 sc1
    buffer_load_dwordx4 v[104:107], v1, s[16:19], s44 offen offset:0 sc1
    buffer_load_dwordx4 v[108:111], v1, s[16:19], s44 offen offset:1024 sc1
    s_waitcnt vmcnt(0)
    v_or3_b32 v28, v96, v100, v104
    v_or_b32 v28, v28, v108
    v_and_b32 v28, 1, v28
    v_cmp_ne_u32 vcc, 0, v28
    s_cbranch_vccnz L_fb_S
    s_branch L_fb_K
    s_endpgm
.section .rodata,"a"
.p2align 6
.amdhsa_kernel sequential_preLN__linear_kernel_hedgehog__mixer_s_mlp__prompt_kernel
  .amdhsa_next_free_vgpr 512
  .amdhsa_next_free_sgpr 102
  .amdhsa_accum_offset 256
  .amdhsa_group_segment_fixed_size 0
  .amdhsa_kernarg_size 96
  .amdhsa_user_sgpr_count 2
  .amdhsa_user_sgpr_kernarg_segment_ptr 1
  .amdhsa_system_sgpr_workgroup_id_x 1
.end_amdhsa_kernel
```
